```python
import torch

def _softmax(x, axis=-1):
    return torch.softmax(x, dim=axis)
def _gelu(x):
    return torch.nn.functional.gelu(x, approximate="tanh")
def _silu(x):
    return torch.nn.functional.silu(x)
def _sigmoid(x):
    return torch.sigmoid(x)
def _layernorm(x, axis=-1, eps=1e-5):
    m = x.mean(dim=axis, keepdim=True)
    v = x.var(dim=axis, keepdim=True, unbiased=False)
    return (x - m) / torch.sqrt(v + eps)
def _scatter_add(tgt, idx, src, axis=0):
    return tgt.clone().index_add_(axis, idx, src)
def _segment_sum(src, seg, n):
    out = torch.zeros((n,) + src.shape[1:], dtype=src.dtype)
    return out.index_add_(0, seg, src)
def _pad(x, pw):
    flat = tuple(v for pair in reversed(pw) for v in pair)
    return torch.nn.functional.pad(x, flat)

kernel_name = 'parallel_sum__linear_attn_block__mixer_channel_mlp__prompt'

def setup_inputs():

    _w = (lambda a: (lambda t: t.to(torch.bfloat16) if t.is_floating_point() else t)(torch.as_tensor(a)))
    def _A_setup():
        B, S, D = 1, 2048, 576
        return {
            "x": _w((lambda *s: torch.randn(*s, dtype=torch.bfloat16) * 0.05)(B, S, D)),
            "wqkv": _w((lambda *s: torch.randn(*s, dtype=torch.bfloat16) * 0.1)(D, 3 * D)),
            "wo": _w((lambda *s: torch.randn(*s, dtype=torch.bfloat16) * 0.05)(D, D)),
        }
    _A_in = _A_setup()

    def _B_setup():
        B, S, D, F = 1, 2048, 576, 4608
        return {
            "x": _w((lambda *s: torch.randn(*s, dtype=torch.bfloat16) * 0.05)(B, S, D)),
            "w1": _w((lambda *s: torch.randn(*s, dtype=torch.bfloat16) * 1.6)(D, F) * (D ** -0.5)),
            "b1": _w((lambda *s: torch.randn(*s, dtype=torch.bfloat16) * 0.8)(F)),
            "w2": _w((lambda *s: torch.randn(*s, dtype=torch.bfloat16) * 0.05)(F, D) * (F ** -0.5)),
            "b2": _w((lambda *s: torch.randn(*s, dtype=torch.bfloat16) * 0.05)(D)),
        }
    _B_in = _B_setup()

    return {
        "A_x": _A_in["x"],
        "A_wqkv": _A_in["wqkv"],
        "A_wo": _A_in["wo"],
        "B_x": _B_in["x"],
        "B_w1": _B_in["w1"],
        "B_b1": _B_in["b1"],
        "B_w2": _B_in["w2"],
        "B_b2": _B_in["b2"],
    }

def reference(A_x, A_wqkv, A_wo, B_x, B_w1, B_b1, B_w2, B_b2):
    def _A_ref(x, wqkv, wo):
        B, S, D = x.shape
        H = 32; Dh = D // H
        qkv = (lambda x, *d: x.permute(*d))((x @ wqkv).reshape(B, S, 3, H, Dh), 2, 0, 3, 1, 4)
        q, k, v = qkv[0], qkv[1], qkv[2]
        phi = lambda t: torch.where(t > 0, t + 1, torch.exp(t)) + 1e-6
        pq, pk = phi(q), phi(k)
        kv = torch.einsum("bhsd,bhse->bhde", pk, v)
        z = torch.einsum("bhsd->bhd", pk)
        num = torch.einsum("bhqd,bhde->bhqe", pq, kv)
        den = torch.einsum("bhqd,bhd->bhq", pq, z)[..., None] + 1e-6
        o = num / den
        return (lambda x, *d: x.permute(*d))(o, 0, 2, 1, 3).reshape(B, S, D) @ wo

    def _B_ref(x, w1, b1, w2, b2):
        y = _layernorm(x, axis=-1)
        h = _gelu(torch.einsum("bsd,df->bsf", y, w1) + b1)
        return torch.einsum("bsf,fd->bsd", h, w2) + b2

    x = A_x
    xn = _layernorm(x, axis=-1)
    return x + _A_ref(xn, A_wqkv, A_wo) + _B_ref(xn, B_w1, B_b1, B_w2, B_b2)
```

```asm
; @launch grid=(256,1,1) block=(256,1,1) lds=163840
.amdgcn_target "amdgcn-amd-amdhsa--gfx950"
.text
.globl parallel_sum__linear_attn_block__mixer_channel_mlp__prompt_kernel
.p2align 8
.type parallel_sum__linear_attn_block__mixer_channel_mlp__prompt_kernel,@function
parallel_sum__linear_attn_block__mixer_channel_mlp__prompt_kernel:
  s_cmp_ge_u32 s2, 256
  s_cbranch_scc1 L_end
  s_load_dwordx16 s[4:19], s[0:1], 0
  s_load_dwordx4 s[20:23], s[0:1], 64
  s_load_dwordx2 s[24:25], s[0:1], 80
  s_getpc_b64 s[54:55]
  v_lshrrev_b32 v4, 6, v0
  v_and_b32 v5, 63, v0
  v_readfirstlane_b32 s26, v4
  v_lshlrev_b32 v1, 4, v5
  v_and_b32 v2, 15, v5
  v_lshrrev_b32 v3, 4, v5
  s_and_b32 s56, s2, 3
  s_lshl_b32 s56, s56, 1
  s_bfe_u32 s57, s2, 0x10003
  s_or_b32 s27, s56, s57
  s_bfe_u32 s56, s2, 0x10002
  s_lshl_b32 s56, s56, 4
  s_lshr_b32 s57, s2, 4
  s_or_b32 s28, s56, s57
  s_lshr_b32 s56, s2, 3
  s_lshl_b32 s56, s56, 4
  s_lshl_b32 s57, s26, 2
  s_add_u32 s56, s56, s57
  v_add_u32 v20, s56, v5
  v_lshlrev_b32 v20, 7, v20
  v_min_u32 v21, 0xaaec, v20
  s_mov_b64 exec, 15
  global_load_dword v174, v21, s[54:55]
  s_mov_b64 exec, -1
  s_lshl_b32 s56, s28, 6
  s_lshl_b32 s57, s26, 4
  s_add_u32 s56, s56, s57
  v_lshrrev_b32 v18, 2, v5
  v_and_b32 v19, 3, v5
  v_add_u32 v24, s56, v18
  v_mul_u32_u24 v24, 1152, v24
  v_lshl_add_u32 v24, v19, 4, v24
  v_lshlrev_b32 v20, 1, v19
  v_xor_b32 v20, v18, v20
  v_lshl_add_u32 v20, v19, 4, v20
  v_lshlrev_b32 v30, 4, v20
  v_mov_b32 v29, v18
  v_and_b32 v9, 7, v5
  v_lshrrev_b32 v10, 3, v5
  v_lshrrev_b32 v4, 2, v10
  v_and_b32 v18, 3, v10
  v_and_b32 v6, 1, v9
  v_bfe_u32 v7, v9, 1, 1
  v_lshrrev_b32 v8, 2, v9
  v_mov_b32 v5, v18
  s_waitcnt lgkmcnt(0)
  s_mov_b32 s40, s4
  s_mov_b32 s41, s5
  s_mov_b32 s42, 2359296
  s_mov_b32 s43, 0x20000
  buffer_load_dwordx4 v[64:67], v24, s[40:43], 0 offen offset:0
  buffer_load_dwordx4 v[68:71], v24, s[40:43], 0 offen offset:64
  buffer_load_dwordx4 v[72:75], v24, s[40:43], 0 offen offset:128
  buffer_load_dwordx4 v[76:79], v24, s[40:43], 0 offen offset:192
  buffer_load_dwordx4 v[80:83], v24, s[40:43], 0 offen offset:256
  buffer_load_dwordx4 v[84:87], v24, s[40:43], 0 offen offset:320
  buffer_load_dwordx4 v[88:91], v24, s[40:43], 0 offen offset:384
  buffer_load_dwordx4 v[92:95], v24, s[40:43], 0 offen offset:448
  buffer_load_dwordx4 v[96:99], v24, s[40:43], 0 offen offset:512
  buffer_load_dwordx4 v[100:103], v24, s[40:43], 0 offen offset:576
  buffer_load_dwordx4 v[104:107], v24, s[40:43], 0 offen offset:640
  buffer_load_dwordx4 v[108:111], v24, s[40:43], 0 offen offset:704
  buffer_load_dwordx4 v[112:115], v24, s[40:43], 0 offen offset:768
  buffer_load_dwordx4 v[116:119], v24, s[40:43], 0 offen offset:832
  buffer_load_dwordx4 v[120:123], v24, s[40:43], 0 offen offset:896
  buffer_load_dwordx4 v[124:127], v24, s[40:43], 0 offen offset:960
  buffer_load_dwordx4 v[128:131], v24, s[40:43], 0 offen offset:1024
  buffer_load_dwordx4 v[132:135], v24, s[40:43], 0 offen offset:1088
  s_lshl_b32 s74, s26, 5
  s_add_u32 s74, s74, s28
  s_sub_u32 s58, s74, 72
  s_cmp_lt_u32 s74, 72
  s_cselect_b32 s58, s74, s58
  s_mul_i32 s59, s58, 3641
  s_lshr_b32 s59, s59, 16
  s_mul_i32 s60, s59, 18
  s_sub_u32 s60, s58, s60
  s_lshl_b32 s60, s60, 5
  s_mov_b32 s61, 4
  s_mov_b32 s62, 8
  s_mov_b32 s64, 575
  s_mul_i32 s71, s27, 144
  s_mov_b32 s65, 1152
  s_mov_b32 s66, 8
  s_mov_b32 s67, 0
  s_mov_b32 s68, 32
  s_mov_b32 s69, 64
  s_mov_b32 s76, 16
  s_mov_b32 s77, 0
  s_cmp_eq_u32 s59, 1
  s_cselect_b32 s65, 2320, s65
  s_cmp_eq_u32 s59, 3
  s_cselect_b32 s65, 0, s65
  s_cmp_eq_u32 s59, 2
  s_cselect_b32 s65, 1280, s65
  s_cselect_b32 s66, 4, s66
  s_cselect_b32 s67, 4294966144, s67
  s_cselect_b32 s68, 0, s68
  s_cselect_b32 s69, 0, s69
  s_cselect_b32 s76, 1024, s76
  s_cselect_b32 s77, 4294966288, s77
  s_add_u32 s65, s65, s71
  s_mul_i32 s72, s27, 1152
  s_lshl_b32 s73, s59, 7
  s_add_u32 s72, s72, s73
  s_cmp_lt_u32 s74, 72
  s_cselect_b32 s65, s65, s72
  s_cselect_b32 s66, s66, 8
  s_cselect_b32 s67, s67, 0
  s_cselect_b32 s68, s68, 32
  s_cselect_b32 s69, s69, 64
  s_cselect_b32 s76, s76, 16
  s_cselect_b32 s77, s77, 0
  s_mov_b32 s72, 9216
  s_cselect_b32 s63, 3456, s72
  s_cselect_b32 s36, s6, s12
  s_cselect_b32 s37, s7, s13
  s_mov_b32 s72, 5308416
  s_cselect_b32 s38, 1990656, s72
  s_mov_b32 s39, 0x20000
  s_mov_b32 s70, s74
  s_mov_b32 s72, 0
  s_mov_b32 s74, s76
  s_mov_b32 s75, s77
  s_mul_i32 s73, s27, 1692
  s_add_u32 s70, s70, s73
  s_lshl_b32 s70, s70, 10
  s_cmp_eq_u32 s72, 0
  s_cselect_b32 s70, s70, 1879048192
  s_cselect_b32 s38, s38, 0
  s_mov_b32 s94, s70
  v_mad_u32_u24 v10, v4, s61, v5
  v_mul_u32_u24 v11, s74, v6
  v_mad_u32_u24 v11, v7, s68, v11
  v_mad_u32_u24 v11, v8, s69, v11
  v_mul_i32_i24 v12, s75, v6
  v_add_u32 v12, s67, v12
  v_cmp_le_u32 vcc, s66, v9
  s_mov_b32 s73, s60
  s_nop 0
  v_cndmask_b32 v12, 0, v12, vcc
  v_add3_u32 v11, v11, v12, s65
  v_add_u32 v12, s73, v10
  v_min_u32 v12, s64, v12
  v_mad_u32_u24 v13, v12, s63, v11
  s_add_u32 s73, s73, s62
  v_add_u32 v12, s73, v10
  v_min_u32 v12, s64, v12
  v_mad_u32_u24 v14, v12, s63, v11
  s_add_u32 s73, s73, s62
  v_add_u32 v12, s73, v10
  v_min_u32 v12, s64, v12
  v_mad_u32_u24 v15, v12, s63, v11
  s_add_u32 s73, s73, s62
  v_add_u32 v12, s73, v10
  v_min_u32 v12, s64, v12
  v_mad_u32_u24 v16, v12, s63, v11
  s_mul_i32 s72, s26, 12288
  s_add_u32 s72, s72, 24576
  s_mov_b32 m0, s72
  s_add_u32 s72, s72, 1024
  buffer_load_dwordx4 v13, s[36:39], 0 offen lds
  s_mov_b32 m0, s72
  s_add_u32 s72, s72, 1024
  buffer_load_dwordx4 v14, s[36:39], 0 offen lds
  s_mov_b32 m0, s72
  s_add_u32 s72, s72, 1024
  buffer_load_dwordx4 v15, s[36:39], 0 offen lds
  s_mov_b32 m0, s72
  s_add_u32 s72, s72, 1024
  buffer_load_dwordx4 v16, s[36:39], 0 offen lds
  s_mov_b32 s40, s4
  s_mov_b32 s41, s5
  s_mov_b32 s42, 2359296
  s_mov_b32 s43, 0x20000
  s_mov_b32 s32, s24
  s_mov_b32 s33, s25
  s_mov_b32 s34, 42991616
  s_mov_b32 s35, 0x20000
  s_lshl_b32 s56, s27, 13
  s_mul_i32 s57, s28, 180
  s_add_u32 s56, s56, s57
  s_add_u32 s56, s56, 37748736
  s_cmp_eq_u32 s26, 0
  s_cselect_b32 s56, s56, 1879048192
  v_lshrrev_b32 v18, 2, v1
  v_mov_b32 v20, 1879048192
  v_cmp_gt_u32 vcc, 180, v18
  s_nop 1
  v_cndmask_b32 v18, v20, v18, vcc
  v_mov_b32 v20, 0
  buffer_store_dword v20, v18, s[32:35], s56 offen sc1
  v_mov_b32 v28, 0
  s_mov_b32 s56, 35684352
  buffer_load_dword v28, v28, s[32:35], s56 offen
  v_lshrrev_b32 v17, 2, v2
  v_lshl_add_u32 v17, v3, 3, v17
  v_lshlrev_b32 v17, 7, v17
  v_and_b32 v18, 3, v2
  v_lshl_add_u32 v17, v18, 3, v17
  s_mul_i32 s72, s26, 12288
  s_add_u32 s72, s72, 24576
  v_add_u32 v17, s72, v17
  s_lshl_b32 s56, s28, 7
  s_lshl_b32 s57, s27, 12
  s_add_u32 s85, s56, s57
  s_lshl_b32 s58, s26, 5
  s_add_u32 s58, s58, s28
  s_mul_i32 s59, s58, 3641
  s_lshr_b32 s59, s59, 16
  s_mul_i32 s71, s59, 18
  s_sub_u32 s71, s58, s71
  s_lshr_b32 s60, s71, 2
  s_lshl_b32 s60, s60, 7
  s_and_b32 s73, s71, 3
  s_lshl_b32 s73, s73, 4
  s_add_u32 s60, s60, s73
  s_sub_u32 s73, s71, 16
  s_lshl_b32 s73, s73, 5
  s_add_u32 s73, s73, 512
  s_cmp_lt_u32 s71, 16
  s_cselect_b32 s60, s60, s73
  s_cselect_b32 s61, 64, 16
  s_mul_i32 s73, s27, 576
  s_add_u32 s60, s60, s73
  s_add_u32 s73, s27, s59
  s_and_b32 s73, s73, 7
  s_cmp_eq_u32 s59, 0
  s_cselect_b32 s73, 8, s73
  s_lshl_b32 s65, s73, 7
  s_mul_i32 s70, s59, 21
  s_add_u32 s70, s70, s71
  s_add_u32 s70, s70, 234
  s_mov_b32 s66, 8
  s_mov_b32 s67, 0
  s_mov_b32 s68, 32
  s_mov_b32 s69, 64
  s_mov_b32 s62, 4
  s_mov_b32 s63, 1152
  s_mov_b32 s64, 4607
  s_mov_b32 s72, 0
  s_mov_b32 s36, s16
  s_mov_b32 s37, s17
  s_mov_b32 s38, 5308416
  s_mov_b32 s39, 0x20000
  s_mov_b32 s74, 16
  s_mov_b32 s75, 0
  s_mul_i32 s73, s27, 1692
  s_add_u32 s70, s70, s73
  s_lshl_b32 s70, s70, 10
  s_cmp_eq_u32 s72, 0
  s_cselect_b32 s70, s70, 1879048192
  s_cselect_b32 s38, s38, 0
  s_mov_b32 s96, s70
  v_mad_u32_u24 v10, v4, s61, v5
  v_mul_u32_u24 v11, s74, v6
  v_mad_u32_u24 v11, v7, s68, v11
  v_mad_u32_u24 v11, v8, s69, v11
  v_mul_i32_i24 v12, s75, v6
  v_add_u32 v12, s67, v12
  v_cmp_le_u32 vcc, s66, v9
  s_mov_b32 s73, s60
  s_nop 0
  v_cndmask_b32 v12, 0, v12, vcc
  v_add3_u32 v11, v11, v12, s65
  v_add_u32 v12, s73, v10
  v_min_u32 v12, s64, v12
  v_mad_u32_u24 v216, v12, s63, v11
  s_add_u32 s73, s73, s62
  v_add_u32 v12, s73, v10
  v_min_u32 v12, s64, v12
  v_mad_u32_u24 v217, v12, s63, v11
  s_add_u32 s73, s73, s62
  v_add_u32 v12, s73, v10
  v_min_u32 v12, s64, v12
  v_mad_u32_u24 v218, v12, s63, v11
  s_add_u32 s73, s73, s62
  v_add_u32 v12, s73, v10
  v_min_u32 v12, s64, v12
  v_mad_u32_u24 v219, v12, s63, v11
  s_lshl_b32 s58, s26, 5
  s_add_u32 s58, s58, s28
  s_add_u32 s58, s58, 128
  s_mul_i32 s59, s58, 3641
  s_lshr_b32 s59, s59, 16
  s_mul_i32 s71, s59, 18
  s_sub_u32 s71, s58, s71
  s_lshr_b32 s60, s71, 2
  s_lshl_b32 s60, s60, 7
  s_and_b32 s73, s71, 3
  s_lshl_b32 s73, s73, 4
  s_add_u32 s60, s60, s73
  s_sub_u32 s73, s71, 16
  s_lshl_b32 s73, s73, 5
  s_add_u32 s73, s73, 512
  s_cmp_lt_u32 s71, 16
  s_cselect_b32 s60, s60, s73
  s_cselect_b32 s61, 64, 16
  s_mul_i32 s73, s27, 576
  s_add_u32 s60, s60, s73
  s_mov_b32 s64, 4607
  s_cmp_ge_u32 s58, 162
  s_cselect_b32 s72, 1, 0
  s_mul_i32 s74, s28, 21846
  s_lshr_b32 s74, s74, 16
  s_mul_i32 s75, s74, 3
  s_sub_u32 s75, s28, s75
  s_mul_i32 s76, s27, 72
  s_add_u32 s77, s76, 71
  s_lshl_b32 s73, s75, 5
  s_add_u32 s76, s76, s73
  s_add_u32 s75, s75, 18
  s_cmp_ge_u32 s28, 27
  s_cselect_b32 s73, 1, 0
  s_cmp_eq_u32 s26, 2
  s_cselect_b32 s59, s74, s59
  s_cselect_b32 s71, s75, s71
  s_cselect_b32 s60, s76, s60
  s_cselect_b32 s64, s77, s64
  s_cselect_b32 s61, 16, s61
  s_cselect_b32 s72, s73, s72
  s_cselect_b32 s36, s8, s16
  s_cselect_b32 s37, s9, s17
  s_mov_b32 s73, 5308416
  s_cselect_b32 s38, 663552, s73
  s_mov_b32 s39, 0x20000
  s_mov_b32 s62, 4
  s_mov_b32 s63, 1152
  s_add_u32 s73, s27, s59
  s_and_b32 s73, s73, 7
  s_cmp_eq_u32 s59, 0
  s_cselect_b32 s73, 8, s73
  s_lshl_b32 s65, s73, 7
  s_mul_i32 s70, s59, 21
  s_add_u32 s70, s70, s71
  s_add_u32 s70, s70, 234
  s_mov_b32 s66, 8
  s_mov_b32 s67, 0
  s_mov_b32 s68, 32
  s_mov_b32 s69, 64
  s_mov_b32 s74, 16
  s_mov_b32 s75, 0
  s_mul_i32 s73, s27, 1692
  s_add_u32 s70, s70, s73
  s_lshl_b32 s70, s70, 10
  s_cmp_eq_u32 s72, 0
  s_cselect_b32 s70, s70, 1879048192
  s_cselect_b32 s38, s38, 0
  s_mov_b32 s97, s70
  v_mad_u32_u24 v10, v4, s61, v5
  v_mul_u32_u24 v11, s74, v6
  v_mad_u32_u24 v11, v7, s68, v11
  v_mad_u32_u24 v11, v8, s69, v11
  v_mul_i32_i24 v12, s75, v6
  v_add_u32 v12, s67, v12
  v_cmp_le_u32 vcc, s66, v9
  s_mov_b32 s73, s60
  s_nop 0
  v_cndmask_b32 v12, 0, v12, vcc
  v_add3_u32 v11, v11, v12, s65
  v_add_u32 v12, s73, v10
  v_min_u32 v12, s64, v12
  v_mad_u32_u24 v220, v12, s63, v11
  s_add_u32 s73, s73, s62
  v_add_u32 v12, s73, v10
  v_min_u32 v12, s64, v12
  v_mad_u32_u24 v221, v12, s63, v11
  s_add_u32 s73, s73, s62
  v_add_u32 v12, s73, v10
  v_min_u32 v12, s64, v12
  v_mad_u32_u24 v222, v12, s63, v11
  s_add_u32 s73, s73, s62
  v_add_u32 v12, s73, v10
  v_min_u32 v12, s64, v12
  v_mad_u32_u24 v223, v12, s63, v11
  s_mov_b32 s98, s36
  s_mov_b32 s99, s37
  s_mov_b32 s100, s38
  s_mov_b32 s101, s39
  s_lshl_b32 s58, s26, 5
  s_add_u32 s58, s58, s28
  s_add_u32 s58, s58, 56
  s_mul_i32 s59, s58, 3641
  s_lshr_b32 s59, s59, 16
  s_mul_i32 s60, s59, 18
  s_sub_u32 s60, s58, s60
  s_lshl_b32 s60, s60, 5
  s_mul_i32 s65, s27, 1152
  s_lshl_b32 s73, s59, 7
  s_add_u32 s65, s65, s73
  s_add_u32 s70, s58, 72
  s_mov_b32 s66, 8
  s_mov_b32 s67, 0
  s_mov_b32 s68, 32
  s_mov_b32 s69, 64
  s_mov_b32 s61, 4
  s_mov_b32 s62, 8
  s_mov_b32 s63, 9216
  s_mov_b32 s64, 575
  s_mov_b32 s36, s12
  s_mov_b32 s37, s13
  s_mov_b32 s38, 5308416
  s_mov_b32 s39, 0x20000
  s_cmp_ge_u32 s58, 162
  s_cselect_b32 s72, 1, 0
  s_mov_b32 s74, 16
  s_mov_b32 s75, 0
  s_mul_i32 s73, s27, 1692
  s_add_u32 s70, s70, s73
  s_lshl_b32 s70, s70, 10
  s_cmp_eq_u32 s72, 0
  s_cselect_b32 s70, s70, 1879048192
  s_cselect_b32 s38, s38, 0
  s_mov_b32 s95, s70
  v_mad_u32_u24 v10, v4, s61, v5
  v_mul_u32_u24 v11, s74, v6
  v_mad_u32_u24 v11, v7, s68, v11
  v_mad_u32_u24 v11, v8, s69, v11
  v_mul_i32_i24 v12, s75, v6
  v_add_u32 v12, s67, v12
  v_cmp_le_u32 vcc, s66, v9
  s_mov_b32 s73, s60
  s_nop 0
  v_cndmask_b32 v12, 0, v12, vcc
  v_add3_u32 v11, v11, v12, s65
  v_add_u32 v12, s73, v10
  v_min_u32 v12, s64, v12
  v_mad_u32_u24 v13, v12, s63, v11
  s_add_u32 s73, s73, s62
  v_add_u32 v12, s73, v10
  v_min_u32 v12, s64, v12
  v_mad_u32_u24 v14, v12, s63, v11
  s_add_u32 s73, s73, s62
  v_add_u32 v12, s73, v10
  v_min_u32 v12, s64, v12
  v_mad_u32_u24 v15, v12, s63, v11
  s_add_u32 s73, s73, s62
  v_add_u32 v12, s73, v10
  v_min_u32 v12, s64, v12
  v_mad_u32_u24 v16, v12, s63, v11
  s_mov_b32 s84, 0x3f803f80
  v_mov_b32 v136, 0
  v_mov_b32 v140, 0
  v_mov_b32 v137, 0
  v_mov_b32 v141, 0
  v_mov_b32 v138, 0
  v_mov_b32 v142, 0
  v_mov_b32 v139, 0
  v_mov_b32 v143, 0
  s_waitcnt vmcnt(21)
  v_dot2_f32_bf16 v136, v64, s84, v136
  v_dot2_f32_bf16 v140, v64, v64, v140
  v_dot2_f32_bf16 v137, v65, s84, v137
  v_dot2_f32_bf16 v141, v65, v65, v141
  v_dot2_f32_bf16 v138, v66, s84, v138
  v_dot2_f32_bf16 v142, v66, v66, v142
  v_dot2_f32_bf16 v139, v67, s84, v139
  v_dot2_f32_bf16 v143, v67, v67, v143
  v_dot2_f32_bf16 v136, v68, s84, v136
  v_dot2_f32_bf16 v140, v68, v68, v140
  v_dot2_f32_bf16 v137, v69, s84, v137
  v_dot2_f32_bf16 v141, v69, v69, v141
  v_dot2_f32_bf16 v138, v70, s84, v138
  v_dot2_f32_bf16 v142, v70, v70, v142
  v_dot2_f32_bf16 v139, v71, s84, v139
  v_dot2_f32_bf16 v143, v71, v71, v143
  v_dot2_f32_bf16 v136, v72, s84, v136
  v_dot2_f32_bf16 v140, v72, v72, v140
  v_dot2_f32_bf16 v137, v73, s84, v137
  v_dot2_f32_bf16 v141, v73, v73, v141
  v_dot2_f32_bf16 v138, v74, s84, v138
  v_dot2_f32_bf16 v142, v74, v74, v142
  v_dot2_f32_bf16 v139, v75, s84, v139
  v_dot2_f32_bf16 v143, v75, v75, v143
  s_waitcnt vmcnt(18)
  v_dot2_f32_bf16 v136, v76, s84, v136
  v_dot2_f32_bf16 v140, v76, v76, v140
  v_dot2_f32_bf16 v137, v77, s84, v137
  v_dot2_f32_bf16 v141, v77, v77, v141
  v_dot2_f32_bf16 v138, v78, s84, v138
  v_dot2_f32_bf16 v142, v78, v78, v142
  v_dot2_f32_bf16 v139, v79, s84, v139
  v_dot2_f32_bf16 v143, v79, v79, v143
  v_dot2_f32_bf16 v136, v80, s84, v136
  v_dot2_f32_bf16 v140, v80, v80, v140
  v_dot2_f32_bf16 v137, v81, s84, v137
  v_dot2_f32_bf16 v141, v81, v81, v141
  v_dot2_f32_bf16 v138, v82, s84, v138
  v_dot2_f32_bf16 v142, v82, v82, v142
  v_dot2_f32_bf16 v139, v83, s84, v139
  v_dot2_f32_bf16 v143, v83, v83, v143
  v_dot2_f32_bf16 v136, v84, s84, v136
  v_dot2_f32_bf16 v140, v84, v84, v140
  v_dot2_f32_bf16 v137, v85, s84, v137
  v_dot2_f32_bf16 v141, v85, v85, v141
  v_dot2_f32_bf16 v138, v86, s84, v138
  v_dot2_f32_bf16 v142, v86, v86, v142
  v_dot2_f32_bf16 v139, v87, s84, v139
  v_dot2_f32_bf16 v143, v87, v87, v143
  s_waitcnt vmcnt(15)
  v_dot2_f32_bf16 v136, v88, s84, v136
  v_dot2_f32_bf16 v140, v88, v88, v140
  v_dot2_f32_bf16 v137, v89, s84, v137
  v_dot2_f32_bf16 v141, v89, v89, v141
  v_dot2_f32_bf16 v138, v90, s84, v138
  v_dot2_f32_bf16 v142, v90, v90, v142
  v_dot2_f32_bf16 v139, v91, s84, v139
  v_dot2_f32_bf16 v143, v91, v91, v143
  v_dot2_f32_bf16 v136, v92, s84, v136
  v_dot2_f32_bf16 v140, v92, v92, v140
  v_dot2_f32_bf16 v137, v93, s84, v137
  v_dot2_f32_bf16 v141, v93, v93, v141
  v_dot2_f32_bf16 v138, v94, s84, v138
  v_dot2_f32_bf16 v142, v94, v94, v142
  v_dot2_f32_bf16 v139, v95, s84, v139
  v_dot2_f32_bf16 v143, v95, v95, v143
  v_dot2_f32_bf16 v136, v96, s84, v136
  v_dot2_f32_bf16 v140, v96, v96, v140
  v_dot2_f32_bf16 v137, v97, s84, v137
  v_dot2_f32_bf16 v141, v97, v97, v141
  v_dot2_f32_bf16 v138, v98, s84, v138
  v_dot2_f32_bf16 v142, v98, v98, v142
  v_dot2_f32_bf16 v139, v99, s84, v139
  v_dot2_f32_bf16 v143, v99, v99, v143
  s_waitcnt vmcnt(12)
  v_dot2_f32_bf16 v136, v100, s84, v136
  v_dot2_f32_bf16 v140, v100, v100, v140
  v_dot2_f32_bf16 v137, v101, s84, v137
  v_dot2_f32_bf16 v141, v101, v101, v141
  v_dot2_f32_bf16 v138, v102, s84, v138
  v_dot2_f32_bf16 v142, v102, v102, v142
  v_dot2_f32_bf16 v139, v103, s84, v139
  v_dot2_f32_bf16 v143, v103, v103, v143
  v_dot2_f32_bf16 v136, v104, s84, v136
  v_dot2_f32_bf16 v140, v104, v104, v140
  v_dot2_f32_bf16 v137, v105, s84, v137
  v_dot2_f32_bf16 v141, v105, v105, v141
  v_dot2_f32_bf16 v138, v106, s84, v138
  v_dot2_f32_bf16 v142, v106, v106, v142
  v_dot2_f32_bf16 v139, v107, s84, v139
  v_dot2_f32_bf16 v143, v107, v107, v143
  v_dot2_f32_bf16 v136, v108, s84, v136
  v_dot2_f32_bf16 v140, v108, v108, v140
  v_dot2_f32_bf16 v137, v109, s84, v137
  v_dot2_f32_bf16 v141, v109, v109, v141
  v_dot2_f32_bf16 v138, v110, s84, v138
  v_dot2_f32_bf16 v142, v110, v110, v142
  v_dot2_f32_bf16 v139, v111, s84, v139
  v_dot2_f32_bf16 v143, v111, v111, v143
  s_waitcnt vmcnt(9)
  v_dot2_f32_bf16 v136, v112, s84, v136
  v_dot2_f32_bf16 v140, v112, v112, v140
  v_dot2_f32_bf16 v137, v113, s84, v137
  v_dot2_f32_bf16 v141, v113, v113, v141
  v_dot2_f32_bf16 v138, v114, s84, v138
  v_dot2_f32_bf16 v142, v114, v114, v142
  v_dot2_f32_bf16 v139, v115, s84, v139
  v_dot2_f32_bf16 v143, v115, v115, v143
  v_dot2_f32_bf16 v136, v116, s84, v136
  v_dot2_f32_bf16 v140, v116, v116, v140
  v_dot2_f32_bf16 v137, v117, s84, v137
  v_dot2_f32_bf16 v141, v117, v117, v141
  v_dot2_f32_bf16 v138, v118, s84, v138
  v_dot2_f32_bf16 v142, v118, v118, v142
  v_dot2_f32_bf16 v139, v119, s84, v139
  v_dot2_f32_bf16 v143, v119, v119, v143
  v_dot2_f32_bf16 v136, v120, s84, v136
  v_dot2_f32_bf16 v140, v120, v120, v140
  v_dot2_f32_bf16 v137, v121, s84, v137
  v_dot2_f32_bf16 v141, v121, v121, v141
  v_dot2_f32_bf16 v138, v122, s84, v138
  v_dot2_f32_bf16 v142, v122, v122, v142
  v_dot2_f32_bf16 v139, v123, s84, v139
  v_dot2_f32_bf16 v143, v123, v123, v143
  s_waitcnt vmcnt(6)
  v_dot2_f32_bf16 v136, v124, s84, v136
  v_dot2_f32_bf16 v140, v124, v124, v140
  v_dot2_f32_bf16 v137, v125, s84, v137
  v_dot2_f32_bf16 v141, v125, v125, v141
  v_dot2_f32_bf16 v138, v126, s84, v138
  v_dot2_f32_bf16 v142, v126, v126, v142
  v_dot2_f32_bf16 v139, v127, s84, v139
  v_dot2_f32_bf16 v143, v127, v127, v143
  v_dot2_f32_bf16 v136, v128, s84, v136
  v_dot2_f32_bf16 v140, v128, v128, v140
  v_dot2_f32_bf16 v137, v129, s84, v137
  v_dot2_f32_bf16 v141, v129, v129, v141
  v_dot2_f32_bf16 v138, v130, s84, v138
  v_dot2_f32_bf16 v142, v130, v130, v142
  v_dot2_f32_bf16 v139, v131, s84, v139
  v_dot2_f32_bf16 v143, v131, v131, v143
  v_dot2_f32_bf16 v136, v132, s84, v136
  v_dot2_f32_bf16 v140, v132, v132, v140
  v_dot2_f32_bf16 v137, v133, s84, v137
  v_dot2_f32_bf16 v141, v133, v133, v141
  v_dot2_f32_bf16 v138, v134, s84, v138
  v_dot2_f32_bf16 v142, v134, v134, v142
  v_dot2_f32_bf16 v139, v135, s84, v139
  v_dot2_f32_bf16 v143, v135, v135, v143
  v_add_f32 v136, v136, v137
  s_nop 0
  v_add_f32 v138, v138, v139
  v_add_f32 v140, v140, v141
  v_add_f32 v142, v142, v143
  v_add_f32 v136, v136, v138
  v_add_f32 v140, v140, v142
  s_nop 0
  v_add_f32_dpp v136, v136, v136 quad_perm:[1,0,3,2] row_mask:0xf bank_mask:0xf
  v_add_f32_dpp v140, v140, v140 quad_perm:[1,0,3,2] row_mask:0xf bank_mask:0xf
  s_nop 0
  v_add_f32_dpp v136, v136, v136 quad_perm:[2,3,0,1] row_mask:0xf bank_mask:0xf
  v_add_f32_dpp v140, v140, v140 quad_perm:[2,3,0,1] row_mask:0xf bank_mask:0xf
  v_mul_f32 v136, 0x3ae38e39, v136
  v_mul_f32 v140, 0x3ae38e39, v140
  v_fma_f32 v140, -v136, v136, v140
  v_max_f32 v140, 0, v140
  v_add_f32 v141, 0x3727c5ac, v140
  v_rsq_f32 v141, v141
  s_nop 0
  v_mul_f32 v142, v141, v141
  v_mul_f32 v142, v142, v140
  v_add_f32 v142, 0x3727c5ac, v142
  v_rsq_f32 v143, v142
  s_nop 0
  v_mul_f32 v137, v142, v143
  v_mul_f32 v138, v141, v143
  v_mul_f32 v137, 0x40088e99, v137
  v_mul_f32 v138, 0x3eeff558, v138
  v_mov_b32 v139, v138
  v_mul_f32 v140, -v136, v138
  v_mov_b32 v141, v140
  s_waitcnt vmcnt(2)
  ds_read_b64_tr_b16 v[144:145], v17 offset:0
  ds_read_b64_tr_b16 v[146:147], v17 offset:512
  ds_read_b64_tr_b16 v[148:149], v17 offset:32
  ds_read_b64_tr_b16 v[150:151], v17 offset:544
  ds_read_b64_tr_b16 v[152:153], v17 offset:64
  ds_read_b64_tr_b16 v[154:155], v17 offset:576
  ds_read_b64_tr_b16 v[156:157], v17 offset:96
  ds_read_b64_tr_b16 v[158:159], v17 offset:608
  s_waitcnt lgkmcnt(6)
  buffer_store_dwordx4 v[144:147], v1, s[32:35], s94 offen sc1
  s_waitcnt lgkmcnt(4)
  s_add_u32 s94, s94, 433152
  buffer_store_dwordx4 v[148:151], v1, s[32:35], s94 offen sc1
  s_waitcnt lgkmcnt(2)
  s_add_u32 s94, s94, 433152
  buffer_store_dwordx4 v[152:155], v1, s[32:35], s94 offen sc1
  s_waitcnt lgkmcnt(0)
  s_add_u32 s94, s94, 433152
  buffer_store_dwordx4 v[156:159], v1, s[32:35], s94 offen sc1
  s_mul_i32 s72, s26, 12288
  s_add_u32 s72, s72, 28672
  s_mov_b32 m0, s72
  s_add_u32 s72, s72, 1024
  buffer_load_dwordx4 v13, s[36:39], 0 offen lds
  s_mov_b32 m0, s72
  s_add_u32 s72, s72, 1024
  buffer_load_dwordx4 v14, s[36:39], 0 offen lds
  s_mov_b32 m0, s72
  s_add_u32 s72, s72, 1024
  buffer_load_dwordx4 v15, s[36:39], 0 offen lds
  s_mov_b32 m0, s72
  s_add_u32 s72, s72, 1024
  buffer_load_dwordx4 v16, s[36:39], 0 offen lds
  s_mul_i32 s56, s27, 1152
  s_add_u32 s48, s14, s56
  s_addc_u32 s49, s15, 0
  s_mov_b32 s50, 1152
  s_mov_b32 s51, 0x20000
  v_lshlrev_b32 v24, 2, v0
  buffer_load_dword v22, v24, s[48:51], 0 offen
  buffer_load_dword v23, v24, s[48:51], 0 offen offset:1024
  s_mov_b32 s56, 0xffff0000
  s_lshl_b32 s57, s26, 10
  s_add_u32 s57, s57, 86016
  v_add_u32 v20, s57, v30
  v_add_u32 v21, 0x10000, v20
  v_lshlrev_b32 v160, 16, v64
  v_and_b32 v161, s56, v64
  v_pk_fma_f32 v[160:161], v[160:161], v[138:139], v[140:141]
  v_cvt_pk_bf16_f32 v64, v160, v161
  v_lshlrev_b32 v162, 16, v65
  v_and_b32 v163, s56, v65
  v_pk_fma_f32 v[162:163], v[162:163], v[138:139], v[140:141]
  v_cvt_pk_bf16_f32 v65, v162, v163
  v_lshlrev_b32 v164, 16, v66
  v_and_b32 v165, s56, v66
  v_pk_fma_f32 v[164:165], v[164:165], v[138:139], v[140:141]
  v_cvt_pk_bf16_f32 v66, v164, v165
  v_lshlrev_b32 v166, 16, v67
  v_and_b32 v167, s56, v67
  v_pk_fma_f32 v[166:167], v[166:167], v[138:139], v[140:141]
  v_cvt_pk_bf16_f32 v67, v166, v167
  ds_write_b128 v20, v[64:67] offset:0
  v_lshlrev_b32 v160, 16, v68
  v_and_b32 v161, s56, v68
  v_pk_fma_f32 v[160:161], v[160:161], v[138:139], v[140:141]
  v_cvt_pk_bf16_f32 v68, v160, v161
  v_lshlrev_b32 v162, 16, v69
  v_and_b32 v163, s56, v69
  v_pk_fma_f32 v[162:163], v[162:163], v[138:139], v[140:141]
  v_cvt_pk_bf16_f32 v69, v162, v163
  v_lshlrev_b32 v164, 16, v70
  v_and_b32 v165, s56, v70
  v_pk_fma_f32 v[164:165], v[164:165], v[138:139], v[140:141]
  v_cvt_pk_bf16_f32 v70, v164, v165
  v_lshlrev_b32 v166, 16, v71
  v_and_b32 v167, s56, v71
  v_pk_fma_f32 v[166:167], v[166:167], v[138:139], v[140:141]
  v_cvt_pk_bf16_f32 v71, v166, v167
  ds_write_b128 v20, v[68:71] offset:4096
  v_lshlrev_b32 v160, 16, v72
  v_and_b32 v161, s56, v72
  v_pk_fma_f32 v[160:161], v[160:161], v[138:139], v[140:141]
  v_cvt_pk_bf16_f32 v72, v160, v161
  v_lshlrev_b32 v162, 16, v73
  v_and_b32 v163, s56, v73
  v_pk_fma_f32 v[162:163], v[162:163], v[138:139], v[140:141]
  v_cvt_pk_bf16_f32 v73, v162, v163
  v_lshlrev_b32 v164, 16, v74
  v_and_b32 v165, s56, v74
  v_pk_fma_f32 v[164:165], v[164:165], v[138:139], v[140:141]
  v_cvt_pk_bf16_f32 v74, v164, v165
  v_lshlrev_b32 v166, 16, v75
  v_and_b32 v167, s56, v75
  v_pk_fma_f32 v[166:167], v[166:167], v[138:139], v[140:141]
  v_cvt_pk_bf16_f32 v75, v166, v167
  ds_write_b128 v20, v[72:75] offset:8192
  v_lshlrev_b32 v160, 16, v76
  v_and_b32 v161, s56, v76
  v_pk_fma_f32 v[160:161], v[160:161], v[138:139], v[140:141]
  v_cvt_pk_bf16_f32 v76, v160, v161
  v_lshlrev_b32 v162, 16, v77
  v_and_b32 v163, s56, v77
  v_pk_fma_f32 v[162:163], v[162:163], v[138:139], v[140:141]
  v_cvt_pk_bf16_f32 v77, v162, v163
  v_lshlrev_b32 v164, 16, v78
  v_and_b32 v165, s56, v78
  v_pk_fma_f32 v[164:165], v[164:165], v[138:139], v[140:141]
  v_cvt_pk_bf16_f32 v78, v164, v165
  v_lshlrev_b32 v166, 16, v79
  v_and_b32 v167, s56, v79
  v_pk_fma_f32 v[166:167], v[166:167], v[138:139], v[140:141]
  v_cvt_pk_bf16_f32 v79, v166, v167
  ds_write_b128 v20, v[76:79] offset:12288
  v_lshlrev_b32 v160, 16, v80
  v_and_b32 v161, s56, v80
  v_pk_fma_f32 v[160:161], v[160:161], v[138:139], v[140:141]
  v_cvt_pk_bf16_f32 v80, v160, v161
  v_lshlrev_b32 v162, 16, v81
  v_and_b32 v163, s56, v81
  v_pk_fma_f32 v[162:163], v[162:163], v[138:139], v[140:141]
  v_cvt_pk_bf16_f32 v81, v162, v163
  v_lshlrev_b32 v164, 16, v82
  v_and_b32 v165, s56, v82
  v_pk_fma_f32 v[164:165], v[164:165], v[138:139], v[140:141]
  v_cvt_pk_bf16_f32 v82, v164, v165
  v_lshlrev_b32 v166, 16, v83
  v_and_b32 v167, s56, v83
  v_pk_fma_f32 v[166:167], v[166:167], v[138:139], v[140:141]
  v_cvt_pk_bf16_f32 v83, v166, v167
  ds_write_b128 v20, v[80:83] offset:16384
  v_lshlrev_b32 v160, 16, v84
  v_and_b32 v161, s56, v84
  v_pk_fma_f32 v[160:161], v[160:161], v[138:139], v[140:141]
  v_cvt_pk_bf16_f32 v84, v160, v161
  v_lshlrev_b32 v162, 16, v85
  v_and_b32 v163, s56, v85
  v_pk_fma_f32 v[162:163], v[162:163], v[138:139], v[140:141]
  v_cvt_pk_bf16_f32 v85, v162, v163
  v_lshlrev_b32 v164, 16, v86
  v_and_b32 v165, s56, v86
  v_pk_fma_f32 v[164:165], v[164:165], v[138:139], v[140:141]
  v_cvt_pk_bf16_f32 v86, v164, v165
  v_lshlrev_b32 v166, 16, v87
  v_and_b32 v167, s56, v87
  v_pk_fma_f32 v[166:167], v[166:167], v[138:139], v[140:141]
  v_cvt_pk_bf16_f32 v87, v166, v167
  ds_write_b128 v20, v[84:87] offset:20480
  v_lshlrev_b32 v160, 16, v88
  v_and_b32 v161, s56, v88
  v_pk_fma_f32 v[160:161], v[160:161], v[138:139], v[140:141]
  v_cvt_pk_bf16_f32 v88, v160, v161
  v_lshlrev_b32 v162, 16, v89
  v_and_b32 v163, s56, v89
  v_pk_fma_f32 v[162:163], v[162:163], v[138:139], v[140:141]
  v_cvt_pk_bf16_f32 v89, v162, v163
  v_lshlrev_b32 v164, 16, v90
  v_and_b32 v165, s56, v90
  v_pk_fma_f32 v[164:165], v[164:165], v[138:139], v[140:141]
  v_cvt_pk_bf16_f32 v90, v164, v165
  v_lshlrev_b32 v166, 16, v91
  v_and_b32 v167, s56, v91
  v_pk_fma_f32 v[166:167], v[166:167], v[138:139], v[140:141]
  v_cvt_pk_bf16_f32 v91, v166, v167
  ds_write_b128 v20, v[88:91] offset:24576
  v_lshlrev_b32 v160, 16, v92
  v_and_b32 v161, s56, v92
  v_pk_fma_f32 v[160:161], v[160:161], v[138:139], v[140:141]
  v_cvt_pk_bf16_f32 v92, v160, v161
  v_lshlrev_b32 v162, 16, v93
  v_and_b32 v163, s56, v93
  v_pk_fma_f32 v[162:163], v[162:163], v[138:139], v[140:141]
  v_cvt_pk_bf16_f32 v93, v162, v163
  v_lshlrev_b32 v164, 16, v94
  v_and_b32 v165, s56, v94
  v_pk_fma_f32 v[164:165], v[164:165], v[138:139], v[140:141]
  v_cvt_pk_bf16_f32 v94, v164, v165
  v_lshlrev_b32 v166, 16, v95
  v_and_b32 v167, s56, v95
  v_pk_fma_f32 v[166:167], v[166:167], v[138:139], v[140:141]
  v_cvt_pk_bf16_f32 v95, v166, v167
  ds_write_b128 v20, v[92:95] offset:28672
  v_lshlrev_b32 v160, 16, v96
  v_and_b32 v161, s56, v96
  v_pk_fma_f32 v[160:161], v[160:161], v[138:139], v[140:141]
  v_cvt_pk_bf16_f32 v96, v160, v161
  v_lshlrev_b32 v162, 16, v97
  v_and_b32 v163, s56, v97
  v_pk_fma_f32 v[162:163], v[162:163], v[138:139], v[140:141]
  v_cvt_pk_bf16_f32 v97, v162, v163
  v_lshlrev_b32 v164, 16, v98
  v_and_b32 v165, s56, v98
  v_pk_fma_f32 v[164:165], v[164:165], v[138:139], v[140:141]
  v_cvt_pk_bf16_f32 v98, v164, v165
  v_lshlrev_b32 v166, 16, v99
  v_and_b32 v167, s56, v99
  v_pk_fma_f32 v[166:167], v[166:167], v[138:139], v[140:141]
  v_cvt_pk_bf16_f32 v99, v166, v167
  ds_write_b128 v20, v[96:99] offset:32768
  v_lshlrev_b32 v160, 16, v100
  v_and_b32 v161, s56, v100
  v_pk_fma_f32 v[160:161], v[160:161], v[138:139], v[140:141]
  v_cvt_pk_bf16_f32 v100, v160, v161
  v_lshlrev_b32 v162, 16, v101
  v_and_b32 v163, s56, v101
  v_pk_fma_f32 v[162:163], v[162:163], v[138:139], v[140:141]
  v_cvt_pk_bf16_f32 v101, v162, v163
  v_lshlrev_b32 v164, 16, v102
  v_and_b32 v165, s56, v102
  v_pk_fma_f32 v[164:165], v[164:165], v[138:139], v[140:141]
  v_cvt_pk_bf16_f32 v102, v164, v165
  v_lshlrev_b32 v166, 16, v103
  v_and_b32 v167, s56, v103
  v_pk_fma_f32 v[166:167], v[166:167], v[138:139], v[140:141]
  v_cvt_pk_bf16_f32 v103, v166, v167
  ds_write_b128 v20, v[100:103] offset:36864
  v_lshlrev_b32 v160, 16, v104
  v_and_b32 v161, s56, v104
  v_pk_fma_f32 v[160:161], v[160:161], v[138:139], v[140:141]
  v_cvt_pk_bf16_f32 v104, v160, v161
  v_lshlrev_b32 v162, 16, v105
  v_and_b32 v163, s56, v105
  v_pk_fma_f32 v[162:163], v[162:163], v[138:139], v[140:141]
  v_cvt_pk_bf16_f32 v105, v162, v163
  v_lshlrev_b32 v164, 16, v106
  v_and_b32 v165, s56, v106
  v_pk_fma_f32 v[164:165], v[164:165], v[138:139], v[140:141]
  v_cvt_pk_bf16_f32 v106, v164, v165
  v_lshlrev_b32 v166, 16, v107
  v_and_b32 v167, s56, v107
  v_pk_fma_f32 v[166:167], v[166:167], v[138:139], v[140:141]
  v_cvt_pk_bf16_f32 v107, v166, v167
  ds_write_b128 v20, v[104:107] offset:40960
  v_lshlrev_b32 v160, 16, v108
  v_and_b32 v161, s56, v108
  v_pk_fma_f32 v[160:161], v[160:161], v[138:139], v[140:141]
  v_cvt_pk_bf16_f32 v108, v160, v161
  v_lshlrev_b32 v162, 16, v109
  v_and_b32 v163, s56, v109
  v_pk_fma_f32 v[162:163], v[162:163], v[138:139], v[140:141]
  v_cvt_pk_bf16_f32 v109, v162, v163
  v_lshlrev_b32 v164, 16, v110
  v_and_b32 v165, s56, v110
  v_pk_fma_f32 v[164:165], v[164:165], v[138:139], v[140:141]
  v_cvt_pk_bf16_f32 v110, v164, v165
  v_lshlrev_b32 v166, 16, v111
  v_and_b32 v167, s56, v111
  v_pk_fma_f32 v[166:167], v[166:167], v[138:139], v[140:141]
  v_cvt_pk_bf16_f32 v111, v166, v167
  ds_write_b128 v20, v[108:111] offset:45056
  v_lshlrev_b32 v160, 16, v112
  v_and_b32 v161, s56, v112
  v_pk_fma_f32 v[160:161], v[160:161], v[138:139], v[140:141]
  v_cvt_pk_bf16_f32 v112, v160, v161
  v_lshlrev_b32 v162, 16, v113
  v_and_b32 v163, s56, v113
  v_pk_fma_f32 v[162:163], v[162:163], v[138:139], v[140:141]
  v_cvt_pk_bf16_f32 v113, v162, v163
  v_lshlrev_b32 v164, 16, v114
  v_and_b32 v165, s56, v114
  v_pk_fma_f32 v[164:165], v[164:165], v[138:139], v[140:141]
  v_cvt_pk_bf16_f32 v114, v164, v165
  v_lshlrev_b32 v166, 16, v115
  v_and_b32 v167, s56, v115
  v_pk_fma_f32 v[166:167], v[166:167], v[138:139], v[140:141]
  v_cvt_pk_bf16_f32 v115, v166, v167
  ds_write_b128 v20, v[112:115] offset:49152
  v_lshlrev_b32 v160, 16, v116
  v_and_b32 v161, s56, v116
  v_pk_fma_f32 v[160:161], v[160:161], v[138:139], v[140:141]
  v_cvt_pk_bf16_f32 v116, v160, v161
  v_lshlrev_b32 v162, 16, v117
  v_and_b32 v163, s56, v117
  v_pk_fma_f32 v[162:163], v[162:163], v[138:139], v[140:141]
  v_cvt_pk_bf16_f32 v117, v162, v163
  v_lshlrev_b32 v164, 16, v118
  v_and_b32 v165, s56, v118
  v_pk_fma_f32 v[164:165], v[164:165], v[138:139], v[140:141]
  v_cvt_pk_bf16_f32 v118, v164, v165
  v_lshlrev_b32 v166, 16, v119
  v_and_b32 v167, s56, v119
  v_pk_fma_f32 v[166:167], v[166:167], v[138:139], v[140:141]
  v_cvt_pk_bf16_f32 v119, v166, v167
  ds_write_b128 v20, v[116:119] offset:53248
  v_lshlrev_b32 v160, 16, v120
  v_and_b32 v161, s56, v120
  v_pk_fma_f32 v[160:161], v[160:161], v[138:139], v[140:141]
  v_cvt_pk_bf16_f32 v120, v160, v161
  v_lshlrev_b32 v162, 16, v121
  v_and_b32 v163, s56, v121
  v_pk_fma_f32 v[162:163], v[162:163], v[138:139], v[140:141]
  v_cvt_pk_bf16_f32 v121, v162, v163
  v_lshlrev_b32 v164, 16, v122
  v_and_b32 v165, s56, v122
  v_pk_fma_f32 v[164:165], v[164:165], v[138:139], v[140:141]
  v_cvt_pk_bf16_f32 v122, v164, v165
  v_lshlrev_b32 v166, 16, v123
  v_and_b32 v167, s56, v123
  v_pk_fma_f32 v[166:167], v[166:167], v[138:139], v[140:141]
  v_cvt_pk_bf16_f32 v123, v166, v167
  ds_write_b128 v20, v[120:123] offset:57344
  v_lshlrev_b32 v160, 16, v124
  v_and_b32 v161, s56, v124
  v_pk_fma_f32 v[160:161], v[160:161], v[138:139], v[140:141]
  v_cvt_pk_bf16_f32 v124, v160, v161
  v_lshlrev_b32 v162, 16, v125
  v_and_b32 v163, s56, v125
  v_pk_fma_f32 v[162:163], v[162:163], v[138:139], v[140:141]
  v_cvt_pk_bf16_f32 v125, v162, v163
  v_lshlrev_b32 v164, 16, v126
  v_and_b32 v165, s56, v126
  v_pk_fma_f32 v[164:165], v[164:165], v[138:139], v[140:141]
  v_cvt_pk_bf16_f32 v126, v164, v165
  v_lshlrev_b32 v166, 16, v127
  v_and_b32 v167, s56, v127
  v_pk_fma_f32 v[166:167], v[166:167], v[138:139], v[140:141]
  v_cvt_pk_bf16_f32 v127, v166, v167
  ds_write_b128 v20, v[124:127] offset:61440
  v_lshlrev_b32 v160, 16, v128
  v_and_b32 v161, s56, v128
  v_pk_fma_f32 v[160:161], v[160:161], v[138:139], v[140:141]
  v_cvt_pk_bf16_f32 v128, v160, v161
  s_waitcnt vmcnt(10)
  v_readfirstlane_b32 s29, v28
  s_nop 0
  s_mul_i32 s29, s29, 1664525
  s_add_u32 s29, s29, 1013904223
  s_waitcnt vmcnt(6)
  s_barrier
  s_add_u32 s56, s85, 35913728
  s_cmp_eq_u32 s26, 0
  s_cselect_b32 s56, s56, 1879048192
  v_mov_b32 v172, s29
  v_mov_b32 v173, 0
  s_mov_b64 exec, 1
  buffer_store_dword v172, v173, s[32:35], s56 offen sc1
  s_mov_b64 exec, -1
  s_mov_b32 s56, 0xffff0000
  v_lshlrev_b32 v162, 16, v129
  v_and_b32 v163, s56, v129
  v_pk_fma_f32 v[162:163], v[162:163], v[138:139], v[140:141]
  v_cvt_pk_bf16_f32 v129, v162, v163
  v_lshlrev_b32 v164, 16, v130
  v_and_b32 v165, s56, v130
  v_pk_fma_f32 v[164:165], v[164:165], v[138:139], v[140:141]
  v_cvt_pk_bf16_f32 v130, v164, v165
  v_lshlrev_b32 v166, 16, v131
  v_and_b32 v167, s56, v131
  v_pk_fma_f32 v[166:167], v[166:167], v[138:139], v[140:141]
  v_cvt_pk_bf16_f32 v131, v166, v167
  ds_write_b128 v21, v[128:131] offset:0
  v_lshlrev_b32 v160, 16, v132
  v_and_b32 v161, s56, v132
  v_pk_fma_f32 v[160:161], v[160:161], v[138:139], v[140:141]
  v_cvt_pk_bf16_f32 v132, v160, v161
  v_lshlrev_b32 v162, 16, v133
  v_and_b32 v163, s56, v133
  v_pk_fma_f32 v[162:163], v[162:163], v[138:139], v[140:141]
  v_cvt_pk_bf16_f32 v133, v162, v163
  v_lshlrev_b32 v164, 16, v134
  v_and_b32 v165, s56, v134
  v_pk_fma_f32 v[164:165], v[164:165], v[138:139], v[140:141]
  v_cvt_pk_bf16_f32 v134, v164, v165
  v_lshlrev_b32 v166, 16, v135
  v_and_b32 v167, s56, v135
  v_pk_fma_f32 v[166:167], v[166:167], v[138:139], v[140:141]
  v_cvt_pk_bf16_f32 v135, v166, v167
  ds_write_b128 v21, v[132:135] offset:4096
  s_lshl_b32 s56, s26, 6
  s_add_u32 s56, s56, 162048
  v_lshlrev_b32 v20, 2, v29
  v_add_u32 v20, s56, v20
  ds_write_b32 v20, v137
  s_lshl_b32 s52, s27, 12
  s_add_u32 s52, s52, 35913728
  v_lshlrev_b32 v28, 3, v1
  v_and_b32 v28, 0xf80, v28
  buffer_load_dword v26, v28, s[32:35], s52 offen sc1
  s_waitcnt lgkmcnt(0)
  s_barrier
  s_waitcnt vmcnt(0)
  s_cmp_eq_u32 s26, 0
  s_cbranch_scc0 Lok_1
  s_mov_b32 s53, 200000
Lsp_2:
  v_cmp_ne_u32 vcc, s29, v26
  s_nop 1
  s_cmp_eq_u64 vcc, 0
  s_cbranch_scc1 Lok_1
  s_sub_u32 s53, s53, 1
  s_cbranch_scc1 Lok_1
  s_sleep 2
  s_lshl_b32 s52, s27, 12
  s_add_u32 s52, s52, 35913728
  buffer_load_dword v26, v28, s[32:35], s52 offen sc1
  s_waitcnt vmcnt(0)
  s_branch Lsp_2
Lok_1:
  s_barrier
  s_lshl_b32 s80, s27, 2
  s_add_u32 s80, s80, s26
  s_mul_i32 s80, s80, 433152
  buffer_load_dwordx4 v[176:179], v1, s[32:35], s80 offen offset:0 sc1
  buffer_load_dwordx4 v[180:183], v1, s[32:35], s80 offen offset:1024 sc1
  buffer_load_dwordx4 v[184:187], v1, s[32:35], s80 offen offset:2048 sc1
  buffer_load_dwordx4 v[188:191], v1, s[32:35], s80 offen offset:3072 sc1
  s_add_u32 s80, s80, 4096
  buffer_load_dwordx4 v[192:195], v1, s[32:35], s80 offen offset:0 sc1
  buffer_load_dwordx4 v[196:199], v1, s[32:35], s80 offen offset:1024 sc1
  buffer_load_dwordx4 v[200:203], v1, s[32:35], s80 offen offset:2048 sc1
  buffer_load_dwordx4 v[204:207], v1, s[32:35], s80 offen offset:3072 sc1
  s_add_u32 s80, s80, 4096
  buffer_load_dwordx4 v[208:211], v1, s[32:35], s80 offen offset:0 sc1
  buffer_load_dwordx4 v[212:215], v1, s[32:35], s80 offen offset:1024 sc1
  buffer_load_dwordx4 v[64:67], v1, s[32:35], s80 offen offset:2048 sc1
  buffer_load_dwordx4 v[68:71], v1, s[32:35], s80 offen offset:3072 sc1
  s_mov_b32 s83, 0x3fb8aa3b
  v_lshlrev_b32 v20, 4, v3
  v_add_u32 v20, 162048, v20
  ds_read_b128 v[152:155], v20 offset:0
  ds_read_b128 v[156:159], v20 offset:64
  ds_read_b128 v[160:163], v20 offset:128
  ds_read_b128 v[164:167], v20 offset:192
  v_lshlrev_b32 v20, 1, v3
  v_xor_b32 v20, v2, v20
  v_lshl_add_u32 v20, v3, 4, v20
  v_lshlrev_b32 v20, 4, v20
  v_add_u32 v20, 86016, v20
  v_add_u32 v21, 0x10000, v20
  ds_read_b128 a[0:3], v20 offset:0
  ds_read_b128 a[4:7], v20 offset:1024
  ds_read_b128 a[8:11], v20 offset:2048
  ds_read_b128 a[12:15], v20 offset:3072
  ds_read_b128 a[16:19], v20 offset:4096
  ds_read_b128 a[20:23], v20 offset:5120
  ds_read_b128 a[24:27], v20 offset:6144
  ds_read_b128 a[28:31], v20 offset:7168
  ds_read_b128 a[32:35], v20 offset:8192
  ds_read_b128 a[36:39], v20 offset:9216
  ds_read_b128 a[40:43], v20 offset:10240
  ds_read_b128 a[44:47], v20 offset:11264
  s_add_u32 s80, s80, 4096
  buffer_load_dwordx4 v[72:75], v1, s[32:35], s80 offen offset:0 sc1
  buffer_load_dwordx4 v[76:79], v1, s[32:35], s80 offen offset:1024 sc1
  buffer_load_dwordx4 v[80:83], v1, s[32:35], s80 offen offset:2048 sc1
  buffer_load_dwordx4 v[84:87], v1, s[32:35], s80 offen offset:3072 sc1
  ds_read_b128 a[48:51], v20 offset:12288
  ds_read_b128 a[52:55], v20 offset:13312
  ds_read_b128 a[56:59], v20 offset:14336
  ds_read_b128 a[60:63], v20 offset:15360
  s_waitcnt lgkmcnt(12)
  s_waitcnt vmcnt(15)
  v_mfma_f32_16x16x32_bf16 v[32:35], a[0:3], v[176:179], 0
  v_mfma_f32_16x16x32_bf16 v[36:39], a[4:7], v[176:179], 0
  v_mfma_f32_16x16x32_bf16 v[40:43], a[8:11], v[176:179], 0
  v_mfma_f32_16x16x32_bf16 v[44:47], a[12:15], v[176:179], 0
  s_add_u32 s80, s80, 4096
  buffer_load_dwordx4 v[176:179], v1, s[32:35], s80 offen offset:0 sc1
  buffer_load_dwordx4 v[88:91], v1, s[32:35], s80 offen offset:1024 sc1
  buffer_load_dwordx4 v[92:95], v1, s[32:35], s80 offen offset:2048 sc1
  ds_read_b128 a[64:67], v20 offset:16384
  ds_read_b128 a[68:71], v20 offset:17408
  ds_read_b128 a[72:75], v20 offset:18432
  ds_read_b128 a[76:79], v20 offset:19456
  s_waitcnt lgkmcnt(12)
  s_waitcnt vmcnt(17)
  v_mfma_f32_16x16x32_bf16 v[32:35], a[16:19], v[180:183], v[32:35]
  v_mfma_f32_16x16x32_bf16 v[36:39], a[20:23], v[180:183], v[36:39]
  v_mfma_f32_16x16x32_bf16 v[40:43], a[24:27], v[180:183], v[40:43]
  v_mfma_f32_16x16x32_bf16 v[44:47], a[28:31], v[180:183], v[44:47]
  buffer_load_dwordx4 v[180:183], v1, s[32:35], s80 offen offset:3072 sc1
  s_add_u32 s80, s80, 4096
  buffer_load_dwordx4 v[96:99], v1, s[32:35], s80 offen offset:0 sc1
  buffer_load_dwordx4 v[100:103], v1, s[32:35], s80 offen offset:1024 sc1
  ds_read_b128 a[80:83], v20 offset:20480
  ds_read_b128 a[84:87], v20 offset:21504
  ds_read_b128 a[88:91], v20 offset:22528
  ds_read_b128 a[92:95], v20 offset:23552
  s_waitcnt lgkmcnt(12)
  s_waitcnt vmcnt(19)
  v_mfma_f32_16x16x32_bf16 v[32:35], a[32:35], v[184:187], v[32:35]
  v_mfma_f32_16x16x32_bf16 v[36:39], a[36:39], v[184:187], v[36:39]
  v_mfma_f32_16x16x32_bf16 v[40:43], a[40:43], v[184:187], v[40:43]
  v_mfma_f32_16x16x32_bf16 v[44:47], a[44:47], v[184:187], v[44:47]
  buffer_load_dwordx4 v[184:187], v1, s[32:35], s80 offen offset:2048 sc1
  buffer_load_dwordx4 v[104:107], v1, s[32:35], s80 offen offset:3072 sc1
  s_add_u32 s80, s80, 4096
  buffer_load_dwordx4 v[108:111], v1, s[32:35], s80 offen offset:0 sc1
  ds_read_b128 a[96:99], v20 offset:24576
  ds_read_b128 a[100:103], v20 offset:25600
  ds_read_b128 a[104:107], v20 offset:26624
  ds_read_b128 a[108:111], v20 offset:27648
  s_waitcnt lgkmcnt(12)
  s_waitcnt vmcnt(21)
  v_mfma_f32_16x16x32_bf16 v[32:35], a[48:51], v[188:191], v[32:35]
  v_mfma_f32_16x16x32_bf16 v[36:39], a[52:55], v[188:191], v[36:39]
  v_mfma_f32_16x16x32_bf16 v[40:43], a[56:59], v[188:191], v[40:43]
  v_mfma_f32_16x16x32_bf16 v[44:47], a[60:63], v[188:191], v[44:47]
  buffer_load_dwordx4 v[188:191], v1, s[32:35], s80 offen offset:1024 sc1
  buffer_load_dwordx4 v[112:115], v1, s[32:35], s80 offen offset:2048 sc1
  buffer_load_dwordx4 v[116:119], v1, s[32:35], s80 offen offset:3072 sc1
  ds_read_b128 a[112:115], v20 offset:28672
  ds_read_b128 a[116:119], v20 offset:29696
  ds_read_b128 a[120:123], v20 offset:30720
  ds_read_b128 a[124:127], v20 offset:31744
  s_waitcnt lgkmcnt(12)
  s_waitcnt vmcnt(23)
  v_mfma_f32_16x16x32_bf16 v[32:35], a[64:67], v[192:195], v[32:35]
  v_mfma_f32_16x16x32_bf16 v[36:39], a[68:71], v[192:195], v[36:39]
  v_mfma_f32_16x16x32_bf16 v[40:43], a[72:75], v[192:195], v[40:43]
  v_mfma_f32_16x16x32_bf16 v[44:47], a[76:79], v[192:195], v[44:47]
  s_add_u32 s80, s80, 4096
  buffer_load_dwordx4 v[192:195], v1, s[32:35], s80 offen offset:0 sc1
  buffer_load_dwordx4 v[120:123], v1, s[32:35], s80 offen offset:1024 sc1
  buffer_load_dwordx4 v[124:127], v1, s[32:35], s80 offen offset:2048 sc1
  ds_read_b128 a[128:131], v20 offset:32768
  ds_read_b128 a[132:135], v20 offset:33792
  ds_read_b128 a[136:139], v20 offset:34816
  ds_read_b128 a[140:143], v20 offset:35840
  s_waitcnt lgkmcnt(12)
  s_waitcnt vmcnt(25)
  v_mfma_f32_16x16x32_bf16 v[32:35], a[80:83], v[196:199], v[32:35]
  v_mfma_f32_16x16x32_bf16 v[36:39], a[84:87], v[196:199], v[36:39]
  v_mfma_f32_16x16x32_bf16 v[40:43], a[88:91], v[196:199], v[40:43]
  v_mfma_f32_16x16x32_bf16 v[44:47], a[92:95], v[196:199], v[44:47]
  buffer_load_dwordx4 v[196:199], v1, s[32:35], s80 offen offset:3072 sc1
  s_add_u32 s80, s80, 4096
  buffer_load_dwordx4 v[128:131], v1, s[32:35], s80 offen offset:0 sc1
  buffer_load_dwordx4 v[132:135], v1, s[32:35], s80 offen offset:1024 sc1
  ds_read_b128 a[144:147], v20 offset:36864
  ds_read_b128 a[148:151], v20 offset:37888
  ds_read_b128 a[152:155], v20 offset:38912
  ds_read_b128 a[156:159], v20 offset:39936
  s_waitcnt lgkmcnt(12)
  s_waitcnt vmcnt(27)
  v_mfma_f32_16x16x32_bf16 v[32:35], a[96:99], v[200:203], v[32:35]
  v_mfma_f32_16x16x32_bf16 v[36:39], a[100:103], v[200:203], v[36:39]
  ds_read_b64_tr_b16 v[144:145], v17 offset:4096
  ds_read_b64_tr_b16 v[146:147], v17 offset:4608
  v_mfma_f32_16x16x32_bf16 v[40:43], a[104:107], v[200:203], v[40:43]
  v_mfma_f32_16x16x32_bf16 v[44:47], a[108:111], v[200:203], v[44:47]
  buffer_load_dwordx4 v[200:203], v1, s[32:35], s80 offen offset:2048 sc1
  buffer_load_dwordx4 v[136:139], v1, s[32:35], s80 offen offset:3072 sc1
  s_add_u32 s80, s80, 4096
  buffer_load_dwordx4 v[140:143], v1, s[32:35], s80 offen offset:0 sc1
  ds_read_b128 a[160:163], v20 offset:40960
  ds_read_b128 a[164:167], v20 offset:41984
  ds_read_b128 a[168:171], v20 offset:43008
  ds_read_b128 a[172:175], v20 offset:44032
  s_waitcnt lgkmcnt(14)
  s_waitcnt vmcnt(29)
  v_mfma_f32_16x16x32_bf16 v[32:35], a[112:115], v[204:207], v[32:35]
  v_mfma_f32_16x16x32_bf16 v[36:39], a[116:119], v[204:207], v[36:39]
  v_mfma_f32_16x16x32_bf16 v[40:43], a[120:123], v[204:207], v[40:43]
  s_waitcnt lgkmcnt(4)
  s_mov_b32 s57, s95
  buffer_store_dwordx4 v[144:147], v1, s[32:35], s57 offen sc1
  v_mfma_f32_16x16x32_bf16 v[44:47], a[124:127], v[204:207], v[44:47]
  buffer_load_dwordx4 v[204:207], v1, s[32:35], s80 offen offset:1024 sc1
  ds_read_b128 a[176:179], v20 offset:45056
  ds_read_b128 a[180:183], v20 offset:46080
  ds_read_b128 a[184:187], v20 offset:47104
  ds_read_b128 a[188:191], v20 offset:48128
  s_waitcnt vmcnt(30)
  v_mfma_f32_16x16x32_bf16 v[32:35], a[128:131], v[208:211], v[32:35]
  v_mfma_f32_16x16x32_bf16 v[36:39], a[132:135], v[208:211], v[36:39]
  v_mfma_f32_16x16x32_bf16 v[40:43], a[136:139], v[208:211], v[40:43]
  v_mfma_f32_16x16x32_bf16 v[44:47], a[140:143], v[208:211], v[44:47]
  buffer_load_dwordx4 v[208:211], v1, s[32:35], s80 offen offset:2048 sc1
  ds_read_b128 a[192:195], v20 offset:49152
  ds_read_b128 a[196:199], v20 offset:50176
  ds_read_b128 a[200:203], v20 offset:51200
  ds_read_b128 a[204:207], v20 offset:52224
  s_waitcnt vmcnt(30)
  v_mfma_f32_16x16x32_bf16 v[32:35], a[144:147], v[212:215], v[32:35]
  ds_read_b64_tr_b16 v[148:149], v17 offset:4128
  ds_read_b64_tr_b16 v[150:151], v17 offset:4640
  v_mfma_f32_16x16x32_bf16 v[36:39], a[148:151], v[212:215], v[36:39]
  v_mfma_f32_16x16x32_bf16 v[40:43], a[152:155], v[212:215], v[40:43]
  v_mfma_f32_16x16x32_bf16 v[44:47], a[156:159], v[212:215], v[44:47]
  buffer_load_dwordx4 v[212:215], v1, s[32:35], s80 offen offset:3072 sc1
  ds_read_b128 a[208:211], v20 offset:53248
  ds_read_b128 a[212:215], v20 offset:54272
  ds_read_b128 a[216:219], v20 offset:55296
  ds_read_b128 a[220:223], v20 offset:56320
  s_waitcnt lgkmcnt(14)
  s_waitcnt vmcnt(30)
  v_mfma_f32_16x16x32_bf16 v[32:35], a[160:163], v[64:67], v[32:35]
  v_mfma_f32_16x16x32_bf16 v[36:39], a[164:167], v[64:67], v[36:39]
  s_waitcnt lgkmcnt(4)
  s_add_u32 s57, s95, 433152
  buffer_store_dwordx4 v[148:151], v1, s[32:35], s57 offen sc1
  v_mfma_f32_16x16x32_bf16 v[40:43], a[168:171], v[64:67], v[40:43]
  v_mfma_f32_16x16x32_bf16 v[44:47], a[172:175], v[64:67], v[44:47]
  s_add_u32 s80, s80, 4096
  buffer_load_dwordx4 v[64:67], v1, s[32:35], s80 offen offset:0 sc1
  ds_read_b128 a[224:227], v20 offset:57344
  ds_read_b128 a[228:231], v20 offset:58368
  ds_read_b128 a[232:235], v20 offset:59392
  ds_read_b128 a[236:239], v20 offset:60416
  s_waitcnt vmcnt(31)
  v_mfma_f32_16x16x32_bf16 v[32:35], a[176:179], v[68:71], v[32:35]
  v_mfma_f32_16x16x32_bf16 v[36:39], a[180:183], v[68:71], v[36:39]
  v_mfma_f32_16x16x32_bf16 v[40:43], a[184:187], v[68:71], v[40:43]
  ds_read_b64_tr_b16 v[144:145], v17 offset:4160
  ds_read_b64_tr_b16 v[146:147], v17 offset:4672
  v_mfma_f32_16x16x32_bf16 v[44:47], a[188:191], v[68:71], v[44:47]
  buffer_load_dwordx4 v[68:71], v1, s[32:35], s80 offen offset:1024 sc1
  ds_read_b128 a[240:243], v20 offset:61440
  ds_read_b128 a[244:247], v20 offset:62464
  ds_read_b128 a[248:251], v20 offset:63488
  ds_read_b128 a[252:255], v20 offset:64512
  s_waitcnt vmcnt(31)
  v_mfma_f32_16x16x32_bf16 v[32:35], a[192:195], v[72:75], v[32:35]
  v_mfma_f32_16x16x32_bf16 v[36:39], a[196:199], v[72:75], v[36:39]
  v_mfma_f32_16x16x32_bf16 v[40:43], a[200:203], v[72:75], v[40:43]
  v_mfma_f32_16x16x32_bf16 v[44:47], a[204:207], v[72:75], v[44:47]
  buffer_load_dwordx4 v[72:75], v1, s[32:35], s80 offen offset:2048 sc1
  ds_read_b128 v[224:227], v21 offset:0
  ds_read_b128 v[228:231], v21 offset:1024
  ds_read_b128 v[232:235], v21 offset:2048
  ds_read_b128 v[236:239], v21 offset:3072
  s_waitcnt lgkmcnt(14)
  s_waitcnt vmcnt(31)
  v_mfma_f32_16x16x32_bf16 v[32:35], a[208:211], v[76:79], v[32:35]
  s_waitcnt lgkmcnt(8)
  s_add_u32 s57, s95, 866304
  buffer_store_dwordx4 v[144:147], v1, s[32:35], s57 offen sc1
  v_mfma_f32_16x16x32_bf16 v[36:39], a[212:215], v[76:79], v[36:39]
  v_mfma_f32_16x16x32_bf16 v[40:43], a[216:219], v[76:79], v[40:43]
  v_mfma_f32_16x16x32_bf16 v[44:47], a[220:223], v[76:79], v[44:47]
  buffer_load_dwordx4 v[76:79], v1, s[32:35], s80 offen offset:3072 sc1
  ds_read_b128 v[240:243], v21 offset:4096
  ds_read_b128 v[244:247], v21 offset:5120
  ds_read_b128 v[248:251], v21 offset:6144
  ds_read_b128 v[252:255], v21 offset:7168
  s_waitcnt vmcnt(32)
  v_mfma_f32_16x16x32_bf16 v[32:35], a[224:227], v[80:83], v[32:35]
  v_mfma_f32_16x16x32_bf16 v[36:39], a[228:231], v[80:83], v[36:39]
  ds_read_b64_tr_b16 v[148:149], v17 offset:4192
  ds_read_b64_tr_b16 v[150:151], v17 offset:4704
  v_mfma_f32_16x16x32_bf16 v[40:43], a[232:235], v[80:83], v[40:43]
  v_mfma_f32_16x16x32_bf16 v[44:47], a[236:239], v[80:83], v[44:47]
  s_add_u32 s80, s80, 4096
  buffer_load_dwordx4 v[80:83], v1, s[32:35], s80 offen offset:0 sc1
  s_waitcnt lgkmcnt(10)
  s_waitcnt vmcnt(32)
  v_mfma_f32_16x16x32_bf16 v[32:35], a[240:243], v[84:87], v[32:35]
  v_mfma_f32_16x16x32_bf16 v[36:39], a[244:247], v[84:87], v[36:39]
  v_mfma_f32_16x16x32_bf16 v[40:43], a[248:251], v[84:87], v[40:43]
  v_mfma_f32_16x16x32_bf16 v[44:47], a[252:255], v[84:87], v[44:47]
  buffer_load_dwordx4 v[84:87], v1, s[32:35], s80 offen offset:1024 sc1
  s_waitcnt lgkmcnt(6)
  s_waitcnt vmcnt(32)
  v_mfma_f32_16x16x32_bf16 v[32:35], v[224:227], v[176:179], v[32:35]
  s_waitcnt lgkmcnt(0)
  s_add_u32 s57, s95, 1299456
  buffer_store_dwordx4 v[148:151], v1, s[32:35], s57 offen sc1
  v_mfma_f32_16x16x32_bf16 v[36:39], v[228:231], v[176:179], v[36:39]
  v_mfma_f32_16x16x32_bf16 v[40:43], v[232:235], v[176:179], v[40:43]
  v_mfma_f32_16x16x32_bf16 v[44:47], v[236:239], v[176:179], v[44:47]
  buffer_load_dwordx4 v[176:179], v1, s[32:35], s80 offen offset:2048 sc1
  s_waitcnt vmcnt(33)
  v_mfma_f32_16x16x32_bf16 v[32:35], v[240:243], v[88:91], v[32:35]
  v_mfma_f32_16x16x32_bf16 v[36:39], v[244:247], v[88:91], v[36:39]
  v_mfma_f32_16x16x32_bf16 v[40:43], v[248:251], v[88:91], v[40:43]
  v_mfma_f32_16x16x32_bf16 v[44:47], v[252:255], v[88:91], v[44:47]
  buffer_load_dwordx4 v[88:91], v1, s[32:35], s80 offen offset:3072 sc1
  s_barrier
  s_waitcnt vmcnt(32)
  v_mfma_f32_16x16x32_bf16 v[48:51], a[0:3], v[92:95], 0
  v_mfma_f32_16x16x32_bf16 v[52:55], a[4:7], v[92:95], 0
  v_mfma_f32_16x16x32_bf16 v[56:59], a[8:11], v[92:95], 0
  v_mfma_f32_16x16x32_bf16 v[60:63], a[12:15], v[92:95], 0
  s_add_u32 s80, s80, 4096
  buffer_load_dwordx4 v[92:95], v1, s[32:35], s80 offen offset:0 sc1
  v_mfma_f32_16x16x32_bf16 v[48:51], a[16:19], v[180:183], v[48:51]
  v_mfma_f32_16x16x32_bf16 v[52:55], a[20:23], v[180:183], v[52:55]
  s_mov_b32 s56, s26
  s_lshl_b32 s57, s56, 4
  v_add_u32 v27, s57, v2
  v_cmp_gt_u32 vcc, 72, v27
  v_mov_b32 v28, 0x358637bd
  v_mov_b32 v29, 0xff7fffff
  v_mov_b32 v27, 0x358637bd
  v_cndmask_b32 v28, 0, v28, vcc
  v_cndmask_b32 v29, v29, v27, vcc
  v_cndmask_b32 v30, 0, 1.0, vcc
  v_mfma_f32_16x16x32_bf16 v[56:59], a[24:27], v[180:183], v[56:59]
  v_mfma_f32_16x16x32_bf16 v[60:63], a[28:31], v[180:183], v[60:63]
  buffer_load_dwordx4 v[180:183], v1, s[32:35], s80 offen offset:1024 sc1
  s_waitcnt vmcnt(32)
  v_mfma_f32_16x16x32_bf16 v[48:51], a[32:35], v[96:99], v[48:51]
  v_fma_f32 v32, v32, v152, v28
  v_mfma_f32_16x16x32_bf16 v[52:55], a[36:39], v[96:99], v[52:55]
  v_fma_f32 v33, v33, v153, v28
  v_fma_f32 v34, v34, v154, v28
  v_fma_f32 v35, v35, v155, v28
  v_mfma_f32_16x16x32_bf16 v[56:59], a[40:43], v[96:99], v[56:59]
  v_mul_f32 v168, s83, v32
  v_mul_f32 v169, s83, v33
  v_mfma_f32_16x16x32_bf16 v[60:63], a[44:47], v[96:99], v[60:63]
  buffer_load_dwordx4 v[96:99], v1, s[32:35], s80 offen offset:2048 sc1
  v_mfma_f32_16x16x32_bf16 v[48:51], a[48:51], v[100:103], v[48:51]
  v_mul_f32 v170, s83, v34
  v_mul_f32 v171, s83, v35
  v_exp_f32_e64 v168, v168 clamp
  v_mfma_f32_16x16x32_bf16 v[52:55], a[52:55], v[100:103], v[52:55]
  v_exp_f32_e64 v169, v169 clamp
  v_mfma_f32_16x16x32_bf16 v[56:59], a[56:59], v[100:103], v[56:59]
  v_exp_f32_e64 v170, v170 clamp
  v_mfma_f32_16x16x32_bf16 v[60:63], a[60:63], v[100:103], v[60:63]
  buffer_load_dwordx4 v[100:103], v1, s[32:35], s80 offen offset:3072 sc1
  s_waitcnt vmcnt(32)
  v_mfma_f32_16x16x32_bf16 v[48:51], a[64:67], v[184:187], v[48:51]
  v_exp_f32_e64 v171, v171 clamp
  v_max_f32 v32, v32, v29
  v_mfma_f32_16x16x32_bf16 v[52:55], a[68:71], v[184:187], v[52:55]
  v_max_f32 v33, v33, v29
  v_max_f32 v34, v34, v29
  v_max_f32 v35, v35, v29
  v_mfma_f32_16x16x32_bf16 v[56:59], a[72:75], v[184:187], v[56:59]
  v_fma_f32 v32, v168, v30, v32
  v_fma_f32 v33, v169, v30, v33
  v_fma_f32 v34, v170, v30, v34
  v_mfma_f32_16x16x32_bf16 v[60:63], a[76:79], v[184:187], v[60:63]
  s_add_u32 s80, s80, 4096
  buffer_load_dwordx4 v[184:187], v1, s[32:35], s80 offen offset:0 sc1
  v_mfma_f32_16x16x32_bf16 v[48:51], a[80:83], v[104:107], v[48:51]
  v_fma_f32 v35, v171, v30, v35
  v_fma_f32 v36, v36, v156, v28
  v_mfma_f32_16x16x32_bf16 v[52:55], a[84:87], v[104:107], v[52:55]
  v_fma_f32 v37, v37, v157, v28
  v_fma_f32 v38, v38, v158, v28
  v_fma_f32 v39, v39, v159, v28
  v_mfma_f32_16x16x32_bf16 v[56:59], a[88:91], v[104:107], v[56:59]
  v_mul_f32 v168, s83, v36
  v_mul_f32 v169, s83, v37
  v_mul_f32 v170, s83, v38
  v_mfma_f32_16x16x32_bf16 v[60:63], a[92:95], v[104:107], v[60:63]
  buffer_load_dwordx4 v[104:107], v1, s[32:35], s80 offen offset:1024 sc1
  s_waitcnt vmcnt(32)
  v_mfma_f32_16x16x32_bf16 v[48:51], a[96:99], v[108:111], v[48:51]
  v_mul_f32 v171, s83, v39
  v_exp_f32_e64 v168, v168 clamp
  v_mfma_f32_16x16x32_bf16 v[52:55], a[100:103], v[108:111], v[52:55]
  v_exp_f32_e64 v169, v169 clamp
  v_mfma_f32_16x16x32_bf16 v[56:59], a[104:107], v[108:111], v[56:59]
  v_exp_f32_e64 v170, v170 clamp
  v_mfma_f32_16x16x32_bf16 v[60:63], a[108:111], v[108:111], v[60:63]
  buffer_load_dwordx4 v[108:111], v1, s[32:35], s80 offen offset:2048 sc1
  v_mfma_f32_16x16x32_bf16 v[48:51], a[112:115], v[188:191], v[48:51]
  v_exp_f32_e64 v171, v171 clamp
  v_max_f32 v36, v36, v29
  v_max_f32 v37, v37, v29
  v_mfma_f32_16x16x32_bf16 v[52:55], a[116:119], v[188:191], v[52:55]
  v_max_f32 v38, v38, v29
  v_max_f32 v39, v39, v29
  v_mfma_f32_16x16x32_bf16 v[56:59], a[120:123], v[188:191], v[56:59]
  v_fma_f32 v36, v168, v30, v36
  v_fma_f32 v37, v169, v30, v37
  v_fma_f32 v38, v170, v30, v38
  v_mfma_f32_16x16x32_bf16 v[60:63], a[124:127], v[188:191], v[60:63]
  buffer_load_dwordx4 v[188:191], v1, s[32:35], s80 offen offset:3072 sc1
  s_waitcnt vmcnt(32)
  v_mfma_f32_16x16x32_bf16 v[48:51], a[128:131], v[112:115], v[48:51]
  v_fma_f32 v39, v171, v30, v39
  v_fma_f32 v40, v40, v160, v28
  v_fma_f32 v41, v41, v161, v28
  v_mfma_f32_16x16x32_bf16 v[52:55], a[132:135], v[112:115], v[52:55]
  v_fma_f32 v42, v42, v162, v28
  v_mfma_f32_16x16x32_bf16 v[56:59], a[136:139], v[112:115], v[56:59]
  v_mfma_f32_16x16x32_bf16 v[60:63], a[140:143], v[112:115], v[60:63]
  s_add_u32 s80, s80, 4096
  buffer_load_dwordx4 v[112:115], v1, s[32:35], s80 offen offset:0 sc1
  v_mfma_f32_16x16x32_bf16 v[48:51], a[144:147], v[116:119], v[48:51]
  v_mfma_f32_16x16x32_bf16 v[52:55], a[148:151], v[116:119], v[52:55]
  s_mov_b32 s56, 0xffff0000
  v_lshlrev_b32 v8, 16, v22
  v_and_b32 v9, s56, v22
  v_lshlrev_b32 v10, 16, v23
  v_and_b32 v11, s56, v23
  v_mul_f32 v8, 0x3eeff558, v8
  v_mul_f32 v9, 0x3eeff558, v9
  v_mul_f32 v10, 0x3eeff558, v10
  v_mul_f32 v11, 0x3eeff558, v11
  v_lshlrev_b32 v24, 3, v0
  v_add_u32 v25, 159744, v24
  ds_write_b64 v25, v[8:9]
  v_add_u32 v25, 161792, v24
  v_mov_b32 v24, 162304
  v_cmp_gt_u32 vcc, 32, v0
  s_nop 1
  v_cndmask_b32 v25, v24, v25, vcc
  ds_write_b64 v25, v[10:11]
  v_mfma_f32_16x16x32_bf16 v[56:59], a[152:155], v[116:119], v[56:59]
  v_mfma_f32_16x16x32_bf16 v[60:63], a[156:159], v[116:119], v[60:63]
  buffer_load_dwordx4 v[116:119], v1, s[32:35], s80 offen offset:1024 sc1
  s_waitcnt vmcnt(32)
  v_mfma_f32_16x16x32_bf16 v[48:51], a[160:163], v[192:195], v[48:51]
  v_mfma_f32_16x16x32_bf16 v[52:55], a[164:167], v[192:195], v[52:55]
  v_fma_f32 v43, v43, v163, v28
  v_mul_f32 v168, s83, v40
  v_mul_f32 v169, s83, v41
  v_mfma_f32_16x16x32_bf16 v[56:59], a[168:171], v[192:195], v[56:59]
  v_mul_f32 v170, s83, v42
  v_mul_f32 v171, s83, v43
  v_mfma_f32_16x16x32_bf16 v[60:63], a[172:175], v[192:195], v[60:63]
  buffer_load_dwordx4 v[192:195], v1, s[32:35], s80 offen offset:2048 sc1
  v_mfma_f32_16x16x32_bf16 v[48:51], a[176:179], v[120:123], v[48:51]
  v_exp_f32_e64 v168, v168 clamp
  v_exp_f32_e64 v169, v169 clamp
  v_mfma_f32_16x16x32_bf16 v[52:55], a[180:183], v[120:123], v[52:55]
  v_exp_f32_e64 v170, v170 clamp
  v_mfma_f32_16x16x32_bf16 v[56:59], a[184:187], v[120:123], v[56:59]
  v_exp_f32_e64 v171, v171 clamp
  v_max_f32 v40, v40, v29
  v_mfma_f32_16x16x32_bf16 v[60:63], a[188:191], v[120:123], v[60:63]
  buffer_load_dwordx4 v[120:123], v1, s[32:35], s80 offen offset:3072 sc1
  s_waitcnt vmcnt(32)
  v_mfma_f32_16x16x32_bf16 v[48:51], a[192:195], v[124:127], v[48:51]
  v_max_f32 v41, v41, v29
  v_max_f32 v42, v42, v29
  v_mfma_f32_16x16x32_bf16 v[52:55], a[196:199], v[124:127], v[52:55]
  v_max_f32 v43, v43, v29
  v_fma_f32 v40, v168, v30, v40
  v_fma_f32 v41, v169, v30, v41
  v_mfma_f32_16x16x32_bf16 v[56:59], a[200:203], v[124:127], v[56:59]
  v_fma_f32 v42, v170, v30, v42
  v_fma_f32 v43, v171, v30, v43
  v_fma_f32 v44, v44, v164, v28
  v_mfma_f32_16x16x32_bf16 v[60:63], a[204:207], v[124:127], v[60:63]
  s_add_u32 s80, s80, 4096
  buffer_load_dwordx4 v[124:127], v1, s[32:35], s80 offen offset:0 sc1
  v_mfma_f32_16x16x32_bf16 v[48:51], a[208:211], v[196:199], v[48:51]
  v_fma_f32 v45, v45, v165, v28
  v_fma_f32 v46, v46, v166, v28
  v_fma_f32 v47, v47, v167, v28
  v_mfma_f32_16x16x32_bf16 v[52:55], a[212:215], v[196:199], v[52:55]
  v_mul_f32 v168, s83, v44
  v_mul_f32 v169, s83, v45
  v_mfma_f32_16x16x32_bf16 v[56:59], a[216:219], v[196:199], v[56:59]
  v_mul_f32 v170, s83, v46
  v_mul_f32 v171, s83, v47
  v_exp_f32_e64 v168, v168 clamp
  v_mfma_f32_16x16x32_bf16 v[60:63], a[220:223], v[196:199], v[60:63]
  buffer_load_dwordx4 v[196:199], v1, s[32:35], s80 offen offset:1024 sc1
  s_waitcnt vmcnt(32)
  v_mfma_f32_16x16x32_bf16 v[48:51], a[224:227], v[128:131], v[48:51]
  v_exp_f32_e64 v169, v169 clamp
  v_mfma_f32_16x16x32_bf16 v[52:55], a[228:231], v[128:131], v[52:55]
  v_exp_f32_e64 v170, v170 clamp
  v_mfma_f32_16x16x32_bf16 v[56:59], a[232:235], v[128:131], v[56:59]
  v_exp_f32_e64 v171, v171 clamp
  v_max_f32 v44, v44, v29
  v_mfma_f32_16x16x32_bf16 v[60:63], a[236:239], v[128:131], v[60:63]
  buffer_load_dwordx4 v[128:131], v1, s[32:35], s80 offen offset:2048 sc1
  v_mfma_f32_16x16x32_bf16 v[48:51], a[240:243], v[132:135], v[48:51]
  v_max_f32 v45, v45, v29
  v_max_f32 v46, v46, v29
  v_max_f32 v47, v47, v29
  v_mfma_f32_16x16x32_bf16 v[52:55], a[244:247], v[132:135], v[52:55]
  v_fma_f32 v44, v168, v30, v44
  v_fma_f32 v45, v169, v30, v45
  v_fma_f32 v46, v170, v30, v46
  v_mfma_f32_16x16x32_bf16 v[56:59], a[248:251], v[132:135], v[56:59]
  v_fma_f32 v47, v171, v30, v47
  v_mfma_f32_16x16x32_bf16 v[60:63], a[252:255], v[132:135], v[60:63]
  buffer_load_dwordx4 v[132:135], v1, s[32:35], s80 offen offset:3072 sc1
  s_waitcnt vmcnt(32)
  v_mfma_f32_16x16x32_bf16 v[48:51], v[224:227], v[200:203], v[48:51]
  s_mov_b32 s56, s26
  s_lshl_b32 s57, s56, 11
  s_add_u32 s57, s57, 0
  v_add_u32 v27, s57, v1
  v_cvt_pk_bf16_f32 v4, v32, v33
  v_mfma_f32_16x16x32_bf16 v[52:55], v[228:231], v[200:203], v[52:55]
  v_cvt_pk_bf16_f32 v5, v34, v35
  v_cvt_pk_bf16_f32 v6, v36, v37
  v_cvt_pk_bf16_f32 v7, v38, v39
  v_mfma_f32_16x16x32_bf16 v[56:59], v[232:235], v[200:203], v[56:59]
  ds_write_b128 v27, v[4:7] offset:0
  v_cvt_pk_bf16_f32 v4, v40, v41
  v_mfma_f32_16x16x32_bf16 v[60:63], v[236:239], v[200:203], v[60:63]
  s_add_u32 s80, s80, 4096
  buffer_load_dwordx4 v[200:203], v1, s[32:35], s80 offen offset:0 sc1
  v_mfma_f32_16x16x32_bf16 v[48:51], v[240:243], v[136:139], v[48:51]
  v_cvt_pk_bf16_f32 v5, v42, v43
  v_cvt_pk_bf16_f32 v6, v44, v45
  v_mfma_f32_16x16x32_bf16 v[52:55], v[244:247], v[136:139], v[52:55]
  v_cvt_pk_bf16_f32 v7, v46, v47
  ds_write_b128 v27, v[4:7] offset:1024
  v_mfma_f32_16x16x32_bf16 v[56:59], v[248:251], v[136:139], v[56:59]
  v_mfma_f32_16x16x32_bf16 v[60:63], v[252:255], v[136:139], v[60:63]
  buffer_load_dwordx4 v[136:139], v1, s[32:35], s80 offen offset:1024 sc1
  s_mul_i32 s56, s26, 4096
  v_subrev_u32 v174, s56, v17
  v_add_u32 v174, 24576, v174
  s_and_b32 s58, s26, 1
  s_cmp_eq_u32 s58, 0
  s_cbranch_scc0 Lp3_3
  s_waitcnt vmcnt(31)
  v_mfma_f32_16x16x32_bf16 v[32:35], a[0:3], v[140:143], 0
  v_mfma_f32_16x16x32_bf16 v[36:39], a[4:7], v[140:143], 0
  buffer_load_dwordx4 v[140:143], v1, s[32:35], s80 offen offset:2048 sc1
  v_mfma_f32_16x16x32_bf16 v[32:35], a[16:19], v[204:207], v[32:35]
  v_mul_f32 v48, v48, v152
  v_mul_f32 v49, v49, v153
  v_mul_f32 v50, v50, v154
  v_mfma_f32_16x16x32_bf16 v[36:39], a[20:23], v[204:207], v[36:39]
  buffer_load_dwordx4 v[204:207], v1, s[32:35], s80 offen offset:3072 sc1
  v_mul_f32 v51, v51, v155
  s_waitcnt vmcnt(31)
  v_mfma_f32_16x16x32_bf16 v[32:35], a[32:35], v[208:211], v[32:35]
  v_mul_f32 v52, v52, v156
  v_mul_f32 v53, v53, v157
  v_mul_f32 v54, v54, v158
  v_mfma_f32_16x16x32_bf16 v[36:39], a[36:39], v[208:211], v[36:39]
  s_add_u32 s80, s80, 4096
  buffer_load_dwordx4 v[208:211], v1, s[32:35], s80 offen offset:0 sc1
  v_mfma_f32_16x16x32_bf16 v[32:35], a[48:51], v[212:215], v[32:35]
  v_mul_f32 v55, v55, v159
  v_mul_f32 v56, v56, v160
  v_mul_f32 v57, v57, v161
  v_mul_f32 v58, v58, v162
  v_mfma_f32_16x16x32_bf16 v[36:39], a[52:55], v[212:215], v[36:39]
  buffer_load_dwordx4 v[212:215], v1, s[32:35], s80 offen offset:1024 sc1
  s_waitcnt vmcnt(30)
  v_mfma_f32_16x16x32_bf16 v[32:35], a[64:67], v[64:67], v[32:35]
  v_mul_f32 v59, v59, v163
  v_mul_f32 v60, v60, v164
  v_mul_f32 v61, v61, v165
  v_mfma_f32_16x16x32_bf16 v[36:39], a[68:71], v[64:67], v[36:39]
  buffer_load_dwordx4 v[64:67], v1, s[32:35], s80 offen offset:2048 sc1
  v_mfma_f32_16x16x32_bf16 v[32:35], a[80:83], v[68:71], v[32:35]
  v_mul_f32 v62, v62, v166
  v_mul_f32 v63, v63, v167
  s_add_u32 s56, s26, 5
  s_lshl_b32 s57, s56, 11
  s_add_u32 s57, s57, 0
  v_add_u32 v27, s57, v1
  v_mfma_f32_16x16x32_bf16 v[36:39], a[84:87], v[68:71], v[36:39]
  buffer_load_dwordx4 v[68:71], v1, s[32:35], s80 offen offset:3072 sc1
  s_waitcnt vmcnt(29)
  v_mfma_f32_16x16x32_bf16 v[32:35], a[96:99], v[72:75], v[32:35]
  v_cvt_pk_bf16_f32 v4, v48, v49
  v_cvt_pk_bf16_f32 v5, v50, v51
  v_mfma_f32_16x16x32_bf16 v[36:39], a[100:103], v[72:75], v[36:39]
  s_add_u32 s80, s80, 4096
  buffer_load_dwordx4 v[72:75], v1, s[32:35], s80 offen offset:0 sc1
  v_cvt_pk_bf16_f32 v6, v52, v53
  v_mfma_f32_16x16x32_bf16 v[32:35], a[112:115], v[76:79], v[32:35]
  v_cvt_pk_bf16_f32 v7, v54, v55
  ds_write_b128 v27, v[4:7] offset:0
  v_mfma_f32_16x16x32_bf16 v[36:39], a[116:119], v[76:79], v[36:39]
  buffer_load_dwordx4 v[76:79], v1, s[32:35], s80 offen offset:1024 sc1
  s_waitcnt vmcnt(29)
  v_mfma_f32_16x16x32_bf16 v[32:35], a[128:131], v[80:83], v[32:35]
  v_cvt_pk_bf16_f32 v4, v56, v57
  v_cvt_pk_bf16_f32 v5, v58, v59
  v_cvt_pk_bf16_f32 v6, v60, v61
  v_cvt_pk_bf16_f32 v7, v62, v63
  v_mfma_f32_16x16x32_bf16 v[36:39], a[132:135], v[80:83], v[36:39]
  buffer_load_dwordx4 v[80:83], v1, s[32:35], s80 offen offset:2048 sc1
  v_mfma_f32_16x16x32_bf16 v[32:35], a[144:147], v[84:87], v[32:35]
  ds_write_b128 v27, v[4:7] offset:1024
  v_mfma_f32_16x16x32_bf16 v[36:39], a[148:151], v[84:87], v[36:39]
  buffer_load_dwordx4 v[84:87], v1, s[32:35], s80 offen offset:3072 sc1
  s_waitcnt vmcnt(28)
  v_mfma_f32_16x16x32_bf16 v[32:35], a[160:163], v[176:179], v[32:35]
  v_mfma_f32_16x16x32_bf16 v[36:39], a[164:167], v[176:179], v[36:39]
  s_add_u32 s80, s80, 4096
  buffer_load_dwordx4 v[176:179], v1, s[32:35], s80 offen offset:0 sc1
  v_mfma_f32_16x16x32_bf16 v[32:35], a[176:179], v[88:91], v[32:35]
  v_mfma_f32_16x16x32_bf16 v[36:39], a[180:183], v[88:91], v[36:39]
  buffer_load_dwordx4 v[88:91], v1, s[32:35], s80 offen offset:1024 sc1
  s_waitcnt vmcnt(28)
  v_mfma_f32_16x16x32_bf16 v[32:35], a[192:195], v[92:95], v[32:35]
  v_mfma_f32_16x16x32_bf16 v[36:39], a[196:199], v[92:95], v[36:39]
  buffer_load_dwordx4 v[92:95], v1, s[32:35], s80 offen offset:2048 sc1
  v_mfma_f32_16x16x32_bf16 v[32:35], a[208:211], v[180:183], v[32:35]
  v_mul_u32_u24 v27, 21846, v0
  v_lshrrev_b32 v27, 16, v27
  v_mul_u32_u24 v26, 3, v27
  v_sub_u32 v26, v0, v26
  v_mul_u32_u24 v27, 208, v27
  v_lshl_add_u32 v27, v26, 4, v27
  v_add_u32 v27, 86176, v27
  v_mov_b32 v26, 162304
  v_cmp_gt_u32 vcc, 192, v0
  s_nop 1
  v_cndmask_b32 v27, v26, v27, vcc
  v_mov_b32 v8, 0
  v_mov_b32 v9, 0
  v_mov_b32 v10, 0
  v_mov_b32 v11, 0
  ds_write_b128 v27, v[8:11]
  v_lshlrev_b32 v27, 4, v0
  v_add_u32 v27, 102400, v27
  ds_write_b128 v27, v[8:11] offset:0
  ds_write_b128 v27, v[8:11] offset:4096
  ds_write_b128 v27, v[8:11] offset:8192
  ds_write_b128 v27, v[8:11] offset:12288
  ds_write_b128 v27, v[8:11] offset:16384
  ds_write_b128 v27, v[8:11] offset:20480
  ds_write_b128 v27, v[8:11] offset:24576
  ds_write_b128 v27, v[8:11] offset:28672
  v_mfma_f32_16x16x32_bf16 v[36:39], a[212:215], v[180:183], v[36:39]
  buffer_load_dwordx4 v[180:183], v1, s[32:35], s80 offen offset:3072 sc1
  s_waitcnt vmcnt(28)
  v_mfma_f32_16x16x32_bf16 v[32:35], a[224:227], v[96:99], v[32:35]
  v_mfma_f32_16x16x32_bf16 v[36:39], a[228:231], v[96:99], v[36:39]
  s_add_u32 s80, s80, 4096
  buffer_load_dwordx4 v[96:99], v1, s[32:35], s80 offen offset:0 sc1
  v_mfma_f32_16x16x32_bf16 v[32:35], a[240:243], v[100:103], v[32:35]
  v_mfma_f32_16x16x32_bf16 v[36:39], a[244:247], v[100:103], v[36:39]
  buffer_load_dwordx4 v[100:103], v1, s[32:35], s80 offen offset:1024 sc1
  s_waitcnt vmcnt(28)
  v_mfma_f32_16x16x32_bf16 v[32:35], v[224:227], v[184:187], v[32:35]
  v_mfma_f32_16x16x32_bf16 v[36:39], v[228:231], v[184:187], v[36:39]
  buffer_load_dwordx4 v[184:187], v1, s[32:35], s80 offen offset:2048 sc1
  v_mfma_f32_16x16x32_bf16 v[32:35], v[240:243], v[104:107], v[32:35]
  v_mfma_f32_16x16x32_bf16 v[36:39], v[244:247], v[104:107], v[36:39]
  buffer_load_dwordx4 v[104:107], v1, s[32:35], s80 offen offset:3072 sc1
  s_branch Lp3_4
Lp3_3:
  s_waitcnt vmcnt(31)
  v_mfma_f32_16x16x32_bf16 v[32:35], a[8:11], v[140:143], 0
  v_mfma_f32_16x16x32_bf16 v[36:39], a[12:15], v[140:143], 0
  buffer_load_dwordx4 v[140:143], v1, s[32:35], s80 offen offset:2048 sc1
  v_mfma_f32_16x16x32_bf16 v[32:35], a[24:27], v[204:207], v[32:35]
  v_mul_f32 v48, v48, v152
  v_mul_f32 v49, v49, v153
  v_mul_f32 v50, v50, v154
  v_mfma_f32_16x16x32_bf16 v[36:39], a[28:31], v[204:207], v[36:39]
  buffer_load_dwordx4 v[204:207], v1, s[32:35], s80 offen offset:3072 sc1
  v_mul_f32 v51, v51, v155
  s_waitcnt vmcnt(31)
  v_mfma_f32_16x16x32_bf16 v[32:35], a[40:43], v[208:211], v[32:35]
  v_mul_f32 v52, v52, v156
  v_mul_f32 v53, v53, v157
  v_mul_f32 v54, v54, v158
  v_mfma_f32_16x16x32_bf16 v[36:39], a[44:47], v[208:211], v[36:39]
  s_add_u32 s80, s80, 4096
  buffer_load_dwordx4 v[208:211], v1, s[32:35], s80 offen offset:0 sc1
  v_mfma_f32_16x16x32_bf16 v[32:35], a[56:59], v[212:215], v[32:35]
  v_mul_f32 v55, v55, v159
  v_mul_f32 v56, v56, v160
  v_mul_f32 v57, v57, v161
  v_mul_f32 v58, v58, v162
  v_mfma_f32_16x16x32_bf16 v[36:39], a[60:63], v[212:215], v[36:39]
  buffer_load_dwordx4 v[212:215], v1, s[32:35], s80 offen offset:1024 sc1
  s_waitcnt vmcnt(30)
  v_mfma_f32_16x16x32_bf16 v[32:35], a[72:75], v[64:67], v[32:35]
  v_mul_f32 v59, v59, v163
  v_mul_f32 v60, v60, v164
  v_mul_f32 v61, v61, v165
  v_mfma_f32_16x16x32_bf16 v[36:39], a[76:79], v[64:67], v[36:39]
  buffer_load_dwordx4 v[64:67], v1, s[32:35], s80 offen offset:2048 sc1
  v_mfma_f32_16x16x32_bf16 v[32:35], a[88:91], v[68:71], v[32:35]
  v_mul_f32 v62, v62, v166
  v_mul_f32 v63, v63, v167
  s_add_u32 s56, s26, 5
  s_lshl_b32 s57, s56, 11
  s_add_u32 s57, s57, 0
  v_add_u32 v27, s57, v1
  v_mfma_f32_16x16x32_bf16 v[36:39], a[92:95], v[68:71], v[36:39]
  buffer_load_dwordx4 v[68:71], v1, s[32:35], s80 offen offset:3072 sc1
  s_waitcnt vmcnt(29)
  v_mfma_f32_16x16x32_bf16 v[32:35], a[104:107], v[72:75], v[32:35]
  v_cvt_pk_bf16_f32 v4, v48, v49
  v_cvt_pk_bf16_f32 v5, v50, v51
  v_mfma_f32_16x16x32_bf16 v[36:39], a[108:111], v[72:75], v[36:39]
  s_add_u32 s80, s80, 4096
  buffer_load_dwordx4 v[72:75], v1, s[32:35], s80 offen offset:0 sc1
  v_cvt_pk_bf16_f32 v6, v52, v53
  v_mfma_f32_16x16x32_bf16 v[32:35], a[120:123], v[76:79], v[32:35]
  v_cvt_pk_bf16_f32 v7, v54, v55
  ds_write_b128 v27, v[4:7] offset:0
  v_mfma_f32_16x16x32_bf16 v[36:39], a[124:127], v[76:79], v[36:39]
  buffer_load_dwordx4 v[76:79], v1, s[32:35], s80 offen offset:1024 sc1
  s_waitcnt vmcnt(29)
  v_mfma_f32_16x16x32_bf16 v[32:35], a[136:139], v[80:83], v[32:35]
  v_cvt_pk_bf16_f32 v4, v56, v57
  v_cvt_pk_bf16_f32 v5, v58, v59
  v_cvt_pk_bf16_f32 v6, v60, v61
  v_cvt_pk_bf16_f32 v7, v62, v63
  v_mfma_f32_16x16x32_bf16 v[36:39], a[140:143], v[80:83], v[36:39]
  buffer_load_dwordx4 v[80:83], v1, s[32:35], s80 offen offset:2048 sc1
  v_mfma_f32_16x16x32_bf16 v[32:35], a[152:155], v[84:87], v[32:35]
  ds_write_b128 v27, v[4:7] offset:1024
  v_mfma_f32_16x16x32_bf16 v[36:39], a[156:159], v[84:87], v[36:39]
  buffer_load_dwordx4 v[84:87], v1, s[32:35], s80 offen offset:3072 sc1
  s_waitcnt vmcnt(28)
  v_mfma_f32_16x16x32_bf16 v[32:35], a[168:171], v[176:179], v[32:35]
  v_mfma_f32_16x16x32_bf16 v[36:39], a[172:175], v[176:179], v[36:39]
  s_add_u32 s80, s80, 4096
  buffer_load_dwordx4 v[176:179], v1, s[32:35], s80 offen offset:0 sc1
  v_mfma_f32_16x16x32_bf16 v[32:35], a[184:187], v[88:91], v[32:35]
  v_mfma_f32_16x16x32_bf16 v[36:39], a[188:191], v[88:91], v[36:39]
  buffer_load_dwordx4 v[88:91], v1, s[32:35], s80 offen offset:1024 sc1
  s_waitcnt vmcnt(28)
  v_mfma_f32_16x16x32_bf16 v[32:35], a[200:203], v[92:95], v[32:35]
  v_mfma_f32_16x16x32_bf16 v[36:39], a[204:207], v[92:95], v[36:39]
  buffer_load_dwordx4 v[92:95], v1, s[32:35], s80 offen offset:2048 sc1
  v_mfma_f32_16x16x32_bf16 v[32:35], a[216:219], v[180:183], v[32:35]
  v_mul_u32_u24 v27, 21846, v0
  v_lshrrev_b32 v27, 16, v27
  v_mul_u32_u24 v26, 3, v27
  v_sub_u32 v26, v0, v26
  v_mul_u32_u24 v27, 208, v27
  v_lshl_add_u32 v27, v26, 4, v27
  v_add_u32 v27, 86176, v27
  v_mov_b32 v26, 162304
  v_cmp_gt_u32 vcc, 192, v0
  s_nop 1
  v_cndmask_b32 v27, v26, v27, vcc
  v_mov_b32 v8, 0
  v_mov_b32 v9, 0
  v_mov_b32 v10, 0
  v_mov_b32 v11, 0
  ds_write_b128 v27, v[8:11]
  v_lshlrev_b32 v27, 4, v0
  v_add_u32 v27, 102400, v27
  ds_write_b128 v27, v[8:11] offset:0
  ds_write_b128 v27, v[8:11] offset:4096
  ds_write_b128 v27, v[8:11] offset:8192
  ds_write_b128 v27, v[8:11] offset:12288
  ds_write_b128 v27, v[8:11] offset:16384
  ds_write_b128 v27, v[8:11] offset:20480
  ds_write_b128 v27, v[8:11] offset:24576
  ds_write_b128 v27, v[8:11] offset:28672
  v_mfma_f32_16x16x32_bf16 v[36:39], a[220:223], v[180:183], v[36:39]
  buffer_load_dwordx4 v[180:183], v1, s[32:35], s80 offen offset:3072 sc1
  s_waitcnt vmcnt(28)
  v_mfma_f32_16x16x32_bf16 v[32:35], a[232:235], v[96:99], v[32:35]
  v_mfma_f32_16x16x32_bf16 v[36:39], a[236:239], v[96:99], v[36:39]
  s_add_u32 s80, s80, 4096
  buffer_load_dwordx4 v[96:99], v1, s[32:35], s80 offen offset:0 sc1
  v_mfma_f32_16x16x32_bf16 v[32:35], a[248:251], v[100:103], v[32:35]
  v_mfma_f32_16x16x32_bf16 v[36:39], a[252:255], v[100:103], v[36:39]
  buffer_load_dwordx4 v[100:103], v1, s[32:35], s80 offen offset:1024 sc1
  s_waitcnt vmcnt(28)
  v_mfma_f32_16x16x32_bf16 v[32:35], v[232:235], v[184:187], v[32:35]
  v_mfma_f32_16x16x32_bf16 v[36:39], v[236:239], v[184:187], v[36:39]
  buffer_load_dwordx4 v[184:187], v1, s[32:35], s80 offen offset:2048 sc1
  v_mfma_f32_16x16x32_bf16 v[32:35], v[248:251], v[104:107], v[32:35]
  v_mfma_f32_16x16x32_bf16 v[36:39], v[252:255], v[104:107], v[36:39]
  buffer_load_dwordx4 v[104:107], v1, s[32:35], s80 offen offset:3072 sc1
Lp3_4:
  s_barrier
  s_add_u32 s56, s85, 35946496
  s_cmp_eq_u32 s26, 0
  s_cselect_b32 s56, s56, 1879048192
  v_mov_b32 v172, s29
  v_mov_b32 v173, 0
  s_mov_b64 exec, 1
  buffer_store_dword v172, v173, s[32:35], s56 offen sc1
  s_mov_b64 exec, -1
  s_waitcnt vmcnt(29)
  v_mfma_f32_16x16x32_bf16 v[48:51], a[0:3], v[108:111], 0
  v_mfma_f32_16x16x32_bf16 v[52:55], a[4:7], v[108:111], 0
  v_mfma_f32_16x16x32_bf16 v[56:59], a[8:11], v[108:111], 0
  v_mfma_f32_16x16x32_bf16 v[60:63], a[12:15], v[108:111], 0
  s_add_u32 s80, s80, 4096
  buffer_load_dwordx4 v[108:111], v1, s[32:35], s80 offen offset:0 sc1
  v_mfma_f32_16x16x32_bf16 v[48:51], a[16:19], v[188:191], v[48:51]
  s_and_b32 s58, s26, 1
  s_cmp_eq_u32 s58, 0
  s_cbranch_scc0 Ls_5
  v_mov_b32 v144, v152
  v_mov_b32 v145, v153
  v_mov_b32 v146, v154
  v_mov_b32 v147, v155
  v_mov_b32 v148, v156
  v_mov_b32 v149, v157
  v_mov_b32 v150, v158
  v_mov_b32 v151, v159
  s_branch Ls_6
Ls_5:
  v_mov_b32 v144, v160
  v_mov_b32 v145, v161
  v_mov_b32 v146, v162
  v_mov_b32 v147, v163
  v_mov_b32 v148, v164
  v_mov_b32 v149, v165
  v_mov_b32 v150, v166
  v_mov_b32 v151, v167
Ls_6:
  v_mfma_f32_16x16x32_bf16 v[52:55], a[20:23], v[188:191], v[52:55]
  v_mfma_f32_16x16x32_bf16 v[56:59], a[24:27], v[188:191], v[56:59]
  s_cmp_lt_u32 s26, 2
  s_cselect_b32 s56, 4, 0
  s_lshl_b32 s57, s56, 4
  v_add_u32 v27, s57, v2
  v_cmp_gt_u32 vcc, 72, v27
  v_mov_b32 v28, 0x358637bd
  v_mov_b32 v29, 0xff7fffff
  v_mov_b32 v27, 0x358637bd
  v_cndmask_b32 v28, 0, v28, vcc
  v_cndmask_b32 v29, v29, v27, vcc
  v_cndmask_b32 v30, 0, 1.0, vcc
  v_mfma_f32_16x16x32_bf16 v[60:63], a[28:31], v[188:191], v[60:63]
  buffer_load_dwordx4 v[188:191], v1, s[32:35], s80 offen offset:1024 sc1
  s_waitcnt vmcnt(29)
  v_mfma_f32_16x16x32_bf16 v[48:51], a[32:35], v[112:115], v[48:51]
  v_fma_f32 v32, v32, v144, v28
  v_mfma_f32_16x16x32_bf16 v[52:55], a[36:39], v[112:115], v[52:55]
  v_fma_f32 v33, v33, v145, v28
  v_fma_f32 v34, v34, v146, v28
  v_fma_f32 v35, v35, v147, v28
  v_mul_f32 v168, s83, v32
  v_mul_f32 v169, s83, v33
  v_mfma_f32_16x16x32_bf16 v[56:59], a[40:43], v[112:115], v[56:59]
  v_mul_f32 v170, s83, v34
  v_mul_f32 v171, s83, v35
  v_exp_f32_e64 v168, v168 clamp
  v_mfma_f32_16x16x32_bf16 v[60:63], a[44:47], v[112:115], v[60:63]
  buffer_load_dwordx4 v[112:115], v1, s[32:35], s80 offen offset:2048 sc1
  v_exp_f32_e64 v169, v169 clamp
  v_mfma_f32_16x16x32_bf16 v[48:51], a[48:51], v[116:119], v[48:51]
  v_exp_f32_e64 v170, v170 clamp
  v_exp_f32_e64 v171, v171 clamp
  v_mfma_f32_16x16x32_bf16 v[52:55], a[52:55], v[116:119], v[52:55]
  v_max_f32 v32, v32, v29
  v_max_f32 v33, v33, v29
  v_max_f32 v34, v34, v29
  v_max_f32 v35, v35, v29
  v_fma_f32 v32, v168, v30, v32
  v_mfma_f32_16x16x32_bf16 v[56:59], a[56:59], v[116:119], v[56:59]
  v_fma_f32 v33, v169, v30, v33
  v_fma_f32 v34, v170, v30, v34
  v_fma_f32 v35, v171, v30, v35
  v_fma_f32 v36, v36, v148, v28
  v_mfma_f32_16x16x32_bf16 v[60:63], a[60:63], v[116:119], v[60:63]
  buffer_load_dwordx4 v[116:119], v1, s[32:35], s80 offen offset:3072 sc1
  v_fma_f32 v37, v37, v149, v28
  v_fma_f32 v38, v38, v150, v28
  s_waitcnt vmcnt(29)
  v_mfma_f32_16x16x32_bf16 v[48:51], a[64:67], v[192:195], v[48:51]
  v_fma_f32 v39, v39, v151, v28
  v_mul_f32 v168, s83, v36
  v_mul_f32 v169, s83, v37
  v_mul_f32 v170, s83, v38
  v_mfma_f32_16x16x32_bf16 v[52:55], a[68:71], v[192:195], v[52:55]
  v_mul_f32 v171, s83, v39
  v_exp_f32_e64 v168, v168 clamp
  v_exp_f32_e64 v169, v169 clamp
  v_mfma_f32_16x16x32_bf16 v[56:59], a[72:75], v[192:195], v[56:59]
  v_exp_f32_e64 v170, v170 clamp
  v_exp_f32_e64 v171, v171 clamp
  v_mfma_f32_16x16x32_bf16 v[60:63], a[76:79], v[192:195], v[60:63]
  s_add_u32 s80, s80, 4096
  buffer_load_dwordx4 v[192:195], v1, s[32:35], s80 offen offset:0 sc1
  v_max_f32 v36, v36, v29
  v_max_f32 v37, v37, v29
  v_mfma_f32_16x16x32_bf16 v[48:51], a[80:83], v[120:123], v[48:51]
  v_max_f32 v38, v38, v29
  v_max_f32 v39, v39, v29
  v_fma_f32 v36, v168, v30, v36
  v_fma_f32 v37, v169, v30, v37
  v_mfma_f32_16x16x32_bf16 v[52:55], a[84:87], v[120:123], v[52:55]
  v_fma_f32 v38, v170, v30, v38
  v_fma_f32 v39, v171, v30, v39
  v_mfma_f32_16x16x32_bf16 v[56:59], a[88:91], v[120:123], v[56:59]
  v_mfma_f32_16x16x32_bf16 v[60:63], a[92:95], v[120:123], v[60:63]
  buffer_load_dwordx4 v[120:123], v1, s[32:35], s80 offen offset:1024 sc1
  s_waitcnt vmcnt(29)
  v_mfma_f32_16x16x32_bf16 v[48:51], a[96:99], v[124:127], v[48:51]
  s_waitcnt lgkmcnt(0)
  s_cmp_lt_u32 s26, 2
  s_cbranch_scc0 Lp2_7
  s_lshl_b32 s57, s26, 10
  s_add_u32 s57, s57, 8192
  v_add_u32 v27, s57, v1
  v_cvt_pk_bf16_f32 v4, v32, v33
  v_cvt_pk_bf16_f32 v5, v34, v35
  v_cvt_pk_bf16_f32 v6, v36, v37
  v_cvt_pk_bf16_f32 v7, v38, v39
  ds_write_b128 v27, v[4:7]
  s_waitcnt lgkmcnt(0)
  s_branch Lp2_8
Lp2_7:
  s_mov_b32 s56, 4
  s_and_b32 s59, s26, 1
  s_lshl_b32 s59, s59, 1
  s_lshl_b32 s57, s56, 5
  s_add_u32 s57, s57, 86016
  s_mul_i32 s58, s59, 3328
  s_add_u32 s57, s57, s58
  v_mul_u32_u24 v27, 832, v3
  v_lshl_add_u32 v27, v2, 1, v27
  v_add_u32 v27, s57, v27
  v_cvt_pk_bf16_f32 v4, v32, v33
  v_cvt_pk_bf16_f32 v5, v34, v35
  ds_write_b16 v27, v4 offset:0
  ds_write_b16_d16_hi v27, v4 offset:208
  ds_write_b16 v27, v5 offset:416
  ds_write_b16_d16_hi v27, v5 offset:624
  v_cvt_pk_bf16_f32 v4, v36, v37
  v_cvt_pk_bf16_f32 v5, v38, v39
  ds_write_b16 v27, v4 offset:3328
  ds_write_b16_d16_hi v27, v4 offset:3536
  ds_write_b16 v27, v5 offset:3744
  ds_write_b16_d16_hi v27, v5 offset:3952
  s_waitcnt lgkmcnt(0)
Lp2_8:
  s_barrier
  v_mfma_f32_16x16x32_bf16 v[52:55], a[100:103], v[124:127], v[52:55]
  v_mfma_f32_16x16x32_bf16 v[56:59], a[104:107], v[124:127], v[56:59]
  v_mfma_f32_16x16x32_bf16 v[60:63], a[108:111], v[124:127], v[60:63]
  buffer_load_dwordx4 v[124:127], v1, s[32:35], s80 offen offset:2048 sc1
  s_lshl_b32 s56, s26, 11
  s_add_u32 s56, s56, 0
  v_add_u32 v28, s56, v1
  v_mov_b32 v24, s84
  v_mov_b32 v25, s84
  v_mov_b32 v26, s84
  v_mov_b32 v27, s84
  ds_read_b128 v[144:147], v28 offset:0
  ds_read_b128 v[148:151], v28 offset:2048
  ds_read_b128 v[12:15], v28 offset:8192
  ds_read_b128 v[20:23], v28 offset:10240
  v_mfma_f32_16x16x32_bf16 v[48:51], a[112:115], v[196:199], v[48:51]
  v_mfma_f32_16x16x32_bf16 v[52:55], a[116:119], v[196:199], v[52:55]
  v_mfma_f32_16x16x32_bf16 v[56:59], a[120:123], v[196:199], v[56:59]
  v_mfma_f32_16x16x32_bf16 v[60:63], a[124:127], v[196:199], v[60:63]
  buffer_load_dwordx4 v[196:199], v1, s[32:35], s80 offen offset:3072 sc1
  s_waitcnt vmcnt(29)
  v_mfma_f32_16x16x32_bf16 v[48:51], a[128:131], v[128:131], v[48:51]
  v_mfma_f32_16x16x32_bf16 v[52:55], a[132:135], v[128:131], v[52:55]
  v_mfma_f32_16x16x32_bf16 v[56:59], a[136:139], v[128:131], v[56:59]
  s_waitcnt lgkmcnt(0)
  v_mfma_f32_16x16x32_bf16 v[32:35], v[144:147], v[12:15], 0
  v_mfma_f32_16x16x32_bf16 v[36:39], v[144:147], v[20:23], 0
  v_mfma_f32_16x16x32_bf16 v[4:7], v[144:147], v[24:27], 0
  v_mfma_f32_16x16x32_bf16 v[40:43], v[148:151], v[12:15], 0
  v_mfma_f32_16x16x32_bf16 v[44:47], v[148:151], v[20:23], 0
  v_mfma_f32_16x16x32_bf16 v[8:11], v[148:151], v[24:27], 0
  ds_read_b128 v[144:147], v28 offset:1024
  ds_read_b128 v[148:151], v28 offset:3072
  ds_read_b128 v[12:15], v28 offset:9216
  ds_read_b128 v[20:23], v28 offset:11264
  v_mfma_f32_16x16x32_bf16 v[60:63], a[140:143], v[128:131], v[60:63]
  s_add_u32 s80, s80, 4096
  buffer_load_dwordx4 v[128:131], v1, s[32:35], s80 offen offset:0 sc1
  v_mfma_f32_16x16x32_bf16 v[48:51], a[144:147], v[132:135], v[48:51]
  v_mfma_f32_16x16x32_bf16 v[52:55], a[148:151], v[132:135], v[52:55]
  v_mfma_f32_16x16x32_bf16 v[56:59], a[152:155], v[132:135], v[56:59]
  v_mfma_f32_16x16x32_bf16 v[60:63], a[156:159], v[132:135], v[60:63]
  buffer_load_dwordx4 v[132:135], v1, s[32:35], s80 offen offset:1024 sc1
  s_waitcnt vmcnt(29)
  v_mfma_f32_16x16x32_bf16 v[48:51], a[160:163], v[200:203], v[48:51]
  v_mfma_f32_16x16x32_bf16 v[52:55], a[164:167], v[200:203], v[52:55]
  v_mfma_f32_16x16x32_bf16 v[56:59], a[168:171], v[200:203], v[56:59]
  s_waitcnt lgkmcnt(0)
  v_mfma_f32_16x16x32_bf16 v[32:35], v[144:147], v[12:15], v[32:35]
  v_mfma_f32_16x16x32_bf16 v[36:39], v[144:147], v[20:23], v[36:39]
  v_mfma_f32_16x16x32_bf16 v[4:7], v[144:147], v[24:27], v[4:7]
  v_mfma_f32_16x16x32_bf16 v[40:43], v[148:151], v[12:15], v[40:43]
  v_mfma_f32_16x16x32_bf16 v[44:47], v[148:151], v[20:23], v[44:47]
  v_mfma_f32_16x16x32_bf16 v[8:11], v[148:151], v[24:27], v[8:11]
  v_mfma_f32_16x16x32_bf16 v[60:63], a[172:175], v[200:203], v[60:63]
  buffer_load_dwordx4 v[200:203], v1, s[32:35], s80 offen offset:2048 sc1
  v_mfma_f32_16x16x32_bf16 v[48:51], a[176:179], v[136:139], v[48:51]
  v_mfma_f32_16x16x32_bf16 v[52:55], a[180:183], v[136:139], v[52:55]
  v_mfma_f32_16x16x32_bf16 v[56:59], a[184:187], v[136:139], v[56:59]
  v_mfma_f32_16x16x32_bf16 v[60:63], a[188:191], v[136:139], v[60:63]
  buffer_load_dwordx4 v[136:139], v1, s[32:35], s80 offen offset:3072 sc1
  s_waitcnt vmcnt(29)
  v_mfma_f32_16x16x32_bf16 v[48:51], a[192:195], v[140:143], v[48:51]
  s_mul_i32 s56, s26, 1440
  s_add_u32 s60, s56, 151552
  s_lshl_b32 s57, s26, 1
  v_lshlrev_b32 v20, 2, v3
  v_subrev_u32 v20, s57, v20
  v_mul_i32_i24 v21, 80, v20
  v_add_u32 v21, s60, v21
  v_subrev_u32 v24, s57, v2
  v_add_u32 v22, 4294967288, v24
  v_cmp_gt_u32 s[62:63], 18, v22
  v_lshl_add_u32 v22, v22, 2, v21
  v_add_u32 v23, 8, v24
  v_cmp_gt_u32 s[64:65], 18, v23
  v_lshl_add_u32 v23, v23, 2, v21
  v_cmp_eq_u32 s[66:67], 0, v2
  v_add_u32 v24, 72, v21
  v_mfma_f32_16x16x32_bf16 v[52:55], a[196:199], v[140:143], v[52:55]
  v_mfma_f32_16x16x32_bf16 v[56:59], a[200:203], v[140:143], v[56:59]
  v_mfma_f32_16x16x32_bf16 v[60:63], a[204:207], v[140:143], v[60:63]
  s_add_u32 s80, s80, 4096
  buffer_load_dwordx4 v[140:143], v1, s[32:35], s80 offen offset:0 sc1
  v_add_u32 v25, 0, v20
  v_cmp_gt_u32 s[68:69], 18, v25
  s_nop 0
  s_and_b64 exec, s[68:69], s[62:63]
  ds_write_b32 v22, v32 offset:0
  s_and_b64 exec, s[68:69], s[64:65]
  ds_write_b32 v23, v36 offset:0
  s_and_b64 exec, s[68:69], s[66:67]
  ds_write_b32 v24, v4 offset:0
  s_mov_b64 exec, -1
  v_mfma_f32_16x16x32_bf16 v[48:51], a[208:211], v[204:207], v[48:51]
  v_mfma_f32_16x16x32_bf16 v[52:55], a[212:215], v[204:207], v[52:55]
  v_mfma_f32_16x16x32_bf16 v[56:59], a[216:219], v[204:207], v[56:59]
  v_add_u32 v25, 1, v20
  v_cmp_gt_u32 s[68:69], 18, v25
  s_nop 0
  s_and_b64 exec, s[68:69], s[62:63]
  ds_write_b32 v22, v33 offset:80
  s_and_b64 exec, s[68:69], s[64:65]
  ds_write_b32 v23, v37 offset:80
  s_and_b64 exec, s[68:69], s[66:67]
  ds_write_b32 v24, v5 offset:80
  s_mov_b64 exec, -1
  v_mfma_f32_16x16x32_bf16 v[60:63], a[220:223], v[204:207], v[60:63]
  buffer_load_dwordx4 v[204:207], v1, s[32:35], s80 offen offset:1024 sc1
  s_waitcnt vmcnt(29)
  v_mfma_f32_16x16x32_bf16 v[48:51], a[224:227], v[208:211], v[48:51]
  v_mfma_f32_16x16x32_bf16 v[52:55], a[228:231], v[208:211], v[52:55]
  v_add_u32 v25, 2, v20
  v_cmp_gt_u32 s[68:69], 18, v25
  s_nop 0
  s_and_b64 exec, s[68:69], s[62:63]
  ds_write_b32 v22, v34 offset:160
  s_and_b64 exec, s[68:69], s[64:65]
  ds_write_b32 v23, v38 offset:160
  s_and_b64 exec, s[68:69], s[66:67]
  ds_write_b32 v24, v6 offset:160
  s_mov_b64 exec, -1
  v_mfma_f32_16x16x32_bf16 v[56:59], a[232:235], v[208:211], v[56:59]
  v_mfma_f32_16x16x32_bf16 v[60:63], a[236:239], v[208:211], v[60:63]
  buffer_load_dwordx4 v[208:211], v1, s[32:35], s80 offen offset:2048 sc1
  v_add_u32 v25, 3, v20
  v_cmp_gt_u32 s[68:69], 18, v25
  s_nop 0
  s_and_b64 exec, s[68:69], s[62:63]
  ds_write_b32 v22, v35 offset:240
  s_and_b64 exec, s[68:69], s[64:65]
  ds_write_b32 v23, v39 offset:240
  s_and_b64 exec, s[68:69], s[66:67]
  ds_write_b32 v24, v7 offset:240
  s_mov_b64 exec, -1
  v_mfma_f32_16x16x32_bf16 v[48:51], a[240:243], v[212:215], v[48:51]
  v_mfma_f32_16x16x32_bf16 v[52:55], a[244:247], v[212:215], v[52:55]
  v_mfma_f32_16x16x32_bf16 v[56:59], a[248:251], v[212:215], v[56:59]
  v_add_u32 v25, 16, v20
  v_cmp_gt_u32 s[68:69], 18, v25
  s_nop 0
  s_and_b64 exec, s[68:69], s[62:63]
  ds_write_b32 v22, v40 offset:1280
  s_and_b64 exec, s[68:69], s[64:65]
  ds_write_b32 v23, v44 offset:1280
  s_and_b64 exec, s[68:69], s[66:67]
  ds_write_b32 v24, v8 offset:1280
  s_mov_b64 exec, -1
  v_mfma_f32_16x16x32_bf16 v[60:63], a[252:255], v[212:215], v[60:63]
  buffer_load_dwordx4 v[212:215], v1, s[32:35], s80 offen offset:3072 sc1
  s_waitcnt vmcnt(29)
  v_mfma_f32_16x16x32_bf16 v[48:51], v[224:227], v[64:67], v[48:51]
  v_mfma_f32_16x16x32_bf16 v[52:55], v[228:231], v[64:67], v[52:55]
  v_add_u32 v25, 17, v20
  v_cmp_gt_u32 s[68:69], 18, v25
  s_nop 0
  s_and_b64 exec, s[68:69], s[62:63]
  ds_write_b32 v22, v41 offset:1360
  s_and_b64 exec, s[68:69], s[64:65]
  ds_write_b32 v23, v45 offset:1360
  s_and_b64 exec, s[68:69], s[66:67]
  ds_write_b32 v24, v9 offset:1360
  s_mov_b64 exec, -1
  v_mfma_f32_16x16x32_bf16 v[56:59], v[232:235], v[64:67], v[56:59]
  v_mfma_f32_16x16x32_bf16 v[60:63], v[236:239], v[64:67], v[60:63]
  s_add_u32 s80, s80, 4096
  buffer_load_dwordx4 v[64:67], v1, s[32:35], s80 offen offset:0 sc1
  v_add_u32 v25, 18, v20
  v_cmp_gt_u32 s[68:69], 18, v25
  s_nop 0
  s_and_b64 exec, s[68:69], s[62:63]
  ds_write_b32 v22, v42 offset:1440
  s_and_b64 exec, s[68:69], s[64:65]
  ds_write_b32 v23, v46 offset:1440
  s_and_b64 exec, s[68:69], s[66:67]
  ds_write_b32 v24, v10 offset:1440
  s_mov_b64 exec, -1
  v_mfma_f32_16x16x32_bf16 v[48:51], v[240:243], v[68:71], v[48:51]
  v_mfma_f32_16x16x32_bf16 v[52:55], v[244:247], v[68:71], v[52:55]
  v_mfma_f32_16x16x32_bf16 v[56:59], v[248:251], v[68:71], v[56:59]
  v_add_u32 v25, 19, v20
  v_cmp_gt_u32 s[68:69], 18, v25
  s_nop 0
  s_and_b64 exec, s[68:69], s[62:63]
  ds_write_b32 v22, v43 offset:1520
  s_and_b64 exec, s[68:69], s[64:65]
  ds_write_b32 v23, v47 offset:1520
  s_and_b64 exec, s[68:69], s[66:67]
  ds_write_b32 v24, v11 offset:1520
  s_mov_b64 exec, -1
  v_mfma_f32_16x16x32_bf16 v[60:63], v[252:255], v[68:71], v[60:63]
  buffer_load_dwordx4 v[68:71], v1, s[32:35], s80 offen offset:1024 sc1
  s_mov_b32 s82, 0x3eeff558
  v_mov_b32 v16, 0x409d30fc
  s_lshl_b32 s56, s26, 6
  s_add_u32 s56, s56, 159744
  v_lshlrev_b32 v17, 4, v3
  v_add_u32 v17, s56, v17
  s_lshl_b32 s56, s26, 12
  s_add_u32 s56, s56, 0
  v_add_u32 v18, s56, v1
  s_lshr_b32 s56, s26, 1
  s_lshl_b32 s56, s56, 12
  s_and_b32 s57, s26, 1
  s_lshl_b32 s57, s57, 3
  s_add_u32 s56, s56, s57
  s_add_u32 s56, s56, 65536
  v_add_u32 v19, s56, v1
  ds_read_b128 v[144:147], v17
  s_waitcnt lgkmcnt(0)
  s_waitcnt vmcnt(29)
  v_mfma_f32_16x16x32_bf16 v[32:35], v[72:75], a[0:3], v[144:147]
  v_mfma_f32_16x16x32_bf16 v[36:39], v[72:75], a[4:7], v[144:147]
  v_mfma_f32_16x16x32_bf16 v[40:43], v[72:75], a[8:11], v[144:147]
  v_mfma_f32_16x16x32_bf16 v[44:47], v[72:75], a[12:15], v[144:147]
  buffer_load_dwordx4 v[72:75], v1, s[32:35], s80 offen offset:2048 sc1
  v_mfma_f32_16x16x32_bf16 v[32:35], v[76:79], a[16:19], v[32:35]
  ds_read_b128 v[148:151], v17 offset:256
  s_lshl_b32 s52, s27, 12
  s_add_u32 s52, s52, 35946496
  v_lshlrev_b32 v22, 3, v1
  v_and_b32 v22, 0xf80, v22
  buffer_load_dword v20, v22, s[32:35], s52 offen sc1
  v_mfma_f32_16x16x32_bf16 v[36:39], v[76:79], a[20:23], v[36:39]
  v_mfma_f32_16x16x32_bf16 v[40:43], v[76:79], a[24:27], v[40:43]
  s_mov_b32 s56, 0
  s_lshl_b32 s57, s56, 4
  v_add_u32 v27, s57, v2
  v_cmp_gt_u32 vcc, 72, v27
  v_mov_b32 v28, 0x358637bd
  v_mov_b32 v29, 0xff7fffff
  v_mov_b32 v27, 0x358637bd
  v_cndmask_b32 v28, 0, v28, vcc
  v_cndmask_b32 v29, v29, v27, vcc
  v_cndmask_b32 v30, 0, 1.0, vcc
  v_mfma_f32_16x16x32_bf16 v[44:47], v[76:79], a[28:31], v[44:47]
  buffer_load_dwordx4 v[76:79], v1, s[32:35], s80 offen offset:3072 sc1
  s_waitcnt vmcnt(30)
  v_mfma_f32_16x16x32_bf16 v[32:35], v[80:83], a[32:35], v[32:35]
  v_mfma_f32_16x16x32_bf16 v[36:39], v[80:83], a[36:39], v[36:39]
  v_fma_f32 v48, v48, v152, v28
  v_fma_f32 v49, v49, v153, v28
  v_mfma_f32_16x16x32_bf16 v[40:43], v[80:83], a[40:43], v[40:43]
  v_fma_f32 v50, v50, v154, v28
  v_fma_f32 v51, v51, v155, v28
  v_mul_f32 v168, s83, v48
  v_mfma_f32_16x16x32_bf16 v[44:47], v[80:83], a[44:47], v[44:47]
  s_add_u32 s80, s80, 4096
  buffer_load_dwordx4 v[80:83], v1, s[32:35], s80 offen offset:0 sc1
  v_mfma_f32_16x16x32_bf16 v[32:35], v[84:87], a[48:51], v[32:35]
  v_mul_f32 v169, s83, v49
  v_mul_f32 v170, s83, v50
  v_mul_f32 v171, s83, v51
  v_mfma_f32_16x16x32_bf16 v[36:39], v[84:87], a[52:55], v[36:39]
  v_exp_f32_e64 v168, v168 clamp
  v_exp_f32_e64 v169, v169 clamp
  v_mfma_f32_16x16x32_bf16 v[40:43], v[84:87], a[56:59], v[40:43]
  v_exp_f32_e64 v170, v170 clamp
  v_mfma_f32_16x16x32_bf16 v[44:47], v[84:87], a[60:63], v[44:47]
  buffer_load_dwordx4 v[84:87], v1, s[32:35], s80 offen offset:1024 sc1
  s_waitcnt vmcnt(30)
  v_mfma_f32_16x16x32_bf16 v[32:35], v[176:179], a[64:67], v[32:35]
  v_exp_f32_e64 v171, v171 clamp
  v_max_f32 v48, v48, v29
  v_mfma_f32_16x16x32_bf16 v[36:39], v[176:179], a[68:71], v[36:39]
  v_max_f32 v49, v49, v29
  v_max_f32 v50, v50, v29
  v_max_f32 v51, v51, v29
  v_mfma_f32_16x16x32_bf16 v[40:43], v[176:179], a[72:75], v[40:43]
  v_fma_f32 v48, v168, v30, v48
  v_fma_f32 v49, v169, v30, v49
  v_fma_f32 v50, v170, v30, v50
  v_mfma_f32_16x16x32_bf16 v[44:47], v[176:179], a[76:79], v[44:47]
  buffer_load_dwordx4 v[176:179], v1, s[32:35], s80 offen offset:2048 sc1
  v_fma_f32 v51, v171, v30, v51
  v_mfma_f32_16x16x32_bf16 v[32:35], v[88:91], a[80:83], v[32:35]
  v_fma_f32 v52, v52, v156, v28
  v_fma_f32 v53, v53, v157, v28
  v_fma_f32 v54, v54, v158, v28
  v_mfma_f32_16x16x32_bf16 v[36:39], v[88:91], a[84:87], v[36:39]
  v_fma_f32 v55, v55, v159, v28
  v_mul_f32 v168, s83, v52
  v_mul_f32 v169, s83, v53
  v_mfma_f32_16x16x32_bf16 v[40:43], v[88:91], a[88:91], v[40:43]
  v_mul_f32 v170, s83, v54
  v_mul_f32 v171, s83, v55
  v_mfma_f32_16x16x32_bf16 v[44:47], v[88:91], a[92:95], v[44:47]
  buffer_load_dwordx4 v[88:91], v1, s[32:35], s80 offen offset:3072 sc1
  s_waitcnt vmcnt(30)
  v_mfma_f32_16x16x32_bf16 v[32:35], v[92:95], a[96:99], v[32:35]
  v_exp_f32_e64 v168, v168 clamp
  v_exp_f32_e64 v169, v169 clamp
  v_mfma_f32_16x16x32_bf16 v[36:39], v[92:95], a[100:103], v[36:39]
  v_exp_f32_e64 v170, v170 clamp
  v_mfma_f32_16x16x32_bf16 v[40:43], v[92:95], a[104:107], v[40:43]
  v_exp_f32_e64 v171, v171 clamp
  v_max_f32 v52, v52, v29
  v_max_f32 v53, v53, v29
  v_mfma_f32_16x16x32_bf16 v[44:47], v[92:95], a[108:111], v[44:47]
  s_add_u32 s80, s80, 4096
  buffer_load_dwordx4 v[92:95], v1, s[32:35], s80 offen offset:0 sc1
  v_mfma_f32_16x16x32_bf16 v[32:35], v[180:183], a[112:115], v[32:35]
  v_max_f32 v54, v54, v29
  v_max_f32 v55, v55, v29
  v_fma_f32 v52, v168, v30, v52
  v_mfma_f32_16x16x32_bf16 v[36:39], v[180:183], a[116:119], v[36:39]
  v_fma_f32 v53, v169, v30, v53
  v_fma_f32 v54, v170, v30, v54
  v_fma_f32 v55, v171, v30, v55
  v_mfma_f32_16x16x32_bf16 v[40:43], v[180:183], a[120:123], v[40:43]
  v_fma_f32 v56, v56, v160, v28
  v_fma_f32 v57, v57, v161, v28
  v_fma_f32 v58, v58, v162, v28
  v_mfma_f32_16x16x32_bf16 v[44:47], v[180:183], a[124:127], v[44:47]
  buffer_load_dwordx4 v[180:183], v1, s[32:35], s80 offen offset:1024 sc1
  s_waitcnt vmcnt(30)
  v_mfma_f32_16x16x32_bf16 v[32:35], v[96:99], a[128:131], v[32:35]
  v_fma_f32 v59, v59, v163, v28
  v_mul_f32 v168, s83, v56
  v_mul_f32 v169, s83, v57
  v_mfma_f32_16x16x32_bf16 v[36:39], v[96:99], a[132:135], v[36:39]
  v_mul_f32 v170, s83, v58
  v_mul_f32 v171, s83, v59
  v_mfma_f32_16x16x32_bf16 v[40:43], v[96:99], a[136:139], v[40:43]
  v_exp_f32_e64 v168, v168 clamp
  v_exp_f32_e64 v169, v169 clamp
  v_mfma_f32_16x16x32_bf16 v[44:47], v[96:99], a[140:143], v[44:47]
  buffer_load_dwordx4 v[96:99], v1, s[32:35], s80 offen offset:2048 sc1
  v_mfma_f32_16x16x32_bf16 v[32:35], v[100:103], a[144:147], v[32:35]
  v_exp_f32_e64 v170, v170 clamp
  v_exp_f32_e64 v171, v171 clamp
  v_mfma_f32_16x16x32_bf16 v[36:39], v[100:103], a[148:151], v[36:39]
  v_max_f32 v56, v56, v29
  v_max_f32 v57, v57, v29
  v_mfma_f32_16x16x32_bf16 v[40:43], v[100:103], a[152:155], v[40:43]
  v_max_f32 v58, v58, v29
  v_max_f32 v59, v59, v29
  v_fma_f32 v56, v168, v30, v56
  v_mfma_f32_16x16x32_bf16 v[44:47], v[100:103], a[156:159], v[44:47]
  buffer_load_dwordx4 v[100:103], v1, s[32:35], s80 offen offset:3072 sc1
  s_waitcnt vmcnt(30)
  v_mfma_f32_16x16x32_bf16 v[32:35], v[184:187], a[160:163], v[32:35]
  v_fma_f32 v57, v169, v30, v57
  v_fma_f32 v58, v170, v30, v58
  v_fma_f32 v59, v171, v30, v59
  v_mfma_f32_16x16x32_bf16 v[36:39], v[184:187], a[164:167], v[36:39]
  v_fma_f32 v60, v60, v164, v28
  v_fma_f32 v61, v61, v165, v28
  v_fma_f32 v62, v62, v166, v28
  v_mfma_f32_16x16x32_bf16 v[40:43], v[184:187], a[168:171], v[40:43]
  v_fma_f32 v63, v63, v167, v28
  v_mul_f32 v168, s83, v60
  v_mul_f32 v169, s83, v61
  v_mfma_f32_16x16x32_bf16 v[44:47], v[184:187], a[172:175], v[44:47]
  s_add_u32 s80, s80, 4096
  buffer_load_dwordx4 v[184:187], v1, s[32:35], s80 offen offset:0 sc1
  v_mfma_f32_16x16x32_bf16 v[32:35], v[104:107], a[176:179], v[32:35]
  v_mul_f32 v170, s83, v62
  v_mul_f32 v171, s83, v63
  v_exp_f32_e64 v168, v168 clamp
  v_mfma_f32_16x16x32_bf16 v[36:39], v[104:107], a[180:183], v[36:39]
  v_exp_f32_e64 v169, v169 clamp
  v_mfma_f32_16x16x32_bf16 v[40:43], v[104:107], a[184:187], v[40:43]
  v_exp_f32_e64 v170, v170 clamp
  v_exp_f32_e64 v171, v171 clamp
  v_mfma_f32_16x16x32_bf16 v[44:47], v[104:107], a[188:191], v[44:47]
  buffer_load_dwordx4 v[104:107], v1, s[32:35], s80 offen offset:1024 sc1
  s_waitcnt vmcnt(29)
  v_mfma_f32_16x16x32_bf16 v[32:35], v[108:111], a[192:195], v[32:35]
  v_max_f32 v60, v60, v29
  v_max_f32 v61, v61, v29
  v_mfma_f32_16x16x32_bf16 v[36:39], v[108:111], a[196:199], v[36:39]
  v_max_f32 v62, v62, v29
  v_max_f32 v63, v63, v29
  v_fma_f32 v60, v168, v30, v60
  v_mfma_f32_16x16x32_bf16 v[40:43], v[108:111], a[200:203], v[40:43]
  v_fma_f32 v61, v169, v30, v61
  v_fma_f32 v62, v170, v30, v62
  v_fma_f32 v63, v171, v30, v63
  v_mfma_f32_16x16x32_bf16 v[44:47], v[108:111], a[204:207], v[44:47]
  buffer_load_dwordx4 v[108:111], v1, s[32:35], s80 offen offset:2048 sc1
  v_mfma_f32_16x16x32_bf16 v[32:35], v[188:191], a[208:211], v[32:35]
  s_mov_b32 s56, s26
  s_lshl_b32 s57, s56, 5
  s_add_u32 s57, s57, 86016
  v_mul_u32_u24 v27, 832, v3
  v_lshl_add_u32 v27, v2, 1, v27
  v_add_u32 v27, s57, v27
  v_mfma_f32_16x16x32_bf16 v[36:39], v[188:191], a[212:215], v[36:39]
  v_cvt_pk_bf16_f32 v4, v48, v49
  v_mfma_f32_16x16x32_bf16 v[40:43], v[188:191], a[216:219], v[40:43]
  v_cvt_pk_bf16_f32 v5, v50, v51
  ds_write_b16 v27, v4 offset:0
  v_mfma_f32_16x16x32_bf16 v[44:47], v[188:191], a[220:223], v[44:47]
  buffer_load_dwordx4 v[188:191], v1, s[32:35], s80 offen offset:3072 sc1
  s_waitcnt vmcnt(29)
  v_mfma_f32_16x16x32_bf16 v[32:35], v[112:115], a[224:227], v[32:35]
  ds_write_b16_d16_hi v27, v4 offset:208
  ds_write_b16 v27, v5 offset:416
  v_mfma_f32_16x16x32_bf16 v[36:39], v[112:115], a[228:231], v[36:39]
  ds_write_b16_d16_hi v27, v5 offset:624
  v_cvt_pk_bf16_f32 v4, v52, v53
  v_cvt_pk_bf16_f32 v5, v54, v55
  v_mfma_f32_16x16x32_bf16 v[40:43], v[112:115], a[232:235], v[40:43]
  ds_write_b16 v27, v4 offset:3328
  ds_write_b16_d16_hi v27, v4 offset:3536
  v_mfma_f32_16x16x32_bf16 v[44:47], v[112:115], a[236:239], v[44:47]
  s_add_u32 s80, s80, 4096
  buffer_load_dwordx4 v[112:115], v1, s[32:35], s80 offen offset:0 sc1
  v_mfma_f32_16x16x32_bf16 v[32:35], v[116:119], a[240:243], v[32:35]
  ds_write_b16 v27, v5 offset:3744
  ds_write_b16_d16_hi v27, v5 offset:3952
  v_mfma_f32_16x16x32_bf16 v[36:39], v[116:119], a[244:247], v[36:39]
  v_cvt_pk_bf16_f32 v4, v56, v57
  v_cvt_pk_bf16_f32 v5, v58, v59
  ds_write_b16 v27, v4 offset:6656
  v_mfma_f32_16x16x32_bf16 v[40:43], v[116:119], a[248:251], v[40:43]
  ds_write_b16_d16_hi v27, v4 offset:6864
  ds_write_b16 v27, v5 offset:7072
  v_mfma_f32_16x16x32_bf16 v[44:47], v[116:119], a[252:255], v[44:47]
  buffer_load_dwordx4 v[116:119], v1, s[32:35], s80 offen offset:1024 sc1
  s_waitcnt vmcnt(29)
  v_mfma_f32_16x16x32_bf16 v[32:35], v[192:195], v[224:227], v[32:35]
  ds_write_b16_d16_hi v27, v5 offset:7280
  v_cvt_pk_bf16_f32 v4, v60, v61
  v_mfma_f32_16x16x32_bf16 v[36:39], v[192:195], v[228:231], v[36:39]
  v_cvt_pk_bf16_f32 v5, v62, v63
  ds_write_b16 v27, v4 offset:9984
  v_mfma_f32_16x16x32_bf16 v[40:43], v[192:195], v[232:235], v[40:43]
  ds_write_b16_d16_hi v27, v4 offset:10192
  ds_write_b16 v27, v5 offset:10400
  v_mfma_f32_16x16x32_bf16 v[44:47], v[192:195], v[236:239], v[44:47]
  buffer_load_dwordx4 v[192:195], v1, s[32:35], s80 offen offset:2048 sc1
  v_mfma_f32_16x16x32_bf16 v[32:35], v[120:123], v[240:243], v[32:35]
  ds_write_b16_d16_hi v27, v5 offset:10608
  v_mfma_f32_16x16x32_bf16 v[36:39], v[120:123], v[244:247], v[36:39]
  s_waitcnt vmcnt(16)
  s_cmp_eq_u32 s26, 0
  s_cbranch_scc0 Lok_9
  s_mov_b32 s53, 200000
Lsp_10:
  v_cmp_ne_u32 vcc, s29, v20
  s_nop 1
  s_cmp_eq_u64 vcc, 0
  s_cbranch_scc1 Lok_9
  s_sub_u32 s53, s53, 1
  s_cbranch_scc1 Lok_9
  s_sleep 2
  s_lshl_b32 s52, s27, 12
  s_add_u32 s52, s52, 35946496
  buffer_load_dword v20, v22, s[32:35], s52 offen sc1
  s_waitcnt vmcnt(0)
  s_branch Lsp_10
Lok_9:
  s_barrier
  v_mfma_f32_16x16x32_bf16 v[40:43], v[120:123], v[248:251], v[40:43]
  v_mfma_f32_16x16x32_bf16 v[44:47], v[120:123], v[252:255], v[44:47]
  buffer_load_dwordx4 v[120:123], v1, s[32:35], s80 offen offset:3072 sc1
  s_mov_b32 s44, s16
  s_mov_b32 s45, s17
  s_mov_b32 s46, 5308416
  s_mov_b32 s47, 0x20000
  s_mul_i32 s72, s26, 8192
  s_add_u32 s72, s72, 49152
  s_mov_b32 m0, s72
  s_add_u32 s72, s72, 1024
  buffer_load_dwordx4 v216, s[44:47], 0 offen lds
  s_mov_b32 m0, s72
  s_add_u32 s72, s72, 1024
  buffer_load_dwordx4 v217, s[44:47], 0 offen lds
  s_mov_b32 m0, s72
  s_add_u32 s72, s72, 1024
  buffer_load_dwordx4 v218, s[44:47], 0 offen lds
  s_mov_b32 m0, s72
  s_add_u32 s72, s72, 1024
  buffer_load_dwordx4 v219, s[44:47], 0 offen lds
  s_mov_b32 s36, s98
  s_mov_b32 s37, s99
  s_mov_b32 s38, s100
  s_mov_b32 s39, 0x20000
  s_mul_i32 s72, s26, 8192
  s_add_u32 s72, s72, 53248
  s_mov_b32 m0, s72
  s_add_u32 s72, s72, 1024
  buffer_load_dwordx4 v220, s[36:39], 0 offen lds
  s_mov_b32 m0, s72
  s_add_u32 s72, s72, 1024
  buffer_load_dwordx4 v221, s[36:39], 0 offen lds
  s_mov_b32 m0, s72
  s_add_u32 s72, s72, 1024
  buffer_load_dwordx4 v222, s[36:39], 0 offen lds
  s_mov_b32 m0, s72
  s_add_u32 s72, s72, 1024
  buffer_load_dwordx4 v223, s[36:39], 0 offen lds
  s_waitcnt lgkmcnt(0)
  s_barrier
  s_lshl_b32 s56, s27, 13
  s_add_u32 s56, s56, 37748736
  s_add_u32 s48, s24, s56
  s_addc_u32 s49, s25, 0
  s_mov_b32 s50, 5760
  s_mov_b32 s51, 0x20000
  v_lshlrev_b32 v20, 2, v0
  v_add_u32 v21, 151552, v20
  v_add_u32 v22, 4096, v20
  ds_read_b32 v4, v21 offset:0
  ds_read_b32 v5, v21 offset:1024
  ds_read_b32 v6, v21 offset:2048
  ds_read_b32 v7, v21 offset:3072
  ds_read_b32 v8, v21 offset:4096
  ds_read_b32 v9, v21 offset:5120
  s_waitcnt lgkmcnt(5)
  buffer_atomic_add_f32 v4, v20, s[48:51], 0 offen offset:0
  s_waitcnt lgkmcnt(4)
  buffer_atomic_add_f32 v5, v20, s[48:51], 0 offen offset:1024
  s_waitcnt lgkmcnt(3)
  buffer_atomic_add_f32 v6, v20, s[48:51], 0 offen offset:2048
  s_waitcnt lgkmcnt(2)
  buffer_atomic_add_f32 v7, v20, s[48:51], 0 offen offset:3072
  s_waitcnt lgkmcnt(1)
  buffer_atomic_add_f32 v8, v22, s[48:51], 0 offen offset:0
  s_waitcnt lgkmcnt(0)
  buffer_atomic_add_f32 v9, v22, s[48:51], 0 offen offset:1024
  v_mfma_f32_16x16x32_bf16 v[48:51], v[124:127], a[0:3], v[148:151]
  v_mfma_f32_16x16x32_bf16 v[52:55], v[124:127], a[4:7], v[148:151]
  v_mfma_f32_16x16x32_bf16 v[56:59], v[124:127], a[8:11], v[148:151]
  v_mfma_f32_16x16x32_bf16 v[60:63], v[124:127], a[12:15], v[148:151]
  v_mfma_f32_16x16x32_bf16 v[48:51], v[196:199], a[16:19], v[48:51]
  ds_read_b128 v[144:147], v17 offset:512
  v_fma_f32 v4, v32, v32, v16
  v_fma_f32 v5, v33, v33, v16
  v_mfma_f32_16x16x32_bf16 v[52:55], v[196:199], a[20:23], v[52:55]
  v_fma_f32 v6, v34, v34, v16
  v_fma_f32 v7, v35, v35, v16
  v_mfma_f32_16x16x32_bf16 v[56:59], v[196:199], a[24:27], v[56:59]
  v_mul_f32 v4, v4, v32
  v_mul_f32 v5, v5, v33
  v_mul_f32 v6, v6, v34
  v_mfma_f32_16x16x32_bf16 v[60:63], v[196:199], a[28:31], v[60:63]
  v_mfma_f32_16x16x32_bf16 v[48:51], v[128:131], a[32:35], v[48:51]
  v_mul_f32 v7, v7, v35
  v_exp_f32_e64 v4, -v4
  v_mfma_f32_16x16x32_bf16 v[52:55], v[128:131], a[36:39], v[52:55]
  v_exp_f32_e64 v5, -v5
  v_mfma_f32_16x16x32_bf16 v[56:59], v[128:131], a[40:43], v[56:59]
  v_exp_f32_e64 v6, -v6
  v_exp_f32_e64 v7, -v7
  v_mfma_f32_16x16x32_bf16 v[60:63], v[128:131], a[44:47], v[60:63]
  v_mfma_f32_16x16x32_bf16 v[48:51], v[132:135], a[48:51], v[48:51]
  v_fma_f32 v4, v4, s82, s82
  v_fma_f32 v5, v5, s82, s82
  v_mfma_f32_16x16x32_bf16 v[52:55], v[132:135], a[52:55], v[52:55]
  v_fma_f32 v6, v6, s82, s82
  v_fma_f32 v7, v7, s82, s82
  v_mfma_f32_16x16x32_bf16 v[56:59], v[132:135], a[56:59], v[56:59]
  v_rcp_f32 v4, v4
  v_rcp_f32 v5, v5
  v_mfma_f32_16x16x32_bf16 v[60:63], v[132:135], a[60:63], v[60:63]
  v_mfma_f32_16x16x32_bf16 v[48:51], v[200:203], a[64:67], v[48:51]
  v_rcp_f32 v6, v6
  v_mfma_f32_16x16x32_bf16 v[52:55], v[200:203], a[68:71], v[52:55]
  v_rcp_f32 v7, v7
  v_mul_f32 v4, v4, v32
  v_mfma_f32_16x16x32_bf16 v[56:59], v[200:203], a[72:75], v[56:59]
  v_mul_f32 v5, v5, v33
  v_mul_f32 v6, v6, v34
  v_mul_f32 v7, v7, v35
  v_mfma_f32_16x16x32_bf16 v[60:63], v[200:203], a[76:79], v[60:63]
  v_mfma_f32_16x16x32_bf16 v[48:51], v[136:139], a[80:83], v[48:51]
  v_cvt_pk_bf16_f32 v152, v4, v5
  v_cvt_pk_bf16_f32 v153, v6, v7
  v_fma_f32 v8, v36, v36, v16
  v_mfma_f32_16x16x32_bf16 v[52:55], v[136:139], a[84:87], v[52:55]
  v_fma_f32 v9, v37, v37, v16
  v_fma_f32 v10, v38, v38, v16
  v_mfma_f32_16x16x32_bf16 v[56:59], v[136:139], a[88:91], v[56:59]
  v_fma_f32 v11, v39, v39, v16
  v_mul_f32 v8, v8, v36
  v_mul_f32 v9, v9, v37
  v_mfma_f32_16x16x32_bf16 v[60:63], v[136:139], a[92:95], v[60:63]
  v_mfma_f32_16x16x32_bf16 v[48:51], v[140:143], a[96:99], v[48:51]
  v_mul_f32 v10, v10, v38
  v_mul_f32 v11, v11, v39
  v_mfma_f32_16x16x32_bf16 v[52:55], v[140:143], a[100:103], v[52:55]
  v_exp_f32_e64 v8, -v8
  v_exp_f32_e64 v9, -v9
  v_mfma_f32_16x16x32_bf16 v[56:59], v[140:143], a[104:107], v[56:59]
  v_exp_f32_e64 v10, -v10
  v_mfma_f32_16x16x32_bf16 v[60:63], v[140:143], a[108:111], v[60:63]
  v_mfma_f32_16x16x32_bf16 v[48:51], v[204:207], a[112:115], v[48:51]
  v_exp_f32_e64 v11, -v11
  v_fma_f32 v8, v8, s82, s82
  v_mfma_f32_16x16x32_bf16 v[52:55], v[204:207], a[116:119], v[52:55]
  v_fma_f32 v9, v9, s82, s82
  v_fma_f32 v10, v10, s82, s82
  v_fma_f32 v11, v11, s82, s82
  v_mfma_f32_16x16x32_bf16 v[56:59], v[204:207], a[120:123], v[56:59]
  v_rcp_f32 v8, v8
  v_mfma_f32_16x16x32_bf16 v[60:63], v[204:207], a[124:127], v[60:63]
  v_mfma_f32_16x16x32_bf16 v[48:51], v[208:211], a[128:131], v[48:51]
  v_rcp_f32 v9, v9
  v_rcp_f32 v10, v10
  v_mfma_f32_16x16x32_bf16 v[52:55], v[208:211], a[132:135], v[52:55]
  v_rcp_f32 v11, v11
  v_mfma_f32_16x16x32_bf16 v[56:59], v[208:211], a[136:139], v[56:59]
  v_mul_f32 v8, v8, v36
  v_mul_f32 v9, v9, v37
  v_mul_f32 v10, v10, v38
  v_mfma_f32_16x16x32_bf16 v[60:63], v[208:211], a[140:143], v[60:63]
  v_mfma_f32_16x16x32_bf16 v[48:51], v[212:215], a[144:147], v[48:51]
  v_mul_f32 v11, v11, v39
  v_cvt_pk_bf16_f32 v156, v8, v9
  v_cvt_pk_bf16_f32 v157, v10, v11
  v_mfma_f32_16x16x32_bf16 v[52:55], v[212:215], a[148:151], v[52:55]
  v_fma_f32 v4, v40, v40, v16
  v_fma_f32 v5, v41, v41, v16
  v_mfma_f32_16x16x32_bf16 v[56:59], v[212:215], a[152:155], v[56:59]
  v_fma_f32 v6, v42, v42, v16
  v_fma_f32 v7, v43, v43, v16
  v_mul_f32 v4, v4, v40
  v_mfma_f32_16x16x32_bf16 v[60:63], v[212:215], a[156:159], v[60:63]
  v_mfma_f32_16x16x32_bf16 v[48:51], v[64:67], a[160:163], v[48:51]
  v_mul_f32 v5, v5, v41
  v_mul_f32 v6, v6, v42
  v_mul_f32 v7, v7, v43
  v_mfma_f32_16x16x32_bf16 v[52:55], v[64:67], a[164:167], v[52:55]
  v_exp_f32_e64 v4, -v4
  v_mfma_f32_16x16x32_bf16 v[56:59], v[64:67], a[168:171], v[56:59]
  v_exp_f32_e64 v5, -v5
  v_exp_f32_e64 v6, -v6
  v_mfma_f32_16x16x32_bf16 v[60:63], v[64:67], a[172:175], v[60:63]
  v_mfma_f32_16x16x32_bf16 v[48:51], v[68:71], a[176:179], v[48:51]
  v_exp_f32_e64 v7, -v7
  v_mfma_f32_16x16x32_bf16 v[52:55], v[68:71], a[180:183], v[52:55]
  v_fma_f32 v4, v4, s82, s82
  v_fma_f32 v5, v5, s82, s82
  v_fma_f32 v6, v6, s82, s82
  v_mfma_f32_16x16x32_bf16 v[56:59], v[68:71], a[184:187], v[56:59]
  v_fma_f32 v7, v7, s82, s82
  v_rcp_f32 v4, v4
  v_mfma_f32_16x16x32_bf16 v[60:63], v[68:71], a[188:191], v[60:63]
  s_waitcnt vmcnt(30)
  v_mfma_f32_16x16x32_bf16 v[48:51], v[72:75], a[192:195], v[48:51]
  v_rcp_f32 v5, v5
  v_mfma_f32_16x16x32_bf16 v[52:55], v[72:75], a[196:199], v[52:55]
  v_rcp_f32 v6, v6
  v_mfma_f32_16x16x32_bf16 v[56:59], v[72:75], a[200:203], v[56:59]
  v_rcp_f32 v7, v7
  v_mul_f32 v4, v4, v40
  v_mul_f32 v5, v5, v41
  v_mfma_f32_16x16x32_bf16 v[60:63], v[72:75], a[204:207], v[60:63]
  v_mfma_f32_16x16x32_bf16 v[48:51], v[76:79], a[208:211], v[48:51]
  v_mul_f32 v6, v6, v42
  v_mul_f32 v7, v7, v43
  v_mfma_f32_16x16x32_bf16 v[52:55], v[76:79], a[212:215], v[52:55]
  v_cvt_pk_bf16_f32 v160, v4, v5
  v_cvt_pk_bf16_f32 v161, v6, v7
  v_fma_f32 v8, v44, v44, v16
  v_mfma_f32_16x16x32_bf16 v[56:59], v[76:79], a[216:219], v[56:59]
  v_fma_f32 v9, v45, v45, v16
  v_fma_f32 v10, v46, v46, v16
  v_fma_f32 v11, v47, v47, v16
  v_mfma_f32_16x16x32_bf16 v[60:63], v[76:79], a[220:223], v[60:63]
  s_waitcnt vmcnt(28)
  v_mfma_f32_16x16x32_bf16 v[48:51], v[80:83], a[224:227], v[48:51]
  v_mul_f32 v8, v8, v44
  v_mul_f32 v9, v9, v45
  v_mul_f32 v10, v10, v46
  v_mfma_f32_16x16x32_bf16 v[52:55], v[80:83], a[228:231], v[52:55]
  v_mul_f32 v11, v11, v47
  v_exp_f32_e64 v8, -v8
  v_mfma_f32_16x16x32_bf16 v[56:59], v[80:83], a[232:235], v[56:59]
  v_exp_f32_e64 v9, -v9
  v_mfma_f32_16x16x32_bf16 v[60:63], v[80:83], a[236:239], v[60:63]
  v_mfma_f32_16x16x32_bf16 v[48:51], v[84:87], a[240:243], v[48:51]
  v_exp_f32_e64 v10, -v10
  v_mfma_f32_16x16x32_bf16 v[52:55], v[84:87], a[244:247], v[52:55]
  v_exp_f32_e64 v11, -v11
  v_fma_f32 v8, v8, s82, s82
  v_fma_f32 v9, v9, s82, s82
  v_mfma_f32_16x16x32_bf16 v[56:59], v[84:87], a[248:251], v[56:59]
  v_fma_f32 v10, v10, s82, s82
  v_fma_f32 v11, v11, s82, s82
  v_mfma_f32_16x16x32_bf16 v[60:63], v[84:87], a[252:255], v[60:63]
  s_waitcnt vmcnt(26)
  v_mfma_f32_16x16x32_bf16 v[48:51], v[176:179], v[224:227], v[48:51]
  v_rcp_f32 v8, v8
  v_rcp_f32 v9, v9
  v_mfma_f32_16x16x32_bf16 v[52:55], v[176:179], v[228:231], v[52:55]
  v_rcp_f32 v10, v10
  v_mfma_f32_16x16x32_bf16 v[56:59], v[176:179], v[232:235], v[56:59]
  v_rcp_f32 v11, v11
  v_mul_f32 v8, v8, v44
  v_mfma_f32_16x16x32_bf16 v[60:63], v[176:179], v[236:239], v[60:63]
  v_mfma_f32_16x16x32_bf16 v[48:51], v[88:91], v[240:243], v[48:51]
  v_mul_f32 v9, v9, v45
  v_mul_f32 v10, v10, v46
  v_mfma_f32_16x16x32_bf16 v[52:55], v[88:91], v[244:247], v[52:55]
  v_mul_f32 v11, v11, v47
  v_cvt_pk_bf16_f32 v164, v8, v9
  v_cvt_pk_bf16_f32 v165, v10, v11
  v_mfma_f32_16x16x32_bf16 v[56:59], v[88:91], v[248:251], v[56:59]
  v_mfma_f32_16x16x32_bf16 v[60:63], v[88:91], v[252:255], v[60:63]
  s_waitcnt lgkmcnt(0)
  s_waitcnt vmcnt(24)
  v_mfma_f32_16x16x32_bf16 v[32:35], v[92:95], a[0:3], v[144:147]
  v_mfma_f32_16x16x32_bf16 v[36:39], v[92:95], a[4:7], v[144:147]
  v_mfma_f32_16x16x32_bf16 v[40:43], v[92:95], a[8:11], v[144:147]
  v_mfma_f32_16x16x32_bf16 v[44:47], v[92:95], a[12:15], v[144:147]
  s_add_u32 s80, s80, 4096
  buffer_load_dwordx4 v[216:219], v1, s[32:35], s80 offen offset:0 sc1
  buffer_load_dwordx4 v[220:223], v1, s[32:35], s80 offen offset:1024 sc1
  v_mfma_f32_16x16x32_bf16 v[32:35], v[180:183], a[16:19], v[32:35]
  ds_read_b128 v[148:151], v17 offset:768
  v_fma_f32 v4, v48, v48, v16
  v_fma_f32 v5, v49, v49, v16
  v_mfma_f32_16x16x32_bf16 v[36:39], v[180:183], a[20:23], v[36:39]
  v_fma_f32 v6, v50, v50, v16
  v_fma_f32 v7, v51, v51, v16
  v_mul_f32 v4, v4, v48
  v_mfma_f32_16x16x32_bf16 v[40:43], v[180:183], a[24:27], v[40:43]
  v_mul_f32 v5, v5, v49
  v_mul_f32 v6, v6, v50
  v_mul_f32 v7, v7, v51
  v_mfma_f32_16x16x32_bf16 v[44:47], v[180:183], a[28:31], v[44:47]
  buffer_load_dwordx4 v[196:199], v1, s[32:35], s80 offen offset:2048 sc1
  buffer_load_dwordx4 v[200:203], v1, s[32:35], s80 offen offset:3072 sc1
  s_waitcnt vmcnt(26)
  v_mfma_f32_16x16x32_bf16 v[32:35], v[96:99], a[32:35], v[32:35]
  v_exp_f32_e64 v4, -v4
  v_mfma_f32_16x16x32_bf16 v[36:39], v[96:99], a[36:39], v[36:39]
  v_exp_f32_e64 v5, -v5
  v_exp_f32_e64 v6, -v6
  v_mfma_f32_16x16x32_bf16 v[40:43], v[96:99], a[40:43], v[40:43]
  v_exp_f32_e64 v7, -v7
  v_mfma_f32_16x16x32_bf16 v[44:47], v[96:99], a[44:47], v[44:47]
  s_add_u32 s80, s80, 4096
  buffer_load_dwordx4 v[204:207], v1, s[32:35], s80 offen offset:0 sc1
  buffer_load_dwordx4 v[208:211], v1, s[32:35], s80 offen offset:1024 sc1
  v_mfma_f32_16x16x32_bf16 v[32:35], v[100:103], a[48:51], v[32:35]
  v_fma_f32 v4, v4, s82, s82
  v_fma_f32 v5, v5, s82, s82
  v_fma_f32 v6, v6, s82, s82
  v_mfma_f32_16x16x32_bf16 v[36:39], v[100:103], a[52:55], v[36:39]
  v_fma_f32 v7, v7, s82, s82
  v_rcp_f32 v4, v4
  v_mfma_f32_16x16x32_bf16 v[40:43], v[100:103], a[56:59], v[40:43]
  v_rcp_f32 v5, v5
  v_rcp_f32 v6, v6
  v_mfma_f32_16x16x32_bf16 v[44:47], v[100:103], a[60:63], v[44:47]
  buffer_load_dwordx4 v[212:215], v1, s[32:35], s80 offen offset:2048 sc1
  buffer_load_dwordx4 v[176:179], v1, s[32:35], s80 offen offset:3072 sc1
  s_waitcnt vmcnt(28)
  v_mfma_f32_16x16x32_bf16 v[32:35], v[184:187], a[64:67], v[32:35]
  v_rcp_f32 v7, v7
  v_mfma_f32_16x16x32_bf16 v[36:39], v[184:187], a[68:71], v[36:39]
  v_mul_f32 v4, v4, v48
  v_mul_f32 v5, v5, v49
  v_mul_f32 v6, v6, v50
  v_mfma_f32_16x16x32_bf16 v[40:43], v[184:187], a[72:75], v[40:43]
  v_mul_f32 v7, v7, v51
  v_cvt_pk_bf16_f32 v154, v4, v5
  v_cvt_pk_bf16_f32 v155, v6, v7
  v_mfma_f32_16x16x32_bf16 v[44:47], v[184:187], a[76:79], v[44:47]
  s_add_u32 s80, s80, 4096
  buffer_load_dwordx4 v[180:183], v1, s[32:35], s80 offen offset:0 sc1
  buffer_load_dwordx4 v[184:187], v1, s[32:35], s80 offen offset:1024 sc1
  v_mfma_f32_16x16x32_bf16 v[32:35], v[104:107], a[80:83], v[32:35]
  ds_write_b128 v18, v[152:155] offset:0
  v_fma_f32 v8, v52, v52, v16
  v_mfma_f32_16x16x32_bf16 v[36:39], v[104:107], a[84:87], v[36:39]
  v_fma_f32 v9, v53, v53, v16
  v_fma_f32 v10, v54, v54, v16
  v_fma_f32 v11, v55, v55, v16
  v_mfma_f32_16x16x32_bf16 v[40:43], v[104:107], a[88:91], v[40:43]
  v_mul_f32 v8, v8, v52
  v_mul_f32 v9, v9, v53
  v_mfma_f32_16x16x32_bf16 v[44:47], v[104:107], a[92:95], v[44:47]
  buffer_load_dwordx4 v[124:127], v1, s[32:35], s80 offen offset:2048 sc1
  buffer_load_dwordx4 v[128:131], v1, s[32:35], s80 offen offset:3072 sc1
  s_waitcnt vmcnt(30)
  v_mfma_f32_16x16x32_bf16 v[32:35], v[108:111], a[96:99], v[32:35]
  v_mul_f32 v10, v10, v54
  v_mul_f32 v11, v11, v55
  v_exp_f32_e64 v8, -v8
  v_mfma_f32_16x16x32_bf16 v[36:39], v[108:111], a[100:103], v[36:39]
  v_exp_f32_e64 v9, -v9
  v_mfma_f32_16x16x32_bf16 v[40:43], v[108:111], a[104:107], v[40:43]
  v_exp_f32_e64 v10, -v10
  v_exp_f32_e64 v11, -v11
  v_mfma_f32_16x16x32_bf16 v[44:47], v[108:111], a[108:111], v[44:47]
  s_add_u32 s80, s80, 4096
  buffer_load_dwordx4 v[132:135], v1, s[32:35], s80 offen offset:0 sc1
  buffer_load_dwordx4 v[136:139], v1, s[32:35], s80 offen offset:1024 sc1
  v_mfma_f32_16x16x32_bf16 v[32:35], v[188:191], a[112:115], v[32:35]
  v_fma_f32 v8, v8, s82, s82
  v_fma_f32 v9, v9, s82, s82
  v_mfma_f32_16x16x32_bf16 v[36:39], v[188:191], a[116:119], v[36:39]
  v_fma_f32 v10, v10, s82, s82
  v_fma_f32 v11, v11, s82, s82
  v_mfma_f32_16x16x32_bf16 v[40:43], v[188:191], a[120:123], v[40:43]
  v_rcp_f32 v8, v8
  v_rcp_f32 v9, v9
  v_mfma_f32_16x16x32_bf16 v[44:47], v[188:191], a[124:127], v[44:47]
  buffer_load_dwordx4 v[188:191], v1, s[32:35], s80 offen offset:2048 sc1
  buffer_load_dwordx4 v[140:143], v1, s[32:35], s80 offen offset:3072 sc1
  s_waitcnt vmcnt(32)
  v_mfma_f32_16x16x32_bf16 v[32:35], v[112:115], a[128:131], v[32:35]
  v_rcp_f32 v10, v10
  v_mfma_f32_16x16x32_bf16 v[36:39], v[112:115], a[132:135], v[36:39]
  v_rcp_f32 v11, v11
  v_mul_f32 v8, v8, v52
  v_mul_f32 v9, v9, v53
  v_mfma_f32_16x16x32_bf16 v[40:43], v[112:115], a[136:139], v[40:43]
  v_mul_f32 v10, v10, v54
  v_mul_f32 v11, v11, v55
  v_cvt_pk_bf16_f32 v158, v8, v9
  v_mfma_f32_16x16x32_bf16 v[44:47], v[112:115], a[140:143], v[44:47]
  s_add_u32 s80, s80, 4096
  buffer_load_dwordx4 v[64:67], v1, s[32:35], s80 offen offset:0 sc1
  buffer_load_dwordx4 v[68:71], v1, s[32:35], s80 offen offset:1024 sc1
  v_mfma_f32_16x16x32_bf16 v[32:35], v[116:119], a[144:147], v[32:35]
  v_cvt_pk_bf16_f32 v159, v10, v11
  ds_write_b128 v18, v[156:159] offset:1024
  v_mfma_f32_16x16x32_bf16 v[36:39], v[116:119], a[148:151], v[36:39]
  v_fma_f32 v4, v56, v56, v16
  v_fma_f32 v5, v57, v57, v16
  v_mfma_f32_16x16x32_bf16 v[40:43], v[116:119], a[152:155], v[40:43]
  v_fma_f32 v6, v58, v58, v16
  v_fma_f32 v7, v59, v59, v16
  v_mul_f32 v4, v4, v56
  v_mfma_f32_16x16x32_bf16 v[44:47], v[116:119], a[156:159], v[44:47]
  buffer_load_dwordx4 v[72:75], v1, s[32:35], s80 offen offset:2048 sc1
  buffer_load_dwordx4 v[76:79], v1, s[32:35], s80 offen offset:3072 sc1
  s_waitcnt vmcnt(34)
  v_mfma_f32_16x16x32_bf16 v[32:35], v[192:195], a[160:163], v[32:35]
  v_mul_f32 v5, v5, v57
  v_mul_f32 v6, v6, v58
  v_mul_f32 v7, v7, v59
  v_mfma_f32_16x16x32_bf16 v[36:39], v[192:195], a[164:167], v[36:39]
  v_exp_f32_e64 v4, -v4
  v_exp_f32_e64 v5, -v5
  v_mfma_f32_16x16x32_bf16 v[40:43], v[192:195], a[168:171], v[40:43]
  v_exp_f32_e64 v6, -v6
  v_mfma_f32_16x16x32_bf16 v[44:47], v[192:195], a[172:175], v[44:47]
  s_add_u32 s80, s80, 4096
  buffer_load_dwordx4 v[192:195], v1, s[32:35], s80 offen offset:0 sc1
  buffer_load_dwordx4 v[80:83], v1, s[32:35], s80 offen offset:1024 sc1
  v_mfma_f32_16x16x32_bf16 v[32:35], v[120:123], a[176:179], v[32:35]
  v_exp_f32_e64 v7, -v7
  v_fma_f32 v4, v4, s82, s82
  v_mfma_f32_16x16x32_bf16 v[36:39], v[120:123], a[180:183], v[36:39]
  v_fma_f32 v5, v5, s82, s82
  v_fma_f32 v6, v6, s82, s82
  v_fma_f32 v7, v7, s82, s82
  v_mfma_f32_16x16x32_bf16 v[40:43], v[120:123], a[184:187], v[40:43]
  v_rcp_f32 v4, v4
  v_mfma_f32_16x16x32_bf16 v[44:47], v[120:123], a[188:191], v[44:47]
  buffer_load_dwordx4 v[84:87], v1, s[32:35], s80 offen offset:2048 sc1
  buffer_load_dwordx4 v[88:91], v1, s[32:35], s80 offen offset:3072 sc1
  s_waitcnt vmcnt(22)
  v_mfma_f32_16x16x32_bf16 v[32:35], v[216:219], a[192:195], v[32:35]
  v_rcp_f32 v5, v5
  v_rcp_f32 v6, v6
  v_mfma_f32_16x16x32_bf16 v[36:39], v[216:219], a[196:199], v[36:39]
  v_rcp_f32 v7, v7
  v_mfma_f32_16x16x32_bf16 v[40:43], v[216:219], a[200:203], v[40:43]
  v_mul_f32 v4, v4, v56
  v_mul_f32 v5, v5, v57
  v_mul_f32 v6, v6, v58
  v_mfma_f32_16x16x32_bf16 v[44:47], v[216:219], a[204:207], v[44:47]
  s_add_u32 s80, s80, 4096
  buffer_load_dwordx4 v[216:219], v1, s[32:35], s80 offen offset:0 sc1
  buffer_load_dwordx4 v[92:95], v1, s[32:35], s80 offen offset:1024 sc1
  v_mfma_f32_16x16x32_bf16 v[32:35], v[220:223], a[208:211], v[32:35]
  v_mul_f32 v7, v7, v59
  v_cvt_pk_bf16_f32 v162, v4, v5
  v_cvt_pk_bf16_f32 v163, v6, v7
  v_mfma_f32_16x16x32_bf16 v[36:39], v[220:223], a[212:215], v[36:39]
  ds_write_b128 v18, v[160:163] offset:2048
  v_fma_f32 v8, v60, v60, v16
  v_mfma_f32_16x16x32_bf16 v[40:43], v[220:223], a[216:219], v[40:43]
  v_fma_f32 v9, v61, v61, v16
  v_fma_f32 v10, v62, v62, v16
  v_fma_f32 v11, v63, v63, v16
  v_mfma_f32_16x16x32_bf16 v[44:47], v[220:223], a[220:223], v[44:47]
  buffer_load_dwordx4 v[220:223], v1, s[32:35], s80 offen offset:2048 sc1
  buffer_load_dwordx4 v[96:99], v1, s[32:35], s80 offen offset:3072 sc1
  s_waitcnt vmcnt(24)
  v_mfma_f32_16x16x32_bf16 v[32:35], v[196:199], a[224:227], v[32:35]
  v_mul_f32 v8, v8, v60
  v_mul_f32 v9, v9, v61
  v_mul_f32 v10, v10, v62
  v_mfma_f32_16x16x32_bf16 v[36:39], v[196:199], a[228:231], v[36:39]
  v_mul_f32 v11, v11, v63
  v_exp_f32_e64 v8, -v8
  v_mfma_f32_16x16x32_bf16 v[40:43], v[196:199], a[232:235], v[40:43]
  v_exp_f32_e64 v9, -v9
  v_mfma_f32_16x16x32_bf16 v[44:47], v[196:199], a[236:239], v[44:47]
  s_add_u32 s80, s80, 4096
  buffer_load_dwordx4 v[196:199], v1, s[32:35], s80 offen offset:0 sc1
  buffer_load_dwordx4 v[100:103], v1, s[32:35], s80 offen offset:1024 sc1
  v_mfma_f32_16x16x32_bf16 v[32:35], v[200:203], a[240:243], v[32:35]
  v_exp_f32_e64 v10, -v10
  v_exp_f32_e64 v11, -v11
  v_mfma_f32_16x16x32_bf16 v[36:39], v[200:203], a[244:247], v[36:39]
  v_fma_f32 v8, v8, s82, s82
  v_fma_f32 v9, v9, s82, s82
  v_fma_f32 v10, v10, s82, s82
  v_mfma_f32_16x16x32_bf16 v[40:43], v[200:203], a[248:251], v[40:43]
  v_fma_f32 v11, v11, s82, s82
  v_rcp_f32 v8, v8
  v_mfma_f32_16x16x32_bf16 v[44:47], v[200:203], a[252:255], v[44:47]
  buffer_load_dwordx4 v[200:203], v1, s[32:35], s80 offen offset:2048 sc1
  buffer_load_dwordx4 v[104:107], v1, s[32:35], s80 offen offset:3072 sc1
  s_waitcnt vmcnt(26)
  v_mfma_f32_16x16x32_bf16 v[32:35], v[204:207], v[224:227], v[32:35]
  v_rcp_f32 v9, v9
  v_mfma_f32_16x16x32_bf16 v[36:39], v[204:207], v[228:231], v[36:39]
  v_rcp_f32 v10, v10
  v_rcp_f32 v11, v11
  v_mfma_f32_16x16x32_bf16 v[40:43], v[204:207], v[232:235], v[40:43]
  v_mul_f32 v8, v8, v60
  v_mul_f32 v9, v9, v61
  v_mfma_f32_16x16x32_bf16 v[44:47], v[204:207], v[236:239], v[44:47]
  s_add_u32 s80, s80, 4096
  buffer_load_dwordx4 v[204:207], v1, s[32:35], s80 offen offset:0 sc1
  buffer_load_dwordx4 v[108:111], v1, s[32:35], s80 offen offset:1024 sc1
  v_mfma_f32_16x16x32_bf16 v[32:35], v[208:211], v[240:243], v[32:35]
  v_mul_f32 v10, v10, v62
  v_mul_f32 v11, v11, v63
  v_cvt_pk_bf16_f32 v166, v8, v9
  v_mfma_f32_16x16x32_bf16 v[36:39], v[208:211], v[244:247], v[36:39]
  v_cvt_pk_bf16_f32 v167, v10, v11
  ds_write_b128 v18, v[164:167] offset:3072
  v_mfma_f32_16x16x32_bf16 v[40:43], v[208:211], v[248:251], v[40:43]
  v_mfma_f32_16x16x32_bf16 v[44:47], v[208:211], v[252:255], v[44:47]
  buffer_load_dwordx4 v[208:211], v1, s[32:35], s80 offen offset:2048 sc1
  buffer_load_dwordx4 v[112:115], v1, s[32:35], s80 offen offset:3072 sc1
  s_waitcnt lgkmcnt(4)
  s_waitcnt vmcnt(28)
  v_mfma_f32_16x16x32_bf16 v[48:51], v[212:215], a[0:3], v[148:151]
  v_mfma_f32_16x16x32_bf16 v[52:55], v[212:215], a[4:7], v[148:151]
  v_mfma_f32_16x16x32_bf16 v[56:59], v[212:215], a[8:11], v[148:151]
  v_mfma_f32_16x16x32_bf16 v[60:63], v[212:215], a[12:15], v[148:151]
  s_add_u32 s80, s80, 4096
  buffer_load_dwordx4 v[212:215], v1, s[32:35], s80 offen offset:0 sc1
  buffer_load_dwordx4 v[116:119], v1, s[32:35], s80 offen offset:1024 sc1
  ds_read_b128 v[144:147], v17 offset:1024
  v_mfma_f32_16x16x32_bf16 v[48:51], v[176:179], a[16:19], v[48:51]
  v_fma_f32 v4, v32, v32, v16
  v_fma_f32 v5, v33, v33, v16
  v_fma_f32 v6, v34, v34, v16
  v_mfma_f32_16x16x32_bf16 v[52:55], v[176:179], a[20:23], v[52:55]
  v_fma_f32 v7, v35, v35, v16
  ds_read_b64_tr_b16 v[12:13], v174 offset:0
  ds_read_b64_tr_b16 v[14:15], v174 offset:512
  v_mfma_f32_16x16x32_bf16 v[56:59], v[176:179], a[24:27], v[56:59]
  v_mul_f32 v4, v4, v32
  v_mul_f32 v5, v5, v33
  v_mul_f32 v6, v6, v34
  v_mfma_f32_16x16x32_bf16 v[60:63], v[176:179], a[28:31], v[60:63]
  buffer_load_dwordx4 v[176:179], v1, s[32:35], s80 offen offset:2048 sc1
  buffer_load_dwordx4 v[120:123], v1, s[32:35], s80 offen offset:3072 sc1
  s_waitcnt vmcnt(30)
  v_mfma_f32_16x16x32_bf16 v[48:51], v[180:183], a[32:35], v[48:51]
  v_mul_f32 v7, v7, v35
  v_exp_f32_e64 v4, -v4
  v_mfma_f32_16x16x32_bf16 v[52:55], v[180:183], a[36:39], v[52:55]
  v_exp_f32_e64 v5, -v5
  v_exp_f32_e64 v6, -v6
  v_mfma_f32_16x16x32_bf16 v[56:59], v[180:183], a[40:43], v[56:59]
  v_exp_f32_e64 v7, -v7
  v_fma_f32 v4, v4, s82, s82
  v_fma_f32 v5, v5, s82, s82
  v_mfma_f32_16x16x32_bf16 v[60:63], v[180:183], a[44:47], v[60:63]
  s_add_u32 s80, s80, 4096
  buffer_load_dwordx4 v[180:183], v1, s[32:35], s80 offen offset:0 sc1
  v_fma_f32 v6, v6, s82, s82
  v_mfma_f32_16x16x32_bf16 v[48:51], v[184:187], a[48:51], v[48:51]
  v_fma_f32 v7, v7, s82, s82
  v_rcp_f32 v4, v4
  v_mfma_f32_16x16x32_bf16 v[52:55], v[184:187], a[52:55], v[52:55]
  v_mfma_f32_16x16x32_bf16 v[56:59], v[184:187], a[56:59], v[56:59]
  s_waitcnt lgkmcnt(0)
  s_mov_b32 s57, s96
  buffer_store_dwordx4 v[12:15], v1, s[32:35], s57 offen sc1
  v_mfma_f32_16x16x32_bf16 v[60:63], v[184:187], a[60:63], v[60:63]
  buffer_load_dwordx4 v[184:187], v1, s[32:35], s80 offen offset:1024 sc1
  s_waitcnt vmcnt(31)
  v_mfma_f32_16x16x32_bf16 v[48:51], v[124:127], a[64:67], v[48:51]
  v_rcp_f32 v5, v5
  v_mfma_f32_16x16x32_bf16 v[52:55], v[124:127], a[68:71], v[52:55]
  v_rcp_f32 v6, v6
  v_rcp_f32 v7, v7
  v_mfma_f32_16x16x32_bf16 v[56:59], v[124:127], a[72:75], v[56:59]
  v_mul_f32 v4, v4, v32
  v_mul_f32 v5, v5, v33
  v_mul_f32 v6, v6, v34
  v_mfma_f32_16x16x32_bf16 v[60:63], v[124:127], a[76:79], v[60:63]
  buffer_load_dwordx4 v[124:127], v1, s[32:35], s80 offen offset:2048 sc1
  v_mul_f32 v7, v7, v35
  v_mfma_f32_16x16x32_bf16 v[48:51], v[128:131], a[80:83], v[48:51]
  v_cvt_pk_bf16_f32 v152, v4, v5
  v_cvt_pk_bf16_f32 v153, v6, v7
  v_fma_f32 v8, v36, v36, v16
  v_fma_f32 v9, v37, v37, v16
  v_mfma_f32_16x16x32_bf16 v[52:55], v[128:131], a[84:87], v[52:55]
  v_fma_f32 v10, v38, v38, v16
  v_fma_f32 v11, v39, v39, v16
  v_mul_f32 v8, v8, v36
  v_mfma_f32_16x16x32_bf16 v[56:59], v[128:131], a[88:91], v[56:59]
  ds_read_b64_tr_b16 v[168:169], v174 offset:32
  ds_read_b64_tr_b16 v[170:171], v174 offset:544
  v_mfma_f32_16x16x32_bf16 v[60:63], v[128:131], a[92:95], v[60:63]
  buffer_load_dwordx4 v[128:131], v1, s[32:35], s80 offen offset:3072 sc1
  s_waitcnt vmcnt(31)
  v_mfma_f32_16x16x32_bf16 v[48:51], v[132:135], a[96:99], v[48:51]
  v_mul_f32 v9, v9, v37
  v_mul_f32 v10, v10, v38
  v_mul_f32 v11, v11, v39
  v_exp_f32_e64 v8, -v8
  v_mfma_f32_16x16x32_bf16 v[52:55], v[132:135], a[100:103], v[52:55]
  v_exp_f32_e64 v9, -v9
  v_mfma_f32_16x16x32_bf16 v[56:59], v[132:135], a[104:107], v[56:59]
  v_exp_f32_e64 v10, -v10
  v_exp_f32_e64 v11, -v11
  v_mfma_f32_16x16x32_bf16 v[60:63], v[132:135], a[108:111], v[60:63]
  s_add_u32 s80, s80, 4096
  buffer_load_dwordx4 v[132:135], v1, s[32:35], s80 offen offset:0 sc1
  v_fma_f32 v8, v8, s82, s82
  v_mfma_f32_16x16x32_bf16 v[48:51], v[136:139], a[112:115], v[48:51]
  v_fma_f32 v9, v9, s82, s82
  v_fma_f32 v10, v10, s82, s82
  v_fma_f32 v11, v11, s82, s82
  v_mfma_f32_16x16x32_bf16 v[52:55], v[136:139], a[116:119], v[52:55]
  v_rcp_f32 v8, v8
  v_mfma_f32_16x16x32_bf16 v[56:59], v[136:139], a[120:123], v[56:59]
  s_waitcnt lgkmcnt(0)
  s_add_u32 s57, s96, 433152
  buffer_store_dwordx4 v[168:171], v1, s[32:35], s57 offen sc1
  v_mfma_f32_16x16x32_bf16 v[60:63], v[136:139], a[124:127], v[60:63]
  buffer_load_dwordx4 v[136:139], v1, s[32:35], s80 offen offset:1024 sc1
  s_waitcnt vmcnt(32)
  v_mfma_f32_16x16x32_bf16 v[48:51], v[188:191], a[128:131], v[48:51]
  v_mfma_f32_16x16x32_bf16 v[52:55], v[188:191], a[132:135], v[52:55]
  v_rcp_f32 v9, v9
  v_rcp_f32 v10, v10
  v_mfma_f32_16x16x32_bf16 v[56:59], v[188:191], a[136:139], v[56:59]
  v_rcp_f32 v11, v11
  v_mul_f32 v8, v8, v36
  v_mul_f32 v9, v9, v37
  v_mfma_f32_16x16x32_bf16 v[60:63], v[188:191], a[140:143], v[60:63]
  buffer_load_dwordx4 v[188:191], v1, s[32:35], s80 offen offset:2048 sc1
  v_mfma_f32_16x16x32_bf16 v[48:51], v[140:143], a[144:147], v[48:51]
  v_mul_f32 v10, v10, v38
  v_mul_f32 v11, v11, v39
  v_cvt_pk_bf16_f32 v156, v8, v9
  v_cvt_pk_bf16_f32 v157, v10, v11
  v_mfma_f32_16x16x32_bf16 v[52:55], v[140:143], a[148:151], v[52:55]
  v_fma_f32 v4, v40, v40, v16
  v_fma_f32 v5, v41, v41, v16
  v_fma_f32 v6, v42, v42, v16
  v_mfma_f32_16x16x32_bf16 v[56:59], v[140:143], a[152:155], v[56:59]
  v_fma_f32 v7, v43, v43, v16
  v_mul_f32 v4, v4, v40
  ds_read_b64_tr_b16 v[12:13], v174 offset:64
  ds_read_b64_tr_b16 v[14:15], v174 offset:576
  v_mfma_f32_16x16x32_bf16 v[60:63], v[140:143], a[156:159], v[60:63]
  buffer_load_dwordx4 v[140:143], v1, s[32:35], s80 offen offset:3072 sc1
  s_waitcnt vmcnt(32)
  v_mfma_f32_16x16x32_bf16 v[48:51], v[64:67], a[160:163], v[48:51]
  v_mul_f32 v5, v5, v41
  v_mul_f32 v6, v6, v42
  v_mfma_f32_16x16x32_bf16 v[52:55], v[64:67], a[164:167], v[52:55]
  v_mul_f32 v7, v7, v43
  v_exp_f32_e64 v4, -v4
  v_exp_f32_e64 v5, -v5
  v_mfma_f32_16x16x32_bf16 v[56:59], v[64:67], a[168:171], v[56:59]
  v_exp_f32_e64 v6, -v6
  v_mfma_f32_16x16x32_bf16 v[60:63], v[64:67], a[172:175], v[60:63]
  s_add_u32 s80, s80, 4096
  buffer_load_dwordx4 v[64:67], v1, s[32:35], s80 offen offset:0 sc1
  v_exp_f32_e64 v7, -v7
  v_mfma_f32_16x16x32_bf16 v[48:51], v[68:71], a[176:179], v[48:51]
  v_fma_f32 v4, v4, s82, s82
  v_fma_f32 v5, v5, s82, s82
  v_fma_f32 v6, v6, s82, s82
  v_mfma_f32_16x16x32_bf16 v[52:55], v[68:71], a[180:183], v[52:55]
  v_fma_f32 v7, v7, s82, s82
  v_rcp_f32 v4, v4
  v_mfma_f32_16x16x32_bf16 v[56:59], v[68:71], a[184:187], v[56:59]
  v_mfma_f32_16x16x32_bf16 v[60:63], v[68:71], a[188:191], v[60:63]
  buffer_load_dwordx4 v[68:71], v1, s[32:35], s80 offen offset:1024 sc1
  s_waitcnt vmcnt(32)
  v_mfma_f32_16x16x32_bf16 v[48:51], v[72:75], a[192:195], v[48:51]
  s_waitcnt lgkmcnt(0)
  s_add_u32 s57, s96, 866304
  buffer_store_dwordx4 v[12:15], v1, s[32:35], s57 offen sc1
  v_mfma_f32_16x16x32_bf16 v[52:55], v[72:75], a[196:199], v[52:55]
  v_rcp_f32 v5, v5
  v_mfma_f32_16x16x32_bf16 v[56:59], v[72:75], a[200:203], v[56:59]
  v_rcp_f32 v6, v6
  v_rcp_f32 v7, v7
  v_mfma_f32_16x16x32_bf16 v[60:63], v[72:75], a[204:207], v[60:63]
  buffer_load_dwordx4 v[72:75], v1, s[32:35], s80 offen offset:2048 sc1
  v_mfma_f32_16x16x32_bf16 v[48:51], v[76:79], a[208:211], v[48:51]
  v_mul_f32 v4, v4, v40
  v_mul_f32 v5, v5, v41
  v_mul_f32 v6, v6, v42
  v_mul_f32 v7, v7, v43
  v_mfma_f32_16x16x32_bf16 v[52:55], v[76:79], a[212:215], v[52:55]
  v_cvt_pk_bf16_f32 v160, v4, v5
  v_cvt_pk_bf16_f32 v161, v6, v7
  v_fma_f32 v8, v44, v44, v16
  v_fma_f32 v9, v45, v45, v16
  v_mfma_f32_16x16x32_bf16 v[56:59], v[76:79], a[216:219], v[56:59]
  v_fma_f32 v10, v46, v46, v16
  v_fma_f32 v11, v47, v47, v16
  v_mul_f32 v8, v8, v44
  v_mfma_f32_16x16x32_bf16 v[60:63], v[76:79], a[220:223], v[60:63]
  buffer_load_dwordx4 v[76:79], v1, s[32:35], s80 offen offset:3072 sc1
  s_waitcnt vmcnt(33)
  v_mfma_f32_16x16x32_bf16 v[48:51], v[192:195], a[224:227], v[48:51]
  ds_read_b64_tr_b16 v[168:169], v174 offset:96
  ds_read_b64_tr_b16 v[170:171], v174 offset:608
  v_mul_f32 v9, v9, v45
  v_mfma_f32_16x16x32_bf16 v[52:55], v[192:195], a[228:231], v[52:55]
  v_mul_f32 v10, v10, v46
  v_mul_f32 v11, v11, v47
  v_exp_f32_e64 v8, -v8
  v_mfma_f32_16x16x32_bf16 v[56:59], v[192:195], a[232:235], v[56:59]
  v_exp_f32_e64 v9, -v9
  v_mfma_f32_16x16x32_bf16 v[60:63], v[192:195], a[236:239], v[60:63]
  s_add_u32 s80, s80, 4096
  buffer_load_dwordx4 v[192:195], v1, s[32:35], s80 offen offset:0 sc1
  v_exp_f32_e64 v10, -v10
  v_mfma_f32_16x16x32_bf16 v[48:51], v[80:83], a[240:243], v[48:51]
  v_exp_f32_e64 v11, -v11
  v_fma_f32 v8, v8, s82, s82
  v_mfma_f32_16x16x32_bf16 v[52:55], v[80:83], a[244:247], v[52:55]
  v_fma_f32 v9, v9, s82, s82
  v_fma_f32 v10, v10, s82, s82
  v_fma_f32 v11, v11, s82, s82
  v_mfma_f32_16x16x32_bf16 v[56:59], v[80:83], a[248:251], v[56:59]
  v_rcp_f32 v8, v8
  v_mfma_f32_16x16x32_bf16 v[60:63], v[80:83], a[252:255], v[60:63]
  buffer_load_dwordx4 v[80:83], v1, s[32:35], s80 offen offset:1024 sc1
  s_waitcnt vmcnt(33)
  v_mfma_f32_16x16x32_bf16 v[48:51], v[84:87], v[224:227], v[48:51]
  s_waitcnt lgkmcnt(0)
  s_add_u32 s57, s96, 1299456
  buffer_store_dwordx4 v[168:171], v1, s[32:35], s57 offen sc1
  v_mfma_f32_16x16x32_bf16 v[52:55], v[84:87], v[228:231], v[52:55]
  v_mfma_f32_16x16x32_bf16 v[56:59], v[84:87], v[232:235], v[56:59]
  v_rcp_f32 v9, v9
  v_rcp_f32 v10, v10
  v_mfma_f32_16x16x32_bf16 v[60:63], v[84:87], v[236:239], v[60:63]
  buffer_load_dwordx4 v[84:87], v1, s[32:35], s80 offen offset:2048 sc1
  v_mfma_f32_16x16x32_bf16 v[48:51], v[88:91], v[240:243], v[48:51]
  v_rcp_f32 v11, v11
  v_mul_f32 v8, v8, v44
  v_mul_f32 v9, v9, v45
  v_mfma_f32_16x16x32_bf16 v[52:55], v[88:91], v[244:247], v[52:55]
  v_mul_f32 v10, v10, v46
  v_mul_f32 v11, v11, v47
  v_cvt_pk_bf16_f32 v164, v8, v9
  v_cvt_pk_bf16_f32 v165, v10, v11
  v_mfma_f32_16x16x32_bf16 v[56:59], v[88:91], v[248:251], v[56:59]
  v_mfma_f32_16x16x32_bf16 v[60:63], v[88:91], v[252:255], v[60:63]
  buffer_load_dwordx4 v[88:91], v1, s[32:35], s80 offen offset:3072 sc1
  s_waitcnt vmcnt(34)
  v_mfma_f32_16x16x32_bf16 v[32:35], v[216:219], a[0:3], v[144:147]
  v_mfma_f32_16x16x32_bf16 v[36:39], v[216:219], a[4:7], v[144:147]
  v_mfma_f32_16x16x32_bf16 v[40:43], v[216:219], a[8:11], v[144:147]
  v_mfma_f32_16x16x32_bf16 v[44:47], v[216:219], a[12:15], v[144:147]
  s_add_u32 s80, s80, 4096
  buffer_load_dwordx4 v[216:219], v1, s[32:35], s80 offen offset:0 sc1
  ds_read_b128 v[148:151], v17 offset:1280
  v_mfma_f32_16x16x32_bf16 v[32:35], v[92:95], a[16:19], v[32:35]
  v_fma_f32 v4, v48, v48, v16
  v_fma_f32 v5, v49, v49, v16
  v_fma_f32 v6, v50, v50, v16
  v_fma_f32 v7, v51, v51, v16
  v_mfma_f32_16x16x32_bf16 v[36:39], v[92:95], a[20:23], v[36:39]
  v_mul_f32 v4, v4, v48
  ds_read_b64_tr_b16 v[12:13], v174 offset:4096
  ds_read_b64_tr_b16 v[14:15], v174 offset:4608
  v_mfma_f32_16x16x32_bf16 v[40:43], v[92:95], a[24:27], v[40:43]
  v_mul_f32 v5, v5, v49
  v_mul_f32 v6, v6, v50
  v_mfma_f32_16x16x32_bf16 v[44:47], v[92:95], a[28:31], v[44:47]
  buffer_load_dwordx4 v[92:95], v1, s[32:35], s80 offen offset:1024 sc1
  v_mul_f32 v7, v7, v51
  s_waitcnt vmcnt(34)
  v_mfma_f32_16x16x32_bf16 v[32:35], v[220:223], a[32:35], v[32:35]
  v_exp_f32_e64 v4, -v4
  v_exp_f32_e64 v5, -v5
  v_mfma_f32_16x16x32_bf16 v[36:39], v[220:223], a[36:39], v[36:39]
  v_exp_f32_e64 v6, -v6
  v_exp_f32_e64 v7, -v7
  v_mfma_f32_16x16x32_bf16 v[40:43], v[220:223], a[40:43], v[40:43]
  v_fma_f32 v4, v4, s82, s82
  v_fma_f32 v5, v5, s82, s82
  v_fma_f32 v6, v6, s82, s82
  v_mfma_f32_16x16x32_bf16 v[44:47], v[220:223], a[44:47], v[44:47]
  buffer_load_dwordx4 v[220:223], v1, s[32:35], s80 offen offset:2048 sc1
  v_fma_f32 v7, v7, s82, s82
  v_mfma_f32_16x16x32_bf16 v[32:35], v[96:99], a[48:51], v[32:35]
  v_rcp_f32 v4, v4
  v_rcp_f32 v5, v5
  v_mfma_f32_16x16x32_bf16 v[36:39], v[96:99], a[52:55], v[36:39]
  v_mfma_f32_16x16x32_bf16 v[40:43], v[96:99], a[56:59], v[40:43]
  s_waitcnt lgkmcnt(0)
  s_mov_b32 s57, s97
  buffer_store_dwordx4 v[12:15], v1, s[32:35], s57 offen sc1
  v_mfma_f32_16x16x32_bf16 v[44:47], v[96:99], a[60:63], v[44:47]
  buffer_load_dwordx4 v[96:99], v1, s[32:35], s80 offen offset:3072 sc1
  s_waitcnt vmcnt(35)
  v_mfma_f32_16x16x32_bf16 v[32:35], v[196:199], a[64:67], v[32:35]
  v_rcp_f32 v6, v6
  v_mfma_f32_16x16x32_bf16 v[36:39], v[196:199], a[68:71], v[36:39]
  v_rcp_f32 v7, v7
  v_mul_f32 v4, v4, v48
  v_mfma_f32_16x16x32_bf16 v[40:43], v[196:199], a[72:75], v[40:43]
  v_mul_f32 v5, v5, v49
  v_mul_f32 v6, v6, v50
  v_mul_f32 v7, v7, v51
  v_cvt_pk_bf16_f32 v154, v4, v5
  v_mfma_f32_16x16x32_bf16 v[44:47], v[196:199], a[76:79], v[44:47]
  s_add_u32 s80, s80, 4096
  buffer_load_dwordx4 v[196:199], v1, s[32:35], s80 offen offset:0 sc1
  v_cvt_pk_bf16_f32 v155, v6, v7
  v_mfma_f32_16x16x32_bf16 v[32:35], v[100:103], a[80:83], v[32:35]
  ds_write_b128 v18, v[152:155] offset:16384
  v_fma_f32 v8, v52, v52, v16
  v_fma_f32 v9, v53, v53, v16
  v_mfma_f32_16x16x32_bf16 v[36:39], v[100:103], a[84:87], v[36:39]
  v_fma_f32 v10, v54, v54, v16
  v_fma_f32 v11, v55, v55, v16
  v_mul_f32 v8, v8, v52
  v_mfma_f32_16x16x32_bf16 v[40:43], v[100:103], a[88:91], v[40:43]
  ds_read_b64_tr_b16 v[168:169], v174 offset:4128
  ds_read_b64_tr_b16 v[170:171], v174 offset:4640
  v_mfma_f32_16x16x32_bf16 v[44:47], v[100:103], a[92:95], v[44:47]
  buffer_load_dwordx4 v[100:103], v1, s[32:35], s80 offen offset:1024 sc1
  v_mul_f32 v9, v9, v53
  s_waitcnt vmcnt(35)
  v_mfma_f32_16x16x32_bf16 v[32:35], v[200:203], a[96:99], v[32:35]
  v_mul_f32 v10, v10, v54
  v_mul_f32 v11, v11, v55
  v_exp_f32_e64 v8, -v8
  v_mfma_f32_16x16x32_bf16 v[36:39], v[200:203], a[100:103], v[36:39]
  v_exp_f32_e64 v9, -v9
  v_exp_f32_e64 v10, -v10
  v_mfma_f32_16x16x32_bf16 v[40:43], v[200:203], a[104:107], v[40:43]
  v_exp_f32_e64 v11, -v11
  v_fma_f32 v8, v8, s82, s82
  v_mfma_f32_16x16x32_bf16 v[44:47], v[200:203], a[108:111], v[44:47]
  buffer_load_dwordx4 v[200:203], v1, s[32:35], s80 offen offset:2048 sc1
  v_fma_f32 v9, v9, s82, s82
  v_mfma_f32_16x16x32_bf16 v[32:35], v[104:107], a[112:115], v[32:35]
  v_fma_f32 v10, v10, s82, s82
  v_fma_f32 v11, v11, s82, s82
  v_rcp_f32 v8, v8
  v_mfma_f32_16x16x32_bf16 v[36:39], v[104:107], a[116:119], v[36:39]
  v_rcp_f32 v9, v9
  v_mfma_f32_16x16x32_bf16 v[40:43], v[104:107], a[120:123], v[40:43]
  s_waitcnt lgkmcnt(0)
  s_add_u32 s57, s97, 433152
  buffer_store_dwordx4 v[168:171], v1, s[32:35], s57 offen sc1
  v_mfma_f32_16x16x32_bf16 v[44:47], v[104:107], a[124:127], v[44:47]
  buffer_load_dwordx4 v[104:107], v1, s[32:35], s80 offen offset:3072 sc1
  s_waitcnt vmcnt(36)
  v_mfma_f32_16x16x32_bf16 v[32:35], v[204:207], a[128:131], v[32:35]
  v_mfma_f32_16x16x32_bf16 v[36:39], v[204:207], a[132:135], v[36:39]
  v_rcp_f32 v10, v10
  v_rcp_f32 v11, v11
  v_mfma_f32_16x16x32_bf16 v[40:43], v[204:207], a[136:139], v[40:43]
  v_mul_f32 v8, v8, v52
  v_mul_f32 v9, v9, v53
  v_mul_f32 v10, v10, v54
  v_mfma_f32_16x16x32_bf16 v[44:47], v[204:207], a[140:143], v[44:47]
  s_add_u32 s80, s80, 4096
  buffer_load_dwordx4 v[204:207], v1, s[32:35], s80 offen offset:0 sc1
  v_mul_f32 v11, v11, v55
  v_mfma_f32_16x16x32_bf16 v[32:35], v[108:111], a[144:147], v[32:35]
  v_cvt_pk_bf16_f32 v158, v8, v9
  v_cvt_pk_bf16_f32 v159, v10, v11
  ds_write_b128 v18, v[156:159] offset:17408
  v_mfma_f32_16x16x32_bf16 v[36:39], v[108:111], a[148:151], v[36:39]
  v_fma_f32 v4, v56, v56, v16
  v_fma_f32 v5, v57, v57, v16
  v_fma_f32 v6, v58, v58, v16
  v_fma_f32 v7, v59, v59, v16
  v_mfma_f32_16x16x32_bf16 v[40:43], v[108:111], a[152:155], v[40:43]
  v_mul_f32 v4, v4, v56
  ds_read_b64_tr_b16 v[12:13], v174 offset:4160
  ds_read_b64_tr_b16 v[14:15], v174 offset:4672
  v_mfma_f32_16x16x32_bf16 v[44:47], v[108:111], a[156:159], v[44:47]
  buffer_load_dwordx4 v[108:111], v1, s[32:35], s80 offen offset:1024 sc1
  s_waitcnt vmcnt(36)
  v_mfma_f32_16x16x32_bf16 v[32:35], v[208:211], a[160:163], v[32:35]
  v_mul_f32 v5, v5, v57
  v_mul_f32 v6, v6, v58
  v_mul_f32 v7, v7, v59
  v_mfma_f32_16x16x32_bf16 v[36:39], v[208:211], a[164:167], v[36:39]
  v_exp_f32_e64 v4, -v4
  v_exp_f32_e64 v5, -v5
  v_mfma_f32_16x16x32_bf16 v[40:43], v[208:211], a[168:171], v[40:43]
  v_exp_f32_e64 v6, -v6
  v_exp_f32_e64 v7, -v7
  v_mfma_f32_16x16x32_bf16 v[44:47], v[208:211], a[172:175], v[44:47]
  buffer_load_dwordx4 v[208:211], v1, s[32:35], s80 offen offset:2048 sc1
  v_mfma_f32_16x16x32_bf16 v[32:35], v[112:115], a[176:179], v[32:35]
  v_fma_f32 v4, v4, s82, s82
  v_fma_f32 v5, v5, s82, s82
  v_fma_f32 v6, v6, s82, s82
  v_fma_f32 v7, v7, s82, s82
  v_mfma_f32_16x16x32_bf16 v[36:39], v[112:115], a[180:183], v[36:39]
  v_rcp_f32 v4, v4
  v_rcp_f32 v5, v5
  v_mfma_f32_16x16x32_bf16 v[40:43], v[112:115], a[184:187], v[40:43]
  v_mfma_f32_16x16x32_bf16 v[44:47], v[112:115], a[188:191], v[44:47]
  buffer_load_dwordx4 v[112:115], v1, s[32:35], s80 offen offset:3072 sc1
  s_waitcnt vmcnt(36)
  v_mfma_f32_16x16x32_bf16 v[32:35], v[212:215], a[192:195], v[32:35]
  s_waitcnt lgkmcnt(0)
  s_add_u32 s57, s97, 866304
  buffer_store_dwordx4 v[12:15], v1, s[32:35], s57 offen sc1
  v_mfma_f32_16x16x32_bf16 v[36:39], v[212:215], a[196:199], v[36:39]
  v_rcp_f32 v6, v6
  v_mfma_f32_16x16x32_bf16 v[40:43], v[212:215], a[200:203], v[40:43]
  v_rcp_f32 v7, v7
  v_mul_f32 v4, v4, v56
  v_mul_f32 v5, v5, v57
  v_mfma_f32_16x16x32_bf16 v[44:47], v[212:215], a[204:207], v[44:47]
  s_add_u32 s80, s80, 4096
  buffer_load_dwordx4 v[212:215], v1, s[32:35], s80 offen offset:0 sc1
  v_mfma_f32_16x16x32_bf16 v[32:35], v[116:119], a[208:211], v[32:35]
  v_mul_f32 v6, v6, v58
  v_mul_f32 v7, v7, v59
  v_cvt_pk_bf16_f32 v162, v4, v5
  v_cvt_pk_bf16_f32 v163, v6, v7
  v_mfma_f32_16x16x32_bf16 v[36:39], v[116:119], a[212:215], v[36:39]
  ds_write_b128 v18, v[160:163] offset:18432
  v_fma_f32 v8, v60, v60, v16
  v_fma_f32 v9, v61, v61, v16
  v_mfma_f32_16x16x32_bf16 v[40:43], v[116:119], a[216:219], v[40:43]
  v_fma_f32 v10, v62, v62, v16
  v_fma_f32 v11, v63, v63, v16
  v_mul_f32 v8, v8, v60
  v_mfma_f32_16x16x32_bf16 v[44:47], v[116:119], a[220:223], v[44:47]
  buffer_load_dwordx4 v[116:119], v1, s[32:35], s80 offen offset:1024 sc1
  s_waitcnt vmcnt(37)
  v_mfma_f32_16x16x32_bf16 v[32:35], v[176:179], a[224:227], v[32:35]
  ds_read_b64_tr_b16 v[168:169], v174 offset:4192
  ds_read_b64_tr_b16 v[170:171], v174 offset:4704
  v_mul_f32 v9, v9, v61
  v_mfma_f32_16x16x32_bf16 v[36:39], v[176:179], a[228:231], v[36:39]
  v_mul_f32 v10, v10, v62
  v_mul_f32 v11, v11, v63
  v_exp_f32_e64 v8, -v8
  v_mfma_f32_16x16x32_bf16 v[40:43], v[176:179], a[232:235], v[40:43]
  v_exp_f32_e64 v9, -v9
  v_exp_f32_e64 v10, -v10
  v_mfma_f32_16x16x32_bf16 v[44:47], v[176:179], a[236:239], v[44:47]
  buffer_load_dwordx4 v[176:179], v1, s[32:35], s80 offen offset:2048 sc1
  v_mfma_f32_16x16x32_bf16 v[32:35], v[120:123], a[240:243], v[32:35]
  v_exp_f32_e64 v11, -v11
  v_fma_f32 v8, v8, s82, s82
  v_fma_f32 v9, v9, s82, s82
  v_mfma_f32_16x16x32_bf16 v[36:39], v[120:123], a[244:247], v[36:39]
  v_fma_f32 v10, v10, s82, s82
  v_fma_f32 v11, v11, s82, s82
  v_rcp_f32 v8, v8
  v_mfma_f32_16x16x32_bf16 v[40:43], v[120:123], a[248:251], v[40:43]
  v_rcp_f32 v9, v9
  v_mfma_f32_16x16x32_bf16 v[44:47], v[120:123], a[252:255], v[44:47]
  buffer_load_dwordx4 v[120:123], v1, s[32:35], s80 offen offset:3072 sc1
  s_waitcnt vmcnt(36)
  v_mfma_f32_16x16x32_bf16 v[32:35], v[180:183], v[224:227], v[32:35]
  s_waitcnt lgkmcnt(0)
  s_add_u32 s57, s97, 1299456
  buffer_store_dwordx4 v[168:171], v1, s[32:35], s57 offen sc1
  v_mfma_f32_16x16x32_bf16 v[36:39], v[180:183], v[228:231], v[36:39]
  v_mfma_f32_16x16x32_bf16 v[40:43], v[180:183], v[232:235], v[40:43]
  v_rcp_f32 v10, v10
  v_rcp_f32 v11, v11
  v_mfma_f32_16x16x32_bf16 v[44:47], v[180:183], v[236:239], v[44:47]
  s_add_u32 s80, s80, 4096
  buffer_load_dwordx4 v[180:183], v1, s[32:35], s80 offen offset:0 sc1
  v_mfma_f32_16x16x32_bf16 v[32:35], v[184:187], v[240:243], v[32:35]
  v_mul_f32 v8, v8, v60
  v_mul_f32 v9, v9, v61
  v_mul_f32 v10, v10, v62
  v_mul_f32 v11, v11, v63
  v_mfma_f32_16x16x32_bf16 v[36:39], v[184:187], v[244:247], v[36:39]
  v_cvt_pk_bf16_f32 v166, v8, v9
  v_cvt_pk_bf16_f32 v167, v10, v11
  ds_write_b128 v18, v[164:167] offset:19456
  v_mfma_f32_16x16x32_bf16 v[40:43], v[184:187], v[248:251], v[40:43]
  v_mfma_f32_16x16x32_bf16 v[44:47], v[184:187], v[252:255], v[44:47]
  buffer_load_dwordx4 v[184:187], v1, s[32:35], s80 offen offset:1024 sc1
  s_waitcnt vmcnt(37)
  v_mfma_f32_16x16x32_bf16 v[48:51], v[124:127], a[0:3], v[148:151]
  v_mfma_f32_16x16x32_bf16 v[52:55], v[124:127], a[4:7], v[148:151]
  v_mfma_f32_16x16x32_bf16 v[56:59], v[124:127], a[8:11], v[148:151]
  v_mfma_f32_16x16x32_bf16 v[60:63], v[124:127], a[12:15], v[148:151]
  buffer_load_dwordx4 v[124:127], v1, s[32:35], s80 offen offset:2048 sc1
  v_mfma_f32_16x16x32_bf16 v[48:51], v[128:131], a[16:19], v[48:51]
  ds_read_b128 v[144:147], v17 offset:1536
  v_fma_f32 v4, v32, v32, v16
  v_fma_f32 v5, v33, v33, v16
  v_mfma_f32_16x16x32_bf16 v[52:55], v[128:131], a[20:23], v[52:55]
  v_fma_f32 v6, v34, v34, v16
  v_fma_f32 v7, v35, v35, v16
  v_mfma_f32_16x16x32_bf16 v[56:59], v[128:131], a[24:27], v[56:59]
  v_mul_f32 v4, v4, v32
  v_mul_f32 v5, v5, v33
  v_mul_f32 v6, v6, v34
  v_mfma_f32_16x16x32_bf16 v[60:63], v[128:131], a[28:31], v[60:63]
  buffer_load_dwordx4 v[128:131], v1, s[32:35], s80 offen offset:3072 sc1
  s_waitcnt vmcnt(36)
  v_mfma_f32_16x16x32_bf16 v[48:51], v[132:135], a[32:35], v[48:51]
  v_mul_f32 v7, v7, v35
  v_exp_f32_e64 v4, -v4
  v_mfma_f32_16x16x32_bf16 v[52:55], v[132:135], a[36:39], v[52:55]
  v_exp_f32_e64 v5, -v5
  v_mfma_f32_16x16x32_bf16 v[56:59], v[132:135], a[40:43], v[56:59]
  v_exp_f32_e64 v6, -v6
  v_exp_f32_e64 v7, -v7
  v_mfma_f32_16x16x32_bf16 v[60:63], v[132:135], a[44:47], v[60:63]
  s_add_u32 s80, s80, 4096
  buffer_load_dwordx4 v[132:135], v1, s[32:35], s80 offen offset:0 sc1
  v_mfma_f32_16x16x32_bf16 v[48:51], v[136:139], a[48:51], v[48:51]
  v_fma_f32 v4, v4, s82, s82
  v_fma_f32 v5, v5, s82, s82
  v_mfma_f32_16x16x32_bf16 v[52:55], v[136:139], a[52:55], v[52:55]
  v_fma_f32 v6, v6, s82, s82
  v_fma_f32 v7, v7, s82, s82
  v_mfma_f32_16x16x32_bf16 v[56:59], v[136:139], a[56:59], v[56:59]
  v_rcp_f32 v4, v4
  v_rcp_f32 v5, v5
  v_mfma_f32_16x16x32_bf16 v[60:63], v[136:139], a[60:63], v[60:63]
  buffer_load_dwordx4 v[136:139], v1, s[32:35], s80 offen offset:1024 sc1
  s_waitcnt vmcnt(36)
  v_mfma_f32_16x16x32_bf16 v[48:51], v[188:191], a[64:67], v[48:51]
  v_rcp_f32 v6, v6
  v_mfma_f32_16x16x32_bf16 v[52:55], v[188:191], a[68:71], v[52:55]
  v_rcp_f32 v7, v7
  v_mul_f32 v4, v4, v32
  v_mfma_f32_16x16x32_bf16 v[56:59], v[188:191], a[72:75], v[56:59]
  v_mul_f32 v5, v5, v33
  v_mul_f32 v6, v6, v34
  v_mul_f32 v7, v7, v35
  v_mfma_f32_16x16x32_bf16 v[60:63], v[188:191], a[76:79], v[60:63]
  buffer_load_dwordx4 v[188:191], v1, s[32:35], s80 offen offset:2048 sc1
  v_mfma_f32_16x16x32_bf16 v[48:51], v[140:143], a[80:83], v[48:51]
  v_cvt_pk_bf16_f32 v152, v4, v5
  v_cvt_pk_bf16_f32 v153, v6, v7
  v_fma_f32 v8, v36, v36, v16
  v_mfma_f32_16x16x32_bf16 v[52:55], v[140:143], a[84:87], v[52:55]
  v_fma_f32 v9, v37, v37, v16
  v_fma_f32 v10, v38, v38, v16
  v_mfma_f32_16x16x32_bf16 v[56:59], v[140:143], a[88:91], v[56:59]
  v_fma_f32 v11, v39, v39, v16
  v_mul_f32 v8, v8, v36
  v_mul_f32 v9, v9, v37
  v_mfma_f32_16x16x32_bf16 v[60:63], v[140:143], a[92:95], v[60:63]
  buffer_load_dwordx4 v[140:143], v1, s[32:35], s80 offen offset:3072 sc1
  s_waitcnt vmcnt(36)
  v_mfma_f32_16x16x32_bf16 v[48:51], v[64:67], a[96:99], v[48:51]
  v_mul_f32 v10, v10, v38
  v_mul_f32 v11, v11, v39
  v_mfma_f32_16x16x32_bf16 v[52:55], v[64:67], a[100:103], v[52:55]
  v_exp_f32_e64 v8, -v8
  v_exp_f32_e64 v9, -v9
  v_mfma_f32_16x16x32_bf16 v[56:59], v[64:67], a[104:107], v[56:59]
  v_exp_f32_e64 v10, -v10
  v_mfma_f32_16x16x32_bf16 v[60:63], v[64:67], a[108:111], v[60:63]
  s_add_u32 s80, s80, 4096
  buffer_load_dwordx4 v[64:67], v1, s[32:35], s80 offen offset:0 sc1
  v_mfma_f32_16x16x32_bf16 v[48:51], v[68:71], a[112:115], v[48:51]
  v_exp_f32_e64 v11, -v11
  v_fma_f32 v8, v8, s82, s82
  v_mfma_f32_16x16x32_bf16 v[52:55], v[68:71], a[116:119], v[52:55]
  v_fma_f32 v9, v9, s82, s82
  v_fma_f32 v10, v10, s82, s82
  v_fma_f32 v11, v11, s82, s82
  v_mfma_f32_16x16x32_bf16 v[56:59], v[68:71], a[120:123], v[56:59]
  v_rcp_f32 v8, v8
  v_mfma_f32_16x16x32_bf16 v[60:63], v[68:71], a[124:127], v[60:63]
  buffer_load_dwordx4 v[68:71], v1, s[32:35], s80 offen offset:1024 sc1
  s_waitcnt vmcnt(35)
  v_mfma_f32_16x16x32_bf16 v[48:51], v[72:75], a[128:131], v[48:51]
  v_rcp_f32 v9, v9
  v_rcp_f32 v10, v10
  v_mfma_f32_16x16x32_bf16 v[52:55], v[72:75], a[132:135], v[52:55]
  v_rcp_f32 v11, v11
  v_mfma_f32_16x16x32_bf16 v[56:59], v[72:75], a[136:139], v[56:59]
  v_mul_f32 v8, v8, v36
  v_mul_f32 v9, v9, v37
  v_mul_f32 v10, v10, v38
  v_mfma_f32_16x16x32_bf16 v[60:63], v[72:75], a[140:143], v[60:63]
  buffer_load_dwordx4 v[72:75], v1, s[32:35], s80 offen offset:2048 sc1
  v_mfma_f32_16x16x32_bf16 v[48:51], v[76:79], a[144:147], v[48:51]
  v_mul_f32 v11, v11, v39
  v_cvt_pk_bf16_f32 v156, v8, v9
  v_cvt_pk_bf16_f32 v157, v10, v11
  v_mfma_f32_16x16x32_bf16 v[52:55], v[76:79], a[148:151], v[52:55]
  v_fma_f32 v4, v40, v40, v16
  v_fma_f32 v5, v41, v41, v16
  v_mfma_f32_16x16x32_bf16 v[56:59], v[76:79], a[152:155], v[56:59]
  v_fma_f32 v6, v42, v42, v16
  v_fma_f32 v7, v43, v43, v16
  v_mul_f32 v4, v4, v40
  v_mfma_f32_16x16x32_bf16 v[60:63], v[76:79], a[156:159], v[60:63]
  buffer_load_dwordx4 v[76:79], v1, s[32:35], s80 offen offset:3072 sc1
  s_waitcnt vmcnt(35)
  v_mfma_f32_16x16x32_bf16 v[48:51], v[192:195], a[160:163], v[48:51]
  v_mul_f32 v5, v5, v41
  v_mul_f32 v6, v6, v42
  v_mul_f32 v7, v7, v43
  v_mfma_f32_16x16x32_bf16 v[52:55], v[192:195], a[164:167], v[52:55]
  v_exp_f32_e64 v4, -v4
  v_mfma_f32_16x16x32_bf16 v[56:59], v[192:195], a[168:171], v[56:59]
  v_exp_f32_e64 v5, -v5
  v_exp_f32_e64 v6, -v6
  v_mfma_f32_16x16x32_bf16 v[60:63], v[192:195], a[172:175], v[60:63]
  s_add_u32 s80, s80, 4096
  buffer_load_dwordx4 v[192:195], v1, s[32:35], s80 offen offset:0 sc1
  v_mfma_f32_16x16x32_bf16 v[48:51], v[80:83], a[176:179], v[48:51]
  v_exp_f32_e64 v7, -v7
  v_mfma_f32_16x16x32_bf16 v[52:55], v[80:83], a[180:183], v[52:55]
  v_fma_f32 v4, v4, s82, s82
  v_fma_f32 v5, v5, s82, s82
  v_fma_f32 v6, v6, s82, s82
  v_mfma_f32_16x16x32_bf16 v[56:59], v[80:83], a[184:187], v[56:59]
  v_fma_f32 v7, v7, s82, s82
  v_rcp_f32 v4, v4
  v_mfma_f32_16x16x32_bf16 v[60:63], v[80:83], a[188:191], v[60:63]
  buffer_load_dwordx4 v[80:83], v1, s[32:35], s80 offen offset:1024 sc1
  s_waitcnt vmcnt(34)
  v_mfma_f32_16x16x32_bf16 v[48:51], v[84:87], a[192:195], v[48:51]
  v_rcp_f32 v5, v5
  v_mfma_f32_16x16x32_bf16 v[52:55], v[84:87], a[196:199], v[52:55]
  v_rcp_f32 v6, v6
  v_mfma_f32_16x16x32_bf16 v[56:59], v[84:87], a[200:203], v[56:59]
  v_rcp_f32 v7, v7
  v_mul_f32 v4, v4, v40
  v_mul_f32 v5, v5, v41
  v_mfma_f32_16x16x32_bf16 v[60:63], v[84:87], a[204:207], v[60:63]
  buffer_load_dwordx4 v[84:87], v1, s[32:35], s80 offen offset:2048 sc1
  v_mfma_f32_16x16x32_bf16 v[48:51], v[88:91], a[208:211], v[48:51]
  v_mul_f32 v6, v6, v42
  v_mul_f32 v7, v7, v43
  v_mfma_f32_16x16x32_bf16 v[52:55], v[88:91], a[212:215], v[52:55]
  v_cvt_pk_bf16_f32 v160, v4, v5
  v_cvt_pk_bf16_f32 v161, v6, v7
  v_fma_f32 v8, v44, v44, v16
  v_mfma_f32_16x16x32_bf16 v[56:59], v[88:91], a[216:219], v[56:59]
  v_fma_f32 v9, v45, v45, v16
  v_fma_f32 v10, v46, v46, v16
  v_fma_f32 v11, v47, v47, v16
  v_mfma_f32_16x16x32_bf16 v[60:63], v[88:91], a[220:223], v[60:63]
  buffer_load_dwordx4 v[88:91], v1, s[32:35], s80 offen offset:3072 sc1
  s_waitcnt vmcnt(34)
  v_mfma_f32_16x16x32_bf16 v[48:51], v[216:219], a[224:227], v[48:51]
  v_mul_f32 v8, v8, v44
  v_mul_f32 v9, v9, v45
  v_mul_f32 v10, v10, v46
  v_mfma_f32_16x16x32_bf16 v[52:55], v[216:219], a[228:231], v[52:55]
  v_mul_f32 v11, v11, v47
  v_exp_f32_e64 v8, -v8
  v_mfma_f32_16x16x32_bf16 v[56:59], v[216:219], a[232:235], v[56:59]
  v_exp_f32_e64 v9, -v9
  v_mfma_f32_16x16x32_bf16 v[60:63], v[216:219], a[236:239], v[60:63]
  s_add_u32 s80, s80, 4096
  buffer_load_dwordx4 v[216:219], v1, s[32:35], s80 offen offset:0 sc1
  v_mfma_f32_16x16x32_bf16 v[48:51], v[92:95], a[240:243], v[48:51]
  v_exp_f32_e64 v10, -v10
  v_mfma_f32_16x16x32_bf16 v[52:55], v[92:95], a[244:247], v[52:55]
  v_exp_f32_e64 v11, -v11
  v_fma_f32 v8, v8, s82, s82
  v_fma_f32 v9, v9, s82, s82
  v_mfma_f32_16x16x32_bf16 v[56:59], v[92:95], a[248:251], v[56:59]
  v_fma_f32 v10, v10, s82, s82
  v_fma_f32 v11, v11, s82, s82
  v_mfma_f32_16x16x32_bf16 v[60:63], v[92:95], a[252:255], v[60:63]
  buffer_load_dwordx4 v[92:95], v1, s[32:35], s80 offen offset:1024 sc1
  s_waitcnt vmcnt(33)
  v_mfma_f32_16x16x32_bf16 v[48:51], v[220:223], v[224:227], v[48:51]
  v_rcp_f32 v8, v8
  v_rcp_f32 v9, v9
  v_mfma_f32_16x16x32_bf16 v[52:55], v[220:223], v[228:231], v[52:55]
  v_rcp_f32 v10, v10
  v_mfma_f32_16x16x32_bf16 v[56:59], v[220:223], v[232:235], v[56:59]
  v_rcp_f32 v11, v11
  v_mul_f32 v8, v8, v44
  v_mfma_f32_16x16x32_bf16 v[60:63], v[220:223], v[236:239], v[60:63]
  buffer_load_dwordx4 v[220:223], v1, s[32:35], s80 offen offset:2048 sc1
  v_mfma_f32_16x16x32_bf16 v[48:51], v[96:99], v[240:243], v[48:51]
  v_mul_f32 v9, v9, v45
  v_mul_f32 v10, v10, v46
  v_mfma_f32_16x16x32_bf16 v[52:55], v[96:99], v[244:247], v[52:55]
  v_mul_f32 v11, v11, v47
  v_cvt_pk_bf16_f32 v164, v8, v9
  v_cvt_pk_bf16_f32 v165, v10, v11
  v_mfma_f32_16x16x32_bf16 v[56:59], v[96:99], v[248:251], v[56:59]
  v_mfma_f32_16x16x32_bf16 v[60:63], v[96:99], v[252:255], v[60:63]
  buffer_load_dwordx4 v[96:99], v1, s[32:35], s80 offen offset:3072 sc1
  s_waitcnt vmcnt(20)
  s_barrier
  s_add_u32 s56, s85, 35979264
  s_cmp_eq_u32 s26, 0
  s_cselect_b32 s56, s56, 1879048192
  v_mov_b32 v172, s29
  v_mov_b32 v173, 0
  s_mov_b64 exec, 1
  buffer_store_dword v172, v173, s[32:35], s56 offen sc1
  s_mov_b64 exec, -1
  s_waitcnt lgkmcnt(0)
  v_mfma_f32_16x16x32_bf16 v[32:35], v[196:199], a[0:3], v[144:147]
  v_mfma_f32_16x16x32_bf16 v[36:39], v[196:199], a[4:7], v[144:147]
  v_mfma_f32_16x16x32_bf16 v[40:43], v[196:199], a[8:11], v[144:147]
  v_mfma_f32_16x16x32_bf16 v[44:47], v[196:199], a[12:15], v[144:147]
  s_add_u32 s80, s80, 4096
  buffer_load_dwordx4 v[196:199], v1, s[32:35], s80 offen offset:0 sc1
  v_mfma_f32_16x16x32_bf16 v[32:35], v[100:103], a[16:19], v[32:35]
  ds_read_b128 v[148:151], v17 offset:1792
  v_fma_f32 v4, v48, v48, v16
  v_fma_f32 v5, v49, v49, v16
  v_mfma_f32_16x16x32_bf16 v[36:39], v[100:103], a[20:23], v[36:39]
  v_fma_f32 v6, v50, v50, v16
  v_fma_f32 v7, v51, v51, v16
  v_mul_f32 v4, v4, v48
  v_mfma_f32_16x16x32_bf16 v[40:43], v[100:103], a[24:27], v[40:43]
  v_mul_f32 v5, v5, v49
  v_mul_f32 v6, v6, v50
  v_mul_f32 v7, v7, v51
  v_mfma_f32_16x16x32_bf16 v[44:47], v[100:103], a[28:31], v[44:47]
  buffer_load_dwordx4 v[100:103], v1, s[32:35], s80 offen offset:1024 sc1
  v_mfma_f32_16x16x32_bf16 v[32:35], v[200:203], a[32:35], v[32:35]
  v_exp_f32_e64 v4, -v4
  v_mfma_f32_16x16x32_bf16 v[36:39], v[200:203], a[36:39], v[36:39]
  v_exp_f32_e64 v5, -v5
  v_exp_f32_e64 v6, -v6
  v_mfma_f32_16x16x32_bf16 v[40:43], v[200:203], a[40:43], v[40:43]
  v_exp_f32_e64 v7, -v7
  v_fma_f32 v4, v4, s82, s82
  v_mfma_f32_16x16x32_bf16 v[44:47], v[200:203], a[44:47], v[44:47]
  buffer_load_dwordx4 v[200:203], v1, s[32:35], s80 offen offset:2048 sc1
  v_mfma_f32_16x16x32_bf16 v[32:35], v[104:107], a[48:51], v[32:35]
  v_fma_f32 v5, v5, s82, s82
  v_fma_f32 v6, v6, s82, s82
  v_fma_f32 v7, v7, s82, s82
  v_mfma_f32_16x16x32_bf16 v[36:39], v[104:107], a[52:55], v[36:39]
  v_rcp_f32 v4, v4
  v_mfma_f32_16x16x32_bf16 v[40:43], v[104:107], a[56:59], v[40:43]
  v_rcp_f32 v5, v5
  v_rcp_f32 v6, v6
  v_mfma_f32_16x16x32_bf16 v[44:47], v[104:107], a[60:63], v[44:47]
  buffer_load_dwordx4 v[104:107], v1, s[32:35], s80 offen offset:3072 sc1
  v_mfma_f32_16x16x32_bf16 v[32:35], v[204:207], a[64:67], v[32:35]
  v_rcp_f32 v7, v7
  v_mfma_f32_16x16x32_bf16 v[36:39], v[204:207], a[68:71], v[36:39]
  v_mul_f32 v4, v4, v48
  v_mul_f32 v5, v5, v49
  v_mul_f32 v6, v6, v50
  v_mfma_f32_16x16x32_bf16 v[40:43], v[204:207], a[72:75], v[40:43]
  v_mul_f32 v7, v7, v51
  v_cvt_pk_bf16_f32 v154, v4, v5
  v_cvt_pk_bf16_f32 v155, v6, v7
  v_mfma_f32_16x16x32_bf16 v[44:47], v[204:207], a[76:79], v[44:47]
  s_add_u32 s80, s80, 4096
  buffer_load_dwordx4 v[204:207], v1, s[32:35], s80 offen offset:0 sc1
  v_mfma_f32_16x16x32_bf16 v[32:35], v[108:111], a[80:83], v[32:35]
  ds_write_b128 v18, v[152:155] offset:32768
  v_fma_f32 v8, v52, v52, v16
  v_mfma_f32_16x16x32_bf16 v[36:39], v[108:111], a[84:87], v[36:39]
  v_fma_f32 v9, v53, v53, v16
  v_fma_f32 v10, v54, v54, v16
  v_fma_f32 v11, v55, v55, v16
  v_mfma_f32_16x16x32_bf16 v[40:43], v[108:111], a[88:91], v[40:43]
  v_mul_f32 v8, v8, v52
  v_mul_f32 v9, v9, v53
  v_mul_f32 v10, v10, v54
  v_mfma_f32_16x16x32_bf16 v[44:47], v[108:111], a[92:95], v[44:47]
  buffer_load_dwordx4 v[108:111], v1, s[32:35], s80 offen offset:1024 sc1
  v_mfma_f32_16x16x32_bf16 v[32:35], v[208:211], a[96:99], v[32:35]
  v_mul_f32 v11, v11, v55
  v_exp_f32_e64 v8, -v8
  v_mfma_f32_16x16x32_bf16 v[36:39], v[208:211], a[100:103], v[36:39]
  v_exp_f32_e64 v9, -v9
  v_mfma_f32_16x16x32_bf16 v[40:43], v[208:211], a[104:107], v[40:43]
  v_exp_f32_e64 v10, -v10
  v_exp_f32_e64 v11, -v11
  v_mfma_f32_16x16x32_bf16 v[44:47], v[208:211], a[108:111], v[44:47]
  buffer_load_dwordx4 v[208:211], v1, s[32:35], s80 offen offset:2048 sc1
  v_mfma_f32_16x16x32_bf16 v[32:35], v[112:115], a[112:115], v[32:35]
  v_fma_f32 v8, v8, s82, s82
  v_fma_f32 v9, v9, s82, s82
  v_fma_f32 v10, v10, s82, s82
  v_mfma_f32_16x16x32_bf16 v[36:39], v[112:115], a[116:119], v[36:39]
  v_fma_f32 v11, v11, s82, s82
  v_rcp_f32 v8, v8
  v_mfma_f32_16x16x32_bf16 v[40:43], v[112:115], a[120:123], v[40:43]
  v_rcp_f32 v9, v9
  v_mfma_f32_16x16x32_bf16 v[44:47], v[112:115], a[124:127], v[44:47]
  buffer_load_dwordx4 v[112:115], v1, s[32:35], s80 offen offset:3072 sc1
  v_mfma_f32_16x16x32_bf16 v[32:35], v[212:215], a[128:131], v[32:35]
  v_rcp_f32 v10, v10
  v_rcp_f32 v11, v11
  v_mfma_f32_16x16x32_bf16 v[36:39], v[212:215], a[132:135], v[36:39]
  v_mul_f32 v8, v8, v52
  v_mul_f32 v9, v9, v53
  v_mul_f32 v10, v10, v54
  v_mfma_f32_16x16x32_bf16 v[40:43], v[212:215], a[136:139], v[40:43]
  v_mul_f32 v11, v11, v55
  v_cvt_pk_bf16_f32 v158, v8, v9
  v_cvt_pk_bf16_f32 v159, v10, v11
  v_mfma_f32_16x16x32_bf16 v[44:47], v[212:215], a[140:143], v[44:47]
  s_add_u32 s80, s80, 4096
  buffer_load_dwordx4 v[212:215], v1, s[32:35], s80 offen offset:0 sc1
  v_mfma_f32_16x16x32_bf16 v[32:35], v[116:119], a[144:147], v[32:35]
  ds_write_b128 v18, v[156:159] offset:33792
  v_mfma_f32_16x16x32_bf16 v[36:39], v[116:119], a[148:151], v[36:39]
  v_fma_f32 v4, v56, v56, v16
  v_fma_f32 v5, v57, v57, v16
  v_fma_f32 v6, v58, v58, v16
  v_mfma_f32_16x16x32_bf16 v[40:43], v[116:119], a[152:155], v[40:43]
  v_fma_f32 v7, v59, v59, v16
  s_lshl_b32 s52, s27, 12
  s_add_u32 s52, s52, 35979264
  v_lshlrev_b32 v14, 3, v1
  v_and_b32 v14, 0xf80, v14
  buffer_load_dword v12, v14, s[32:35], s52 offen sc1
  v_mfma_f32_16x16x32_bf16 v[44:47], v[116:119], a[156:159], v[44:47]
  buffer_load_dwordx4 v[116:119], v1, s[32:35], s80 offen offset:1024 sc1
  v_mfma_f32_16x16x32_bf16 v[32:35], v[176:179], a[160:163], v[32:35]
  v_mul_f32 v4, v4, v56
  v_mul_f32 v5, v5, v57
  v_mul_f32 v6, v6, v58
  v_mfma_f32_16x16x32_bf16 v[36:39], v[176:179], a[164:167], v[36:39]
  v_mul_f32 v7, v7, v59
  v_exp_f32_e64 v4, -v4
  v_mfma_f32_16x16x32_bf16 v[40:43], v[176:179], a[168:171], v[40:43]
  v_exp_f32_e64 v5, -v5
  v_exp_f32_e64 v6, -v6
  v_mfma_f32_16x16x32_bf16 v[44:47], v[176:179], a[172:175], v[44:47]
  buffer_load_dwordx4 v[176:179], v1, s[32:35], s80 offen offset:2048 sc1
  v_mfma_f32_16x16x32_bf16 v[32:35], v[120:123], a[176:179], v[32:35]
  v_exp_f32_e64 v7, -v7
  v_mfma_f32_16x16x32_bf16 v[36:39], v[120:123], a[180:183], v[36:39]
  v_fma_f32 v4, v4, s82, s82
  v_fma_f32 v5, v5, s82, s82
  v_fma_f32 v6, v6, s82, s82
  v_mfma_f32_16x16x32_bf16 v[40:43], v[120:123], a[184:187], v[40:43]
  v_fma_f32 v7, v7, s82, s82
  v_rcp_f32 v4, v4
  v_mfma_f32_16x16x32_bf16 v[44:47], v[120:123], a[188:191], v[44:47]
  buffer_load_dwordx4 v[120:123], v1, s[32:35], s80 offen offset:3072 sc1
  s_waitcnt vmcnt(32)
  v_mfma_f32_16x16x32_bf16 v[32:35], v[180:183], a[192:195], v[32:35]
  v_rcp_f32 v5, v5
  v_mfma_f32_16x16x32_bf16 v[36:39], v[180:183], a[196:199], v[36:39]
  v_rcp_f32 v6, v6
  v_rcp_f32 v7, v7
  v_mfma_f32_16x16x32_bf16 v[40:43], v[180:183], a[200:203], v[40:43]
  v_mul_f32 v4, v4, v56
  v_mul_f32 v5, v5, v57
  v_mul_f32 v6, v6, v58
  v_mfma_f32_16x16x32_bf16 v[44:47], v[180:183], a[204:207], v[44:47]
  s_add_u32 s80, s80, 4096
  buffer_load_dwordx4 v[180:183], v1, s[32:35], s80 offen offset:0 sc1
  v_mfma_f32_16x16x32_bf16 v[32:35], v[184:187], a[208:211], v[32:35]
  v_mul_f32 v7, v7, v59
  v_cvt_pk_bf16_f32 v162, v4, v5
  v_cvt_pk_bf16_f32 v163, v6, v7
  v_mfma_f32_16x16x32_bf16 v[36:39], v[184:187], a[212:215], v[36:39]
  ds_write_b128 v18, v[160:163] offset:34816
  v_fma_f32 v8, v60, v60, v16
  v_mfma_f32_16x16x32_bf16 v[40:43], v[184:187], a[216:219], v[40:43]
  v_fma_f32 v9, v61, v61, v16
  v_fma_f32 v10, v62, v62, v16
  v_fma_f32 v11, v63, v63, v16
  v_mfma_f32_16x16x32_bf16 v[44:47], v[184:187], a[220:223], v[44:47]
  buffer_load_dwordx4 v[184:187], v1, s[32:35], s80 offen offset:1024 sc1
  s_waitcnt vmcnt(32)
  v_mfma_f32_16x16x32_bf16 v[32:35], v[124:127], a[224:227], v[32:35]
  v_mul_f32 v8, v8, v60
  v_mul_f32 v9, v9, v61
  v_mul_f32 v10, v10, v62
  v_mfma_f32_16x16x32_bf16 v[36:39], v[124:127], a[228:231], v[36:39]
  v_mul_f32 v11, v11, v63
  v_exp_f32_e64 v8, -v8
  v_mfma_f32_16x16x32_bf16 v[40:43], v[124:127], a[232:235], v[40:43]
  v_exp_f32_e64 v9, -v9
  v_mfma_f32_16x16x32_bf16 v[44:47], v[124:127], a[236:239], v[44:47]
  buffer_load_dwordx4 v[124:127], v1, s[32:35], s80 offen offset:2048 sc1
  v_mfma_f32_16x16x32_bf16 v[32:35], v[128:131], a[240:243], v[32:35]
  v_exp_f32_e64 v10, -v10
  v_exp_f32_e64 v11, -v11
  v_mfma_f32_16x16x32_bf16 v[36:39], v[128:131], a[244:247], v[36:39]
  v_fma_f32 v8, v8, s82, s82
  v_fma_f32 v9, v9, s82, s82
  v_mfma_f32_16x16x32_bf16 v[40:43], v[128:131], a[248:251], v[40:43]
  v_fma_f32 v10, v10, s82, s82
  v_fma_f32 v11, v11, s82, s82
  v_rcp_f32 v8, v8
  v_mfma_f32_16x16x32_bf16 v[44:47], v[128:131], a[252:255], v[44:47]
  buffer_load_dwordx4 v[128:131], v1, s[32:35], s80 offen offset:3072 sc1
  s_waitcnt vmcnt(32)
  v_mfma_f32_16x16x32_bf16 v[32:35], v[132:135], v[224:227], v[32:35]
  v_rcp_f32 v9, v9
  v_mfma_f32_16x16x32_bf16 v[36:39], v[132:135], v[228:231], v[36:39]
  v_rcp_f32 v10, v10
  v_rcp_f32 v11, v11
  v_mfma_f32_16x16x32_bf16 v[40:43], v[132:135], v[232:235], v[40:43]
  v_mul_f32 v8, v8, v60
  v_mul_f32 v9, v9, v61
  v_mfma_f32_16x16x32_bf16 v[44:47], v[132:135], v[236:239], v[44:47]
  s_add_u32 s80, s80, 4096
  buffer_load_dwordx4 v[132:135], v1, s[32:35], s80 offen offset:0 sc1
  v_mfma_f32_16x16x32_bf16 v[32:35], v[136:139], v[240:243], v[32:35]
  v_mul_f32 v10, v10, v62
  v_mul_f32 v11, v11, v63
  v_cvt_pk_bf16_f32 v166, v8, v9
  v_mfma_f32_16x16x32_bf16 v[36:39], v[136:139], v[244:247], v[36:39]
  v_cvt_pk_bf16_f32 v167, v10, v11
  ds_write_b128 v18, v[164:167] offset:35840
  v_mfma_f32_16x16x32_bf16 v[40:43], v[136:139], v[248:251], v[40:43]
  v_mfma_f32_16x16x32_bf16 v[44:47], v[136:139], v[252:255], v[44:47]
  buffer_load_dwordx4 v[136:139], v1, s[32:35], s80 offen offset:1024 sc1
  s_waitcnt lgkmcnt(4)
  s_waitcnt vmcnt(32)
  v_mfma_f32_16x16x32_bf16 v[48:51], v[188:191], a[0:3], v[148:151]
  v_mfma_f32_16x16x32_bf16 v[52:55], v[188:191], a[4:7], v[148:151]
  v_mfma_f32_16x16x32_bf16 v[56:59], v[188:191], a[8:11], v[148:151]
  v_mfma_f32_16x16x32_bf16 v[60:63], v[188:191], a[12:15], v[148:151]
  buffer_load_dwordx4 v[188:191], v1, s[32:35], s80 offen offset:2048 sc1
  v_mfma_f32_16x16x32_bf16 v[48:51], v[140:143], a[16:19], v[48:51]
  ds_read_b128 v[144:147], v17 offset:2048
  v_mfma_f32_16x16x32_bf16 v[52:55], v[140:143], a[20:23], v[52:55]
  s_waitcnt lgkmcnt(0)
  s_waitcnt vmcnt(10)
  s_cmp_eq_u32 s26, 0
  s_cbranch_scc0 Lok_11
  s_mov_b32 s53, 200000
Lsp_12:
  v_cmp_ne_u32 vcc, s29, v12
  s_nop 1
  s_cmp_eq_u64 vcc, 0
  s_cbranch_scc1 Lok_11
  s_sub_u32 s53, s53, 1
  s_cbranch_scc1 Lok_11
  s_sleep 2
  s_lshl_b32 s52, s27, 12
  s_add_u32 s52, s52, 35979264
  buffer_load_dword v12, v14, s[32:35], s52 offen sc1
  s_waitcnt vmcnt(0)
  s_branch Lsp_12
Lok_11:
  s_barrier
  v_fma_f32 v4, v32, v32, v16
  v_mfma_f32_16x16x32_bf16 v[56:59], v[140:143], a[24:27], v[56:59]
  v_fma_f32 v5, v33, v33, v16
  v_fma_f32 v6, v34, v34, v16
  v_fma_f32 v7, v35, v35, v16
  v_mfma_f32_16x16x32_bf16 v[60:63], v[140:143], a[28:31], v[60:63]
  buffer_load_dwordx4 v[140:143], v1, s[32:35], s80 offen offset:3072 sc1
  v_mfma_f32_16x16x32_bf16 v[48:51], v[64:67], a[32:35], v[48:51]
  v_mul_f32 v4, v4, v32
  v_mul_f32 v5, v5, v33
  v_mul_f32 v6, v6, v34
  v_mfma_f32_16x16x32_bf16 v[52:55], v[64:67], a[36:39], v[52:55]
  v_mul_f32 v7, v7, v35
  v_exp_f32_e64 v4, -v4
  v_mfma_f32_16x16x32_bf16 v[56:59], v[64:67], a[40:43], v[56:59]
  v_exp_f32_e64 v5, -v5
  v_exp_f32_e64 v6, -v6
  v_mfma_f32_16x16x32_bf16 v[60:63], v[64:67], a[44:47], v[60:63]
  s_add_u32 s80, s80, 4096
  buffer_load_dwordx4 v[64:67], v1, s[32:35], s80 offen offset:0 sc1
  v_mfma_f32_16x16x32_bf16 v[48:51], v[68:71], a[48:51], v[48:51]
  v_exp_f32_e64 v7, -v7
  v_fma_f32 v4, v4, s82, s82
  v_mfma_f32_16x16x32_bf16 v[52:55], v[68:71], a[52:55], v[52:55]
  v_fma_f32 v5, v5, s82, s82
  v_fma_f32 v6, v6, s82, s82
  v_fma_f32 v7, v7, s82, s82
  v_mfma_f32_16x16x32_bf16 v[56:59], v[68:71], a[56:59], v[56:59]
  v_rcp_f32 v4, v4
  v_rcp_f32 v5, v5
  v_mfma_f32_16x16x32_bf16 v[60:63], v[68:71], a[60:63], v[60:63]
  buffer_load_dwordx4 v[68:71], v1, s[32:35], s80 offen offset:1024 sc1
  v_mfma_f32_16x16x32_bf16 v[48:51], v[72:75], a[64:67], v[48:51]
  v_rcp_f32 v6, v6
  v_rcp_f32 v7, v7
  v_mfma_f32_16x16x32_bf16 v[52:55], v[72:75], a[68:71], v[52:55]
  v_mul_f32 v4, v4, v32
  v_mul_f32 v5, v5, v33
  v_mfma_f32_16x16x32_bf16 v[56:59], v[72:75], a[72:75], v[56:59]
  v_mul_f32 v6, v6, v34
  v_mul_f32 v7, v7, v35
  v_mfma_f32_16x16x32_bf16 v[60:63], v[72:75], a[76:79], v[60:63]
  buffer_load_dwordx4 v[72:75], v1, s[32:35], s80 offen offset:2048 sc1
  v_mfma_f32_16x16x32_bf16 v[48:51], v[76:79], a[80:83], v[48:51]
  v_mfma_f32_16x16x32_bf16 v[52:55], v[76:79], a[84:87], v[52:55]
  v_mfma_f32_16x16x32_bf16 v[56:59], v[76:79], a[88:91], v[56:59]
  s_lshl_b32 s56, s27, 13
  s_add_u32 s56, s56, 37748736
  s_add_u32 s48, s24, s56
  s_addc_u32 s49, s25, 0
  s_mov_b32 s50, 5760
  s_mov_b32 s51, 0x20000
  v_lshrrev_b32 v20, 4, v1
  v_mul_u32_u24 v21, 43, v20
  v_lshrrev_b32 v21, 7, v21
  v_mul_u32_u24 v22, 3, v21
  v_sub_u32 v22, v20, v22
  s_mul_i32 s57, s26, 18
  v_add_u32 v23, s57, v21
  v_mul_u32_u24 v24, 80, v23
  v_mul_u32_u24 v22, 6, v22
  v_lshl_add_u32 v27, v22, 2, v24
  v_add_u32 v22, s57, v22
  v_mul_u32_u24 v25, 192, v22
  v_lshl_add_u32 v25, v23, 1, v25
  v_add_u32 v25, 102400, v25
  v_mov_b32 v22, 135168
  v_cmp_gt_u32 vcc, 54, v20
  s_nop 1
  v_cndmask_b32 v25, v22, v25, vcc
  buffer_load_dwordx2 v[168:169], v27, s[48:51], 0 offen offset:0 sc1
  buffer_load_dwordx2 v[170:171], v27, s[48:51], 0 offen offset:8 sc1
  buffer_load_dwordx2 v[172:173], v27, s[48:51], 0 offen offset:16 sc1
  buffer_load_dword v174, v24, s[48:51], 0 offen offset:72 sc1
  v_mfma_f32_16x16x32_bf16 v[60:63], v[76:79], a[92:95], v[60:63]
  buffer_load_dwordx4 v[76:79], v1, s[32:35], s80 offen offset:3072 sc1
  v_mfma_f32_16x16x32_bf16 v[48:51], v[192:195], a[96:99], v[48:51]
  v_mfma_f32_16x16x32_bf16 v[52:55], v[192:195], a[100:103], v[52:55]
  v_mfma_f32_16x16x32_bf16 v[56:59], v[192:195], a[104:107], v[56:59]
  v_mfma_f32_16x16x32_bf16 v[60:63], v[192:195], a[108:111], v[60:63]
  s_add_u32 s80, s80, 4096
  buffer_load_dwordx4 v[192:195], v1, s[32:35], s80 offen offset:0 sc1
  v_mfma_f32_16x16x32_bf16 v[48:51], v[80:83], a[112:115], v[48:51]
  v_cvt_pk_bf16_f32 v152, v4, v5
  v_cvt_pk_bf16_f32 v153, v6, v7
  v_mfma_f32_16x16x32_bf16 v[52:55], v[80:83], a[116:119], v[52:55]
  v_fma_f32 v8, v36, v36, v16
  v_fma_f32 v9, v37, v37, v16
  v_fma_f32 v10, v38, v38, v16
  v_mfma_f32_16x16x32_bf16 v[56:59], v[80:83], a[120:123], v[56:59]
  v_fma_f32 v11, v39, v39, v16
  v_mul_f32 v8, v8, v36
  v_mul_f32 v9, v9, v37
  v_mul_f32 v10, v10, v38
  v_mfma_f32_16x16x32_bf16 v[60:63], v[80:83], a[124:127], v[60:63]
  buffer_load_dwordx4 v[80:83], v1, s[32:35], s80 offen offset:1024 sc1
  v_mfma_f32_16x16x32_bf16 v[48:51], v[84:87], a[128:131], v[48:51]
  v_mul_f32 v11, v11, v39
  v_exp_f32_e64 v8, -v8
  v_mfma_f32_16x16x32_bf16 v[52:55], v[84:87], a[132:135], v[52:55]
  v_exp_f32_e64 v9, -v9
  v_exp_f32_e64 v10, -v10
  v_mfma_f32_16x16x32_bf16 v[56:59], v[84:87], a[136:139], v[56:59]
  v_exp_f32_e64 v11, -v11
  v_mfma_f32_16x16x32_bf16 v[60:63], v[84:87], a[140:143], v[60:63]
  buffer_load_dwordx4 v[84:87], v1, s[32:35], s80 offen offset:2048 sc1
  v_fma_f32 v8, v8, s82, s82
  v_mfma_f32_16x16x32_bf16 v[48:51], v[88:91], a[144:147], v[48:51]
  v_fma_f32 v9, v9, s82, s82
  v_fma_f32 v10, v10, s82, s82
  v_fma_f32 v11, v11, s82, s82
  v_mfma_f32_16x16x32_bf16 v[52:55], v[88:91], a[148:151], v[52:55]
  v_rcp_f32 v8, v8
  v_rcp_f32 v9, v9
  v_mfma_f32_16x16x32_bf16 v[56:59], v[88:91], a[152:155], v[56:59]
  v_rcp_f32 v10, v10
  v_mfma_f32_16x16x32_bf16 v[60:63], v[88:91], a[156:159], v[60:63]
  buffer_load_dwordx4 v[88:91], v1, s[32:35], s80 offen offset:3072 sc1
  v_mfma_f32_16x16x32_bf16 v[48:51], v[216:219], a[160:163], v[48:51]
  v_rcp_f32 v11, v11
  v_mul_f32 v8, v8, v36
  v_mul_f32 v9, v9, v37
  v_mfma_f32_16x16x32_bf16 v[52:55], v[216:219], a[164:167], v[52:55]
  v_mul_f32 v10, v10, v38
  v_mul_f32 v11, v11, v39
  v_cvt_pk_bf16_f32 v156, v8, v9
  v_mfma_f32_16x16x32_bf16 v[56:59], v[216:219], a[168:171], v[56:59]
  v_cvt_pk_bf16_f32 v157, v10, v11
  v_fma_f32 v4, v40, v40, v16
  v_fma_f32 v5, v41, v41, v16
  v_mfma_f32_16x16x32_bf16 v[60:63], v[216:219], a[172:175], v[60:63]
  s_add_u32 s80, s80, 4096
  buffer_load_dwordx4 v[216:219], v1, s[32:35], s80 offen offset:0 sc1
  v_mfma_f32_16x16x32_bf16 v[48:51], v[92:95], a[176:179], v[48:51]
  v_fma_f32 v6, v42, v42, v16
  v_fma_f32 v7, v43, v43, v16
  v_mul_f32 v4, v4, v40
  v_mul_f32 v5, v5, v41
  v_mfma_f32_16x16x32_bf16 v[52:55], v[92:95], a[180:183], v[52:55]
  v_mul_f32 v6, v6, v42
  v_mul_f32 v7, v7, v43
  v_mfma_f32_16x16x32_bf16 v[56:59], v[92:95], a[184:187], v[56:59]
  v_exp_f32_e64 v4, -v4
  v_exp_f32_e64 v5, -v5
  v_mfma_f32_16x16x32_bf16 v[60:63], v[92:95], a[188:191], v[60:63]
  buffer_load_dwordx4 v[92:95], v1, s[32:35], s80 offen offset:1024 sc1
  v_mfma_f32_16x16x32_bf16 v[48:51], v[220:223], a[192:195], v[48:51]
  v_exp_f32_e64 v6, -v6
  v_exp_f32_e64 v7, -v7
  v_mfma_f32_16x16x32_bf16 v[52:55], v[220:223], a[196:199], v[52:55]
  v_fma_f32 v4, v4, s82, s82
  v_fma_f32 v5, v5, s82, s82
  v_fma_f32 v6, v6, s82, s82
  v_mfma_f32_16x16x32_bf16 v[56:59], v[220:223], a[200:203], v[56:59]
  v_fma_f32 v7, v7, s82, s82
  v_rcp_f32 v4, v4
  v_mfma_f32_16x16x32_bf16 v[60:63], v[220:223], a[204:207], v[60:63]
  buffer_load_dwordx4 v[220:223], v1, s[32:35], s80 offen offset:2048 sc1
  v_mfma_f32_16x16x32_bf16 v[48:51], v[96:99], a[208:211], v[48:51]
  v_rcp_f32 v5, v5
  v_rcp_f32 v6, v6
  v_mfma_f32_16x16x32_bf16 v[52:55], v[96:99], a[212:215], v[52:55]
  v_rcp_f32 v7, v7
  v_mul_f32 v4, v4, v40
  v_mfma_f32_16x16x32_bf16 v[56:59], v[96:99], a[216:219], v[56:59]
  v_mul_f32 v5, v5, v41
  v_mul_f32 v6, v6, v42
  v_mul_f32 v7, v7, v43
  v_mfma_f32_16x16x32_bf16 v[60:63], v[96:99], a[220:223], v[60:63]
  buffer_load_dwordx4 v[96:99], v1, s[32:35], s80 offen offset:3072 sc1
  v_mfma_f32_16x16x32_bf16 v[48:51], v[196:199], a[224:227], v[48:51]
  v_cvt_pk_bf16_f32 v160, v4, v5
  v_cvt_pk_bf16_f32 v161, v6, v7
  v_fma_f32 v8, v44, v44, v16
  v_mfma_f32_16x16x32_bf16 v[52:55], v[196:199], a[228:231], v[52:55]
  v_fma_f32 v9, v45, v45, v16
  v_fma_f32 v10, v46, v46, v16
  v_fma_f32 v11, v47, v47, v16
  v_mfma_f32_16x16x32_bf16 v[56:59], v[196:199], a[232:235], v[56:59]
  v_mul_f32 v8, v8, v44
  v_mul_f32 v9, v9, v45
  v_mul_f32 v10, v10, v46
  v_mul_f32 v11, v11, v47
  v_mfma_f32_16x16x32_bf16 v[60:63], v[196:199], a[236:239], v[60:63]
  s_add_u32 s80, s80, 4096
  buffer_load_dwordx4 v[196:199], v1, s[32:35], s80 offen offset:0 sc1
  v_mfma_f32_16x16x32_bf16 v[48:51], v[100:103], a[240:243], v[48:51]
  v_exp_f32_e64 v8, -v8
  v_exp_f32_e64 v9, -v9
  v_mfma_f32_16x16x32_bf16 v[52:55], v[100:103], a[244:247], v[52:55]
  v_exp_f32_e64 v10, -v10
  v_mfma_f32_16x16x32_bf16 v[56:59], v[100:103], a[248:251], v[56:59]
  v_exp_f32_e64 v11, -v11
  v_fma_f32 v8, v8, s82, s82
  v_mfma_f32_16x16x32_bf16 v[60:63], v[100:103], a[252:255], v[60:63]
  buffer_load_dwordx4 v[100:103], v1, s[32:35], s80 offen offset:1024 sc1
  v_fma_f32 v9, v9, s82, s82
  v_mfma_f32_16x16x32_bf16 v[48:51], v[200:203], v[224:227], v[48:51]
  v_fma_f32 v10, v10, s82, s82
  v_fma_f32 v11, v11, s82, s82
  v_mfma_f32_16x16x32_bf16 v[52:55], v[200:203], v[228:231], v[52:55]
  v_rcp_f32 v8, v8
  v_rcp_f32 v9, v9
  v_mfma_f32_16x16x32_bf16 v[56:59], v[200:203], v[232:235], v[56:59]
  v_rcp_f32 v10, v10
  v_rcp_f32 v11, v11
  v_mfma_f32_16x16x32_bf16 v[60:63], v[200:203], v[236:239], v[60:63]
  buffer_load_dwordx4 v[200:203], v1, s[32:35], s80 offen offset:2048 sc1
  v_mfma_f32_16x16x32_bf16 v[48:51], v[104:107], v[240:243], v[48:51]
  v_mul_f32 v8, v8, v44
  v_mul_f32 v9, v9, v45
  v_mul_f32 v10, v10, v46
  v_mfma_f32_16x16x32_bf16 v[52:55], v[104:107], v[244:247], v[52:55]
  v_mul_f32 v11, v11, v47
  v_cvt_pk_bf16_f32 v164, v8, v9
  v_cvt_pk_bf16_f32 v165, v10, v11
  v_mfma_f32_16x16x32_bf16 v[56:59], v[104:107], v[248:251], v[56:59]
  v_mfma_f32_16x16x32_bf16 v[60:63], v[104:107], v[252:255], v[60:63]
  buffer_load_dwordx4 v[104:107], v1, s[32:35], s80 offen offset:3072 sc1
  v_mfma_f32_16x16x32_bf16 v[32:35], v[204:207], a[0:3], v[144:147]
  v_mfma_f32_16x16x32_bf16 v[36:39], v[204:207], a[4:7], v[144:147]
  v_mfma_f32_16x16x32_bf16 v[40:43], v[204:207], a[8:11], v[144:147]
  v_mfma_f32_16x16x32_bf16 v[44:47], v[204:207], a[12:15], v[144:147]
  s_add_u32 s80, s80, 4096
  buffer_load_dwordx4 v[204:207], v1, s[32:35], s80 offen offset:0 sc1
  ds_read_b128 a[0:3], v1 offset:0
  ds_read_b128 a[4:7], v1 offset:1024
  ds_read_b128 a[8:11], v1 offset:2048
  ds_read_b128 a[12:15], v1 offset:3072
  v_mfma_f32_16x16x32_bf16 v[32:35], v[108:111], a[16:19], v[32:35]
  v_fma_f32 v4, v48, v48, v16
  v_fma_f32 v5, v49, v49, v16
  v_fma_f32 v6, v50, v50, v16
  v_fma_f32 v7, v51, v51, v16
  v_mfma_f32_16x16x32_bf16 v[36:39], v[108:111], a[20:23], v[36:39]
  v_mul_f32 v4, v4, v48
  v_mul_f32 v5, v5, v49
  v_mul_f32 v6, v6, v50
  v_mfma_f32_16x16x32_bf16 v[40:43], v[108:111], a[24:27], v[40:43]
  s_waitcnt vmcnt(14)
  v_cvt_pk_bf16_f32 v168, v168, v174
  ds_write_b16 v25, v168 offset:0
  ds_write_b16_d16_hi v25, v168 offset:15360
  v_mfma_f32_16x16x32_bf16 v[44:47], v[108:111], a[28:31], v[44:47]
  buffer_load_dwordx4 v[108:111], v1, s[32:35], s80 offen offset:1024 sc1
  ds_read_b128 a[16:19], v1 offset:4096
  ds_read_b128 a[20:23], v1 offset:5120
  ds_read_b128 a[24:27], v1 offset:6144
  ds_read_b128 a[28:31], v1 offset:7168
  v_mfma_f32_16x16x32_bf16 v[32:35], v[208:211], a[32:35], v[32:35]
  v_mul_f32 v7, v7, v51
  v_exp_f32_e64 v4, -v4
  v_mfma_f32_16x16x32_bf16 v[36:39], v[208:211], a[36:39], v[36:39]
  v_exp_f32_e64 v5, -v5
  v_mfma_f32_16x16x32_bf16 v[40:43], v[208:211], a[40:43], v[40:43]
  v_exp_f32_e64 v6, -v6
  v_exp_f32_e64 v7, -v7
  v_mfma_f32_16x16x32_bf16 v[44:47], v[208:211], a[44:47], v[44:47]
  buffer_load_dwordx4 v[208:211], v1, s[32:35], s80 offen offset:2048 sc1
  ds_read_b128 a[32:35], v1 offset:8192
  ds_read_b128 a[36:39], v1 offset:9216
  ds_read_b128 a[40:43], v1 offset:10240
  ds_read_b128 a[44:47], v1 offset:11264
  v_mfma_f32_16x16x32_bf16 v[32:35], v[112:115], a[48:51], v[32:35]
  v_fma_f32 v4, v4, s82, s82
  v_fma_f32 v5, v5, s82, s82
  v_fma_f32 v6, v6, s82, s82
  v_fma_f32 v7, v7, s82, s82
  v_mfma_f32_16x16x32_bf16 v[36:39], v[112:115], a[52:55], v[36:39]
  v_cvt_pk_bf16_f32 v169, v169, v174
  ds_write_b16 v25, v169 offset:192
  ds_write_b16_d16_hi v25, v169 offset:15552
  v_mfma_f32_16x16x32_bf16 v[40:43], v[112:115], a[56:59], v[40:43]
  v_rcp_f32 v4, v4
  v_mfma_f32_16x16x32_bf16 v[44:47], v[112:115], a[60:63], v[44:47]
  buffer_load_dwordx4 v[112:115], v1, s[32:35], s80 offen offset:3072 sc1
  ds_read_b128 a[48:51], v1 offset:12288
  ds_read_b128 a[52:55], v1 offset:13312
  ds_read_b128 a[56:59], v1 offset:14336
  ds_read_b128 a[60:63], v1 offset:15360
  v_mfma_f32_16x16x32_bf16 v[32:35], v[212:215], a[64:67], v[32:35]
  v_rcp_f32 v5, v5
  v_rcp_f32 v6, v6
  v_mfma_f32_16x16x32_bf16 v[36:39], v[212:215], a[68:71], v[36:39]
  v_rcp_f32 v7, v7
  v_mul_f32 v4, v4, v48
  v_mfma_f32_16x16x32_bf16 v[40:43], v[212:215], a[72:75], v[40:43]
  v_mul_f32 v5, v5, v49
  v_mul_f32 v6, v6, v50
  v_mul_f32 v7, v7, v51
  v_mfma_f32_16x16x32_bf16 v[44:47], v[212:215], a[76:79], v[44:47]
  s_add_u32 s80, s80, 4096
  buffer_load_dwordx4 v[212:215], v1, s[32:35], s80 offen offset:0 sc1
  ds_read_b128 a[64:67], v1 offset:20480
  ds_read_b128 a[68:71], v1 offset:21504
  ds_read_b128 a[72:75], v1 offset:22528
  ds_read_b128 a[76:79], v1 offset:23552
  v_cvt_pk_bf16_f32 v154, v4, v5
  v_mfma_f32_16x16x32_bf16 v[32:35], v[116:119], a[80:83], v[32:35]
  v_cvt_pk_bf16_f32 v170, v170, v174
  ds_write_b16 v25, v170 offset:384
  ds_write_b16_d16_hi v25, v170 offset:15744
  v_mfma_f32_16x16x32_bf16 v[36:39], v[116:119], a[84:87], v[36:39]
  v_cvt_pk_bf16_f32 v155, v6, v7
  ds_write_b128 v18, v[152:155] offset:49152
  v_mfma_f32_16x16x32_bf16 v[40:43], v[116:119], a[88:91], v[40:43]
  v_fma_f32 v8, v52, v52, v16
  v_fma_f32 v9, v53, v53, v16
  v_mfma_f32_16x16x32_bf16 v[44:47], v[116:119], a[92:95], v[44:47]
  buffer_load_dwordx4 v[116:119], v1, s[32:35], s80 offen offset:1024 sc1
  ds_read_b128 a[80:83], v1 offset:24576
  ds_read_b128 a[84:87], v1 offset:25600
  ds_read_b128 a[88:91], v1 offset:26624
  ds_read_b128 a[92:95], v1 offset:27648
  v_fma_f32 v10, v54, v54, v16
  v_mfma_f32_16x16x32_bf16 v[32:35], v[176:179], a[96:99], v[32:35]
  v_fma_f32 v11, v55, v55, v16
  v_mul_f32 v8, v8, v52
  v_mul_f32 v9, v9, v53
  v_mfma_f32_16x16x32_bf16 v[36:39], v[176:179], a[100:103], v[36:39]
  v_mul_f32 v10, v10, v54
  v_mul_f32 v11, v11, v55
  v_exp_f32_e64 v8, -v8
  v_mfma_f32_16x16x32_bf16 v[40:43], v[176:179], a[104:107], v[40:43]
  v_cvt_pk_bf16_f32 v171, v171, v174
  ds_write_b16 v25, v171 offset:576
  ds_write_b16_d16_hi v25, v171 offset:15936
  v_mfma_f32_16x16x32_bf16 v[44:47], v[176:179], a[108:111], v[44:47]
  buffer_load_dwordx4 v[176:179], v1, s[32:35], s80 offen offset:2048 sc1
  ds_read_b128 a[96:99], v1 offset:28672
  ds_read_b128 a[100:103], v1 offset:29696
  ds_read_b128 a[104:107], v1 offset:30720
  ds_read_b128 a[108:111], v1 offset:31744
  v_mfma_f32_16x16x32_bf16 v[32:35], v[120:123], a[112:115], v[32:35]
  v_exp_f32_e64 v9, -v9
  v_mfma_f32_16x16x32_bf16 v[36:39], v[120:123], a[116:119], v[36:39]
  v_exp_f32_e64 v10, -v10
  v_exp_f32_e64 v11, -v11
  v_mfma_f32_16x16x32_bf16 v[40:43], v[120:123], a[120:123], v[40:43]
  v_fma_f32 v8, v8, s82, s82
  v_fma_f32 v9, v9, s82, s82
  v_fma_f32 v10, v10, s82, s82
  v_mfma_f32_16x16x32_bf16 v[44:47], v[120:123], a[124:127], v[44:47]
  buffer_load_dwordx4 v[120:123], v1, s[32:35], s80 offen offset:3072 sc1
  ds_read_b128 a[112:115], v1 offset:32768
  ds_read_b128 a[116:119], v1 offset:33792
  ds_read_b128 a[120:123], v1 offset:34816
  ds_read_b128 a[124:127], v1 offset:35840
  v_mfma_f32_16x16x32_bf16 v[32:35], v[180:183], a[128:131], v[32:35]
  v_fma_f32 v11, v11, s82, s82
  v_rcp_f32 v8, v8
  v_mfma_f32_16x16x32_bf16 v[36:39], v[180:183], a[132:135], v[36:39]
  v_rcp_f32 v9, v9
  v_mfma_f32_16x16x32_bf16 v[40:43], v[180:183], a[136:139], v[40:43]
  v_cvt_pk_bf16_f32 v172, v172, v174
  ds_write_b16 v25, v172 offset:768
  ds_write_b16_d16_hi v25, v172 offset:16128
  v_mfma_f32_16x16x32_bf16 v[44:47], v[180:183], a[140:143], v[44:47]
  s_add_u32 s80, s80, 4096
  buffer_load_dwordx4 v[180:183], v1, s[32:35], s80 offen offset:0 sc1
  ds_read_b128 a[128:131], v1 offset:40960
  ds_read_b128 a[132:135], v1 offset:41984
  ds_read_b128 a[136:139], v1 offset:43008
  ds_read_b128 a[140:143], v1 offset:44032
  v_mfma_f32_16x16x32_bf16 v[32:35], v[184:187], a[144:147], v[32:35]
  v_rcp_f32 v10, v10
  v_rcp_f32 v11, v11
  v_mfma_f32_16x16x32_bf16 v[36:39], v[184:187], a[148:151], v[36:39]
  v_mul_f32 v8, v8, v52
  v_mul_f32 v9, v9, v53
  v_mul_f32 v10, v10, v54
  v_mfma_f32_16x16x32_bf16 v[40:43], v[184:187], a[152:155], v[40:43]
  v_mul_f32 v11, v11, v55
  v_cvt_pk_bf16_f32 v158, v8, v9
  v_cvt_pk_bf16_f32 v159, v10, v11
  v_mfma_f32_16x16x32_bf16 v[44:47], v[184:187], a[156:159], v[44:47]
  buffer_load_dwordx4 v[184:187], v1, s[32:35], s80 offen offset:1024 sc1
  ds_read_b128 a[144:147], v1 offset:45056
  ds_read_b128 a[148:151], v1 offset:46080
  ds_read_b128 a[152:155], v1 offset:47104
  ds_read_b128 a[156:159], v1 offset:48128
  v_mfma_f32_16x16x32_bf16 v[32:35], v[124:127], a[160:163], v[32:35]
  ds_write_b128 v18, v[156:159] offset:50176
  v_cvt_pk_bf16_f32 v173, v173, v174
  ds_write_b16 v25, v173 offset:960
  ds_write_b16_d16_hi v25, v173 offset:16320
  v_mfma_f32_16x16x32_bf16 v[36:39], v[124:127], a[164:167], v[36:39]
  v_fma_f32 v4, v56, v56, v16
  v_mfma_f32_16x16x32_bf16 v[40:43], v[124:127], a[168:171], v[40:43]
  v_fma_f32 v5, v57, v57, v16
  v_fma_f32 v6, v58, v58, v16
  v_fma_f32 v7, v59, v59, v16
  v_mul_f32 v4, v4, v56
  v_mfma_f32_16x16x32_bf16 v[44:47], v[124:127], a[172:175], v[44:47]
  buffer_load_dwordx4 v[124:127], v1, s[32:35], s80 offen offset:2048 sc1
  v_mfma_f32_16x16x32_bf16 v[32:35], v[128:131], a[176:179], v[32:35]
  v_mul_f32 v5, v5, v57
  v_mul_f32 v6, v6, v58
  v_mul_f32 v7, v7, v59
  v_mfma_f32_16x16x32_bf16 v[36:39], v[128:131], a[180:183], v[36:39]
  v_exp_f32_e64 v4, -v4
  v_exp_f32_e64 v5, -v5
  v_mfma_f32_16x16x32_bf16 v[40:43], v[128:131], a[184:187], v[40:43]
  v_exp_f32_e64 v6, -v6
  v_mfma_f32_16x16x32_bf16 v[44:47], v[128:131], a[188:191], v[44:47]
  buffer_load_dwordx4 v[128:131], v1, s[32:35], s80 offen offset:3072 sc1
  v_exp_f32_e64 v7, -v7
  v_mfma_f32_16x16x32_bf16 v[32:35], v[132:135], a[192:195], v[32:35]
  v_fma_f32 v4, v4, s82, s82
  v_fma_f32 v5, v5, s82, s82
  v_mfma_f32_16x16x32_bf16 v[36:39], v[132:135], a[196:199], v[36:39]
  v_fma_f32 v6, v6, s82, s82
  v_fma_f32 v7, v7, s82, s82
  v_rcp_f32 v4, v4
  v_mfma_f32_16x16x32_bf16 v[40:43], v[132:135], a[200:203], v[40:43]
  v_rcp_f32 v5, v5
  v_mfma_f32_16x16x32_bf16 v[44:47], v[132:135], a[204:207], v[44:47]
  s_add_u32 s80, s80, 4096
  buffer_load_dwordx4 v[132:135], v1, s[32:35], s80 offen offset:0 sc1
  v_rcp_f32 v6, v6
  v_mfma_f32_16x16x32_bf16 v[32:35], v[136:139], a[208:211], v[32:35]
  v_rcp_f32 v7, v7
  v_mfma_f32_16x16x32_bf16 v[36:39], v[136:139], a[212:215], v[36:39]
  v_mul_f32 v4, v4, v56
  v_mul_f32 v5, v5, v57
  v_mul_f32 v6, v6, v58
  v_mul_f32 v7, v7, v59
  v_mfma_f32_16x16x32_bf16 v[40:43], v[136:139], a[216:219], v[40:43]
  v_cvt_pk_bf16_f32 v162, v4, v5
  v_cvt_pk_bf16_f32 v163, v6, v7
  v_mfma_f32_16x16x32_bf16 v[44:47], v[136:139], a[220:223], v[44:47]
  buffer_load_dwordx4 v[136:139], v1, s[32:35], s80 offen offset:1024 sc1
  ds_write_b128 v18, v[160:163] offset:51200
  v_mfma_f32_16x16x32_bf16 v[32:35], v[188:191], a[224:227], v[32:35]
  v_fma_f32 v8, v60, v60, v16
  v_fma_f32 v9, v61, v61, v16
  v_fma_f32 v10, v62, v62, v16
  v_mfma_f32_16x16x32_bf16 v[36:39], v[188:191], a[228:231], v[36:39]
  v_fma_f32 v11, v63, v63, v16
  v_mul_f32 v8, v8, v60
  v_mul_f32 v9, v9, v61
  v_mfma_f32_16x16x32_bf16 v[40:43], v[188:191], a[232:235], v[40:43]
  v_mul_f32 v10, v10, v62
  v_mul_f32 v11, v11, v63
  v_exp_f32_e64 v8, -v8
  v_mfma_f32_16x16x32_bf16 v[44:47], v[188:191], a[236:239], v[44:47]
  buffer_load_dwordx4 v[188:191], v1, s[32:35], s80 offen offset:2048 sc1
  v_mfma_f32_16x16x32_bf16 v[32:35], v[140:143], a[240:243], v[32:35]
  v_exp_f32_e64 v9, -v9
  v_mfma_f32_16x16x32_bf16 v[36:39], v[140:143], a[244:247], v[36:39]
  v_exp_f32_e64 v10, -v10
  v_exp_f32_e64 v11, -v11
  v_mfma_f32_16x16x32_bf16 v[40:43], v[140:143], a[248:251], v[40:43]
  v_fma_f32 v8, v8, s82, s82
  v_fma_f32 v9, v9, s82, s82
  v_fma_f32 v10, v10, s82, s82
  v_mfma_f32_16x16x32_bf16 v[44:47], v[140:143], a[252:255], v[44:47]
  buffer_load_dwordx4 v[140:143], v1, s[32:35], s80 offen offset:3072 sc1
  v_mfma_f32_16x16x32_bf16 v[32:35], v[64:67], v[224:227], v[32:35]
  v_fma_f32 v11, v11, s82, s82
  v_rcp_f32 v8, v8
  v_mfma_f32_16x16x32_bf16 v[36:39], v[64:67], v[228:231], v[36:39]
  v_rcp_f32 v9, v9
  v_rcp_f32 v10, v10
  v_mfma_f32_16x16x32_bf16 v[40:43], v[64:67], v[232:235], v[40:43]
  v_rcp_f32 v11, v11
  v_mul_f32 v8, v8, v60
  v_mfma_f32_16x16x32_bf16 v[44:47], v[64:67], v[236:239], v[44:47]
  s_add_u32 s80, s80, 4096
  buffer_load_dwordx4 v[64:67], v1, s[32:35], s80 offen offset:0 sc1
  v_mfma_f32_16x16x32_bf16 v[32:35], v[68:71], v[240:243], v[32:35]
  v_mul_f32 v9, v9, v61
  v_mul_f32 v10, v10, v62
  v_mul_f32 v11, v11, v63
  v_cvt_pk_bf16_f32 v166, v8, v9
  v_mfma_f32_16x16x32_bf16 v[36:39], v[68:71], v[244:247], v[36:39]
  v_cvt_pk_bf16_f32 v167, v10, v11
  ds_write_b128 v18, v[164:167] offset:52224
  v_mfma_f32_16x16x32_bf16 v[40:43], v[68:71], v[248:251], v[40:43]
  v_mfma_f32_16x16x32_bf16 v[44:47], v[68:71], v[252:255], v[44:47]
  buffer_load_dwordx4 v[68:71], v1, s[32:35], s80 offen offset:1024 sc1
  v_add_u32 v26, 65536, v1
  s_waitcnt lgkmcnt(0)
  s_barrier
  ds_read_b128 v[224:227], v1 offset:16384
  ds_read_b128 v[228:231], v1 offset:17408
  ds_read_b128 v[232:235], v1 offset:18432
  ds_read_b128 v[236:239], v1 offset:19456
  s_lshl_b32 s74, s28, 19
  s_lshl_b32 s56, s26, 11
  s_add_u32 s74, s74, s56
  s_add_u32 s74, s74, 16777216
  s_lshl_b32 s56, s27, 13
  s_add_u32 s74, s74, s56
  s_lshl_b32 s75, s28, 6
  s_add_u32 s75, s75, s27
  s_lshl_b32 s75, s75, 10
  s_add_u32 s75, s75, 33554432
  s_lshl_b32 s76, s28, 5
  s_add_u32 s76, s76, s26
  s_lshl_b32 s76, s76, 3
  s_add_u32 s76, s76, s27
  s_lshl_b32 s76, s76, 7
  s_add_u32 s76, s76, 36700160
  s_waitcnt vmcnt(30)
  v_mfma_f32_16x16x32_bf16 v[48:51], v[72:75], a[0:3], 0
  v_mfma_f32_16x16x32_bf16 v[52:55], v[72:75], a[4:7], 0
  v_mfma_f32_16x16x32_bf16 v[56:59], v[72:75], a[8:11], 0
  s_mul_i32 s56, s26, 3328
  s_add_u32 s56, s56, 86016
  v_mul_u32_u24 v27, 208, v2
  v_lshl_add_u32 v27, v3, 4, v27
  v_add_u32 v27, s56, v27
  ds_read_b128 v[240:243], v27 offset:0
  ds_read_b128 v[244:247], v27 offset:64
  ds_read_b128 v[248:251], v27 offset:128
  v_mul_u32_u24 v28, 192, v2
  v_lshl_add_u32 v28, v3, 4, v28
  v_add_u32 v28, 102400, v28
  ds_read_b128 a[208:211], v28 offset:0
  ds_read_b128 a[212:215], v28 offset:15360
  ds_read_b128 a[216:219], v28 offset:3072
  ds_read_b128 a[220:223], v28 offset:18432
  ds_read_b128 a[224:227], v28 offset:3136
  ds_read_b128 a[228:231], v28 offset:18496
  ds_read_b128 a[232:235], v28 offset:6144
  ds_read_b128 a[236:239], v28 offset:21504
  ds_read_b128 a[240:243], v28 offset:6208
  ds_read_b128 a[244:247], v28 offset:21568
  s_lshl_b32 s56, s26, 10
  s_add_u32 s56, s56, 73728
  v_add_u32 v29, s56, v1
  v_mfma_f32_16x16x32_bf16 v[60:63], v[72:75], a[12:15], 0
  buffer_load_dwordx4 v[72:75], v1, s[32:35], s80 offen offset:2048 sc1
  ds_read_b128 a[160:163], v1 offset:49152
  ds_read_b128 a[164:167], v1 offset:50176
  ds_read_b128 a[168:171], v1 offset:51200
  ds_read_b128 a[172:175], v1 offset:52224
  v_mfma_f32_16x16x32_bf16 v[48:51], v[76:79], a[16:19], v[48:51]
  ds_read_b128 a[176:179], v1 offset:53248
  ds_read_b128 a[180:183], v1 offset:54272
  ds_read_b128 a[184:187], v1 offset:55296
  ds_read_b128 a[188:191], v1 offset:56320
  ds_read_b128 a[192:195], v1 offset:61440
  ds_read_b128 a[196:199], v1 offset:62464
  ds_read_b128 a[200:203], v1 offset:63488
  ds_read_b128 a[204:207], v1 offset:64512
  v_mfma_f32_16x16x32_bf16 v[52:55], v[76:79], a[20:23], v[52:55]
  s_mov_b32 s81, 0x358637bd
  v_fma_f32 v4, v32, v32, v16
  v_fma_f32 v5, v33, v33, v16
  v_fma_f32 v6, v34, v34, v16
  v_fma_f32 v7, v35, v35, v16
  v_mul_f32 v4, v4, v32
  v_mul_f32 v5, v5, v33
  v_mul_f32 v6, v6, v34
  v_mul_f32 v7, v7, v35
  v_mfma_f32_16x16x32_bf16 v[56:59], v[76:79], a[24:27], v[56:59]
  v_exp_f32_e64 v4, -v4
  v_exp_f32_e64 v5, -v5
  v_exp_f32_e64 v6, -v6
  v_exp_f32_e64 v7, -v7
  v_mfma_f32_16x16x32_bf16 v[60:63], v[76:79], a[28:31], v[60:63]
  buffer_load_dwordx4 v[76:79], v1, s[32:35], s80 offen offset:3072 sc1
  v_fma_f32 v4, v4, s82, s82
  v_fma_f32 v5, v5, s82, s82
  v_fma_f32 v6, v6, s82, s82
  v_fma_f32 v7, v7, s82, s82
  v_rcp_f32 v4, v4
  s_waitcnt vmcnt(30)
  v_mfma_f32_16x16x32_bf16 v[48:51], v[192:195], a[32:35], v[48:51]
  v_rcp_f32 v5, v5
  v_rcp_f32 v6, v6
  v_rcp_f32 v7, v7
  v_mul_f32 v4, v4, v32
  v_mfma_f32_16x16x32_bf16 v[52:55], v[192:195], a[36:39], v[52:55]
  v_mul_f32 v5, v5, v33
  v_mul_f32 v6, v6, v34
  v_mul_f32 v7, v7, v35
  v_cvt_pk_bf16_f32 v152, v4, v5
  v_cvt_pk_bf16_f32 v153, v6, v7
  ds_write_b64 v19, v[152:153] offset:0
  v_fma_f32 v8, v36, v36, v16
  v_fma_f32 v9, v37, v37, v16
  v_mfma_f32_16x16x32_bf16 v[56:59], v[192:195], a[40:43], v[56:59]
  v_fma_f32 v10, v38, v38, v16
  v_fma_f32 v11, v39, v39, v16
  v_mul_f32 v8, v8, v36
  v_mul_f32 v9, v9, v37
  v_mul_f32 v10, v10, v38
  v_mul_f32 v11, v11, v39
  v_exp_f32_e64 v8, -v8
  v_mfma_f32_16x16x32_bf16 v[60:63], v[192:195], a[44:47], v[60:63]
  s_add_u32 s80, s80, 4096
  buffer_load_dwordx4 v[192:195], v1, s[32:35], s80 offen offset:0 sc1
  v_exp_f32_e64 v9, -v9
  v_exp_f32_e64 v10, -v10
  v_exp_f32_e64 v11, -v11
  v_mfma_f32_16x16x32_bf16 v[48:51], v[80:83], a[48:51], v[48:51]
  v_fma_f32 v8, v8, s82, s82
  v_mfma_f32_16x16x32_bf16 v[52:55], v[80:83], a[52:55], v[52:55]
  v_mfma_f32_16x16x32_bf16 v[56:59], v[80:83], a[56:59], v[56:59]
  s_waitcnt lgkmcnt(13)
  v_mfma_f32_16x16x32_bf16 v[144:147], a[208:211], v[240:243], 0
  v_mfma_f32_16x16x32_bf16 v[148:151], a[212:215], v[240:243], 0
  v_mfma_f32_16x16x32_bf16 v[168:171], a[216:219], v[240:243], 0
  v_mfma_f32_16x16x32_bf16 v[252:255], a[220:223], v[240:243], 0
  v_mfma_f32_16x16x32_bf16 v[168:171], a[224:227], v[244:247], v[168:171]
  v_mfma_f32_16x16x32_bf16 v[252:255], a[228:231], v[244:247], v[252:255]
  v_mfma_f32_16x16x32_bf16 v[12:15], a[232:235], v[240:243], 0
  v_mfma_f32_16x16x32_bf16 v[20:23], a[236:239], v[240:243], 0
  v_mfma_f32_16x16x32_bf16 v[12:15], a[240:243], v[244:247], v[12:15]
  v_mfma_f32_16x16x32_bf16 v[20:23], a[244:247], v[244:247], v[20:23]
  ds_read_b128 a[208:211], v28 offset:9280
  ds_read_b128 a[212:215], v28 offset:24640
  ds_read_b128 a[216:219], v28 offset:9344
  ds_read_b128 a[220:223], v28 offset:24704
  ds_read_b128 a[224:227], v28 offset:12352
  ds_read_b128 a[228:231], v28 offset:27712
  ds_read_b128 a[232:235], v28 offset:12416
  ds_read_b128 a[236:239], v28 offset:27776
  v_mfma_f32_16x16x32_bf16 v[60:63], v[80:83], a[60:63], v[60:63]
  buffer_load_dwordx4 v[80:83], v1, s[32:35], s80 offen offset:1024 sc1
  s_waitcnt vmcnt(30)
  v_mfma_f32_16x16x32_bf16 v[48:51], v[84:87], v[224:227], v[48:51]
  v_mfma_f32_16x16x32_bf16 v[52:55], v[84:87], v[228:231], v[52:55]
  v_fma_f32 v9, v9, s82, s82
  v_fma_f32 v10, v10, s82, s82
  v_fma_f32 v11, v11, s82, s82
  v_rcp_f32 v8, v8
  v_mfma_f32_16x16x32_bf16 v[56:59], v[84:87], v[232:235], v[56:59]
  v_rcp_f32 v9, v9
  v_rcp_f32 v10, v10
  v_rcp_f32 v11, v11
  v_mul_f32 v8, v8, v36
  v_mul_f32 v9, v9, v37
  v_mfma_f32_16x16x32_bf16 v[60:63], v[84:87], v[236:239], v[60:63]
  buffer_load_dwordx4 v[84:87], v1, s[32:35], s80 offen offset:2048 sc1
  ds_read_b128 v[224:227], v1 offset:36864
  ds_read_b128 v[228:231], v1 offset:37888
  ds_read_b128 v[232:235], v1 offset:38912
  ds_read_b128 v[236:239], v1 offset:39936
  v_mul_f32 v10, v10, v38
  v_mul_f32 v11, v11, v39
  v_cvt_pk_bf16_f32 v156, v8, v9
  v_cvt_pk_bf16_f32 v157, v10, v11
  v_mfma_f32_16x16x32_bf16 v[48:51], v[88:91], a[64:67], v[48:51]
  ds_write_b64 v19, v[156:157] offset:1024
  v_fma_f32 v4, v40, v40, v16
  v_fma_f32 v5, v41, v41, v16
  v_fma_f32 v6, v42, v42, v16
  v_fma_f32 v7, v43, v43, v16
  v_mul_f32 v4, v4, v40
  v_mul_f32 v5, v5, v41
  v_mul_f32 v6, v6, v42
  v_mfma_f32_16x16x32_bf16 v[52:55], v[88:91], a[68:71], v[52:55]
  v_mul_f32 v7, v7, v43
  v_exp_f32_e64 v4, -v4
  v_exp_f32_e64 v5, -v5
  v_exp_f32_e64 v6, -v6
  v_exp_f32_e64 v7, -v7
  v_mfma_f32_16x16x32_bf16 v[56:59], v[88:91], a[72:75], v[56:59]
  v_fma_f32 v4, v4, s82, s82
  v_fma_f32 v5, v5, s82, s82
  v_fma_f32 v6, v6, s82, s82
  v_fma_f32 v7, v7, s82, s82
  v_rcp_f32 v4, v4
  v_rcp_f32 v5, v5
  v_mfma_f32_16x16x32_bf16 v[60:63], v[88:91], a[76:79], v[60:63]
  buffer_load_dwordx4 v[88:91], v1, s[32:35], s80 offen offset:3072 sc1
  v_rcp_f32 v6, v6
  v_rcp_f32 v7, v7
  v_mul_f32 v4, v4, v40
  s_waitcnt vmcnt(30)
  v_mfma_f32_16x16x32_bf16 v[48:51], v[216:219], a[80:83], v[48:51]
  v_mul_f32 v5, v5, v41
  v_mul_f32 v6, v6, v42
  v_mul_f32 v7, v7, v43
  v_cvt_pk_bf16_f32 v160, v4, v5
  v_cvt_pk_bf16_f32 v161, v6, v7
  v_add_f32 v148, s81, v148
  v_add_f32 v149, s81, v149
  v_add_f32 v150, s81, v150
  v_mfma_f32_16x16x32_bf16 v[52:55], v[216:219], a[84:87], v[52:55]
  v_add_f32 v151, s81, v151
  v_rcp_f32 v148, v148
  v_rcp_f32 v149, v149
  v_rcp_f32 v150, v150
  v_rcp_f32 v151, v151
  v_mfma_f32_16x16x32_bf16 v[56:59], v[216:219], a[88:91], v[56:59]
  v_mul_f32 v144, v144, v148
  v_mul_f32 v145, v145, v149
  v_mul_f32 v146, v146, v150
  v_mul_f32 v147, v147, v151
  v_cvt_pk_bf16_f32 v144, v144, v145
  v_cvt_pk_bf16_f32 v145, v146, v147
  ds_write_b64 v29, v[144:145] offset:0
  v_mfma_f32_16x16x32_bf16 v[60:63], v[216:219], a[92:95], v[60:63]
  s_add_u32 s80, s80, 4096
  buffer_load_dwordx4 v[216:219], v1, s[32:35], s80 offen offset:0 sc1
  v_add_f32 v252, s81, v252
  v_add_f32 v253, s81, v253
  v_add_f32 v254, s81, v254
  v_add_f32 v255, s81, v255
  v_mfma_f32_16x16x32_bf16 v[48:51], v[92:95], a[96:99], v[48:51]
  v_rcp_f32 v252, v252
  v_rcp_f32 v253, v253
  v_rcp_f32 v254, v254
  v_rcp_f32 v255, v255
  v_mul_f32 v168, v168, v252
  v_mfma_f32_16x16x32_bf16 v[52:55], v[92:95], a[100:103], v[52:55]
  v_mul_f32 v169, v169, v253
  v_mul_f32 v170, v170, v254
  v_mul_f32 v171, v171, v255
  v_cvt_pk_bf16_f32 v168, v168, v169
  v_cvt_pk_bf16_f32 v169, v170, v171
  ds_write_b64 v29, v[168:169] offset:8
  v_mfma_f32_16x16x32_bf16 v[56:59], v[92:95], a[104:107], v[56:59]
  v_mfma_f32_16x16x32_bf16 v[60:63], v[92:95], a[108:111], v[60:63]
  buffer_load_dwordx4 v[92:95], v1, s[32:35], s80 offen offset:1024 sc1
  s_waitcnt vmcnt(30)
  v_mfma_f32_16x16x32_bf16 v[48:51], v[220:223], a[112:115], v[48:51]
  s_waitcnt lgkmcnt(7)
  v_mfma_f32_16x16x32_bf16 v[144:147], a[208:211], v[244:247], 0
  v_mfma_f32_16x16x32_bf16 v[148:151], a[212:215], v[244:247], 0
  v_mfma_f32_16x16x32_bf16 v[144:147], a[216:219], v[248:251], v[144:147]
  v_mfma_f32_16x16x32_bf16 v[148:151], a[220:223], v[248:251], v[148:151]
  v_mfma_f32_16x16x32_bf16 v[168:171], a[224:227], v[244:247], 0
  v_mfma_f32_16x16x32_bf16 v[252:255], a[228:231], v[244:247], 0
  v_mfma_f32_16x16x32_bf16 v[168:171], a[232:235], v[248:251], v[168:171]
  v_mfma_f32_16x16x32_bf16 v[252:255], a[236:239], v[248:251], v[252:255]
  v_mfma_f32_16x16x32_bf16 v[52:55], v[220:223], a[116:119], v[52:55]
  v_mfma_f32_16x16x32_bf16 v[56:59], v[220:223], a[120:123], v[56:59]
  v_add_f32 v20, s81, v20
  v_add_f32 v21, s81, v21
  v_add_f32 v22, s81, v22
  v_add_f32 v23, s81, v23
  v_rcp_f32 v20, v20
  v_mfma_f32_16x16x32_bf16 v[60:63], v[220:223], a[124:127], v[60:63]
  buffer_load_dwordx4 v[220:223], v1, s[32:35], s80 offen offset:2048 sc1
  v_rcp_f32 v21, v21
  v_rcp_f32 v22, v22
  v_rcp_f32 v23, v23
  s_waitcnt lgkmcnt(3)
  v_mfma_f32_16x16x32_bf16 v[48:51], v[96:99], v[224:227], v[48:51]
  v_mul_f32 v12, v12, v20
  v_mul_f32 v13, v13, v21
  v_mul_f32 v14, v14, v22
  v_mul_f32 v15, v15, v23
  v_cvt_pk_bf16_f32 v12, v12, v13
  v_cvt_pk_bf16_f32 v13, v14, v15
  ds_write_b64 v29, v[12:13] offset:4096
  v_mfma_f32_16x16x32_bf16 v[52:55], v[96:99], v[228:231], v[52:55]
  v_mov_b32 v12, 0
  v_mov_b32 v13, 0
  ds_write_b64 v29, v[12:13] offset:8200
  ds_write_b64 v19, v[160:161] offset:2048
  v_fma_f32 v8, v44, v44, v16
  v_fma_f32 v9, v45, v45, v16
  v_fma_f32 v10, v46, v46, v16
  v_mfma_f32_16x16x32_bf16 v[56:59], v[96:99], v[232:235], v[56:59]
  v_fma_f32 v11, v47, v47, v16
  v_mul_f32 v8, v8, v44
  v_mul_f32 v9, v9, v45
  v_mul_f32 v10, v10, v46
  v_mul_f32 v11, v11, v47
  v_exp_f32_e64 v8, -v8
  v_mfma_f32_16x16x32_bf16 v[60:63], v[96:99], v[236:239], v[60:63]
  buffer_load_dwordx4 v[96:99], v1, s[32:35], s80 offen offset:3072 sc1
  ds_read_b128 v[224:227], v1 offset:57344
  ds_read_b128 v[228:231], v1 offset:58368
  ds_read_b128 v[232:235], v1 offset:59392
  ds_read_b128 v[236:239], v1 offset:60416
  v_exp_f32_e64 v9, -v9
  v_exp_f32_e64 v10, -v10
  v_exp_f32_e64 v11, -v11
  s_waitcnt vmcnt(30)
  v_mfma_f32_16x16x32_bf16 v[48:51], v[196:199], a[128:131], v[48:51]
  v_fma_f32 v8, v8, s82, s82
  v_fma_f32 v9, v9, s82, s82
  v_fma_f32 v10, v10, s82, s82
  v_fma_f32 v11, v11, s82, s82
  v_rcp_f32 v8, v8
  v_rcp_f32 v9, v9
  v_mfma_f32_16x16x32_bf16 v[52:55], v[196:199], a[132:135], v[52:55]
  v_rcp_f32 v10, v10
  v_rcp_f32 v11, v11
  v_mul_f32 v8, v8, v44
  v_mul_f32 v9, v9, v45
  v_mul_f32 v10, v10, v46
  v_mul_f32 v11, v11, v47
  v_cvt_pk_bf16_f32 v164, v8, v9
  v_mfma_f32_16x16x32_bf16 v[56:59], v[196:199], a[136:139], v[56:59]
  v_cvt_pk_bf16_f32 v165, v10, v11
  ds_write_b64 v19, v[164:165] offset:3072
  v_add_f32 v148, s81, v148
  v_add_f32 v149, s81, v149
  v_add_f32 v150, s81, v150
  v_add_f32 v151, s81, v151
  v_mfma_f32_16x16x32_bf16 v[60:63], v[196:199], a[140:143], v[60:63]
  s_add_u32 s80, s80, 4096
  buffer_load_dwordx4 v[196:199], v1, s[32:35], s80 offen offset:0 sc1
  v_rcp_f32 v148, v148
  v_rcp_f32 v149, v149
  v_rcp_f32 v150, v150
  v_mfma_f32_16x16x32_bf16 v[48:51], v[100:103], a[144:147], v[48:51]
  v_rcp_f32 v151, v151
  v_mul_f32 v144, v144, v148
  v_mul_f32 v145, v145, v149
  v_mul_f32 v146, v146, v150
  v_mul_f32 v147, v147, v151
  v_cvt_pk_bf16_f32 v144, v144, v145
  v_cvt_pk_bf16_f32 v145, v146, v147
  v_mfma_f32_16x16x32_bf16 v[52:55], v[100:103], a[148:151], v[52:55]
  ds_write_b64 v29, v[144:145] offset:4104
  v_add_f32 v252, s81, v252
  v_add_f32 v253, s81, v253
  v_add_f32 v254, s81, v254
  v_add_f32 v255, s81, v255
  v_rcp_f32 v252, v252
  v_mfma_f32_16x16x32_bf16 v[56:59], v[100:103], a[152:155], v[56:59]
  v_rcp_f32 v253, v253
  v_rcp_f32 v254, v254
  v_rcp_f32 v255, v255
  v_mul_f32 v168, v168, v252
  v_mul_f32 v169, v169, v253
  v_mul_f32 v170, v170, v254
  v_mfma_f32_16x16x32_bf16 v[60:63], v[100:103], a[156:159], v[60:63]
  buffer_load_dwordx4 v[100:103], v1, s[32:35], s80 offen offset:1024 sc1
  v_mul_f32 v171, v171, v255
  v_cvt_pk_bf16_f32 v168, v168, v169
  v_cvt_pk_bf16_f32 v169, v170, v171
  ds_write_b64 v29, v[168:169] offset:8192
  s_waitcnt lgkmcnt(0)
  s_barrier
  ds_read_b128 a[208:211], v26 offset:0
  ds_read_b128 a[212:215], v26 offset:1024
  ds_read_b128 a[216:219], v26 offset:2048
  ds_read_b128 a[220:223], v26 offset:3072
  ds_read_b128 a[224:227], v26 offset:4096
  ds_read_b128 a[228:231], v26 offset:5120
  ds_read_b128 a[232:235], v26 offset:6144
  ds_read_b128 a[236:239], v26 offset:7168
  ds_read_b128 a[240:243], v26 offset:8192
  ds_read_b128 a[244:247], v26 offset:9216
  ds_read_b128 a[248:251], v26 offset:10240
  ds_read_b128 a[252:255], v26 offset:11264
  ds_read_b128 v[240:243], v26 offset:16384
  ds_read_b128 v[244:247], v26 offset:17408
  ds_read_b128 v[248:251], v26 offset:18432
  ds_read_b128 v[252:255], v26 offset:19456
  s_waitcnt vmcnt(30)
  v_mfma_f32_16x16x32_bf16 v[48:51], v[200:203], a[160:163], v[48:51]
  v_mfma_f32_16x16x32_bf16 v[52:55], v[200:203], a[164:167], v[52:55]
  v_mfma_f32_16x16x32_bf16 v[56:59], v[200:203], a[168:171], v[56:59]
  v_mfma_f32_16x16x32_bf16 v[60:63], v[200:203], a[172:175], v[60:63]
  buffer_load_dwordx4 v[200:203], v1, s[32:35], s80 offen offset:2048 sc1
  v_mfma_f32_16x16x32_bf16 v[48:51], v[104:107], a[176:179], v[48:51]
  v_mfma_f32_16x16x32_bf16 v[52:55], v[104:107], a[180:183], v[52:55]
  v_mfma_f32_16x16x32_bf16 v[56:59], v[104:107], a[184:187], v[56:59]
  v_mfma_f32_16x16x32_bf16 v[60:63], v[104:107], a[188:191], v[60:63]
  buffer_load_dwordx4 v[104:107], v1, s[32:35], s80 offen offset:3072 sc1
  s_waitcnt vmcnt(30)
  v_mfma_f32_16x16x32_bf16 v[48:51], v[204:207], v[224:227], v[48:51]
  v_mfma_f32_16x16x32_bf16 v[52:55], v[204:207], v[228:231], v[52:55]
  v_mfma_f32_16x16x32_bf16 v[56:59], v[204:207], v[232:235], v[56:59]
  v_mfma_f32_16x16x32_bf16 v[60:63], v[204:207], v[236:239], v[60:63]
  s_add_u32 s80, s80, 4096
  buffer_load_dwordx4 v[204:207], v1, s[32:35], s80 offen offset:0 sc1
  ds_read_b128 v[224:227], v26 offset:12288
  ds_read_b128 v[228:231], v26 offset:13312
  ds_read_b128 v[232:235], v26 offset:14336
  ds_read_b128 v[236:239], v26 offset:15360
  v_mfma_f32_16x16x32_bf16 v[48:51], v[108:111], a[192:195], v[48:51]
  v_mfma_f32_16x16x32_bf16 v[52:55], v[108:111], a[196:199], v[52:55]
  v_mfma_f32_16x16x32_bf16 v[56:59], v[108:111], a[200:203], v[56:59]
  v_mfma_f32_16x16x32_bf16 v[60:63], v[108:111], a[204:207], v[60:63]
  buffer_load_dwordx4 v[108:111], v1, s[32:35], s80 offen offset:1024 sc1
  s_waitcnt lgkmcnt(15)
  s_waitcnt vmcnt(30)
  v_mfma_f32_16x16x32_bf16 v[48:51], v[208:211], a[208:211], v[48:51]
  v_mfma_f32_16x16x32_bf16 v[52:55], v[208:211], a[212:215], v[52:55]
  v_mfma_f32_16x16x32_bf16 v[56:59], v[208:211], a[216:219], v[56:59]
  v_mfma_f32_16x16x32_bf16 v[60:63], v[208:211], a[220:223], v[60:63]
  buffer_load_dwordx4 v[208:211], v1, s[32:35], s80 offen offset:2048 sc1
  s_waitcnt lgkmcnt(12)
  v_mfma_f32_16x16x32_bf16 v[48:51], v[112:115], a[224:227], v[48:51]
  v_mfma_f32_16x16x32_bf16 v[52:55], v[112:115], a[228:231], v[52:55]
  v_mfma_f32_16x16x32_bf16 v[56:59], v[112:115], a[232:235], v[56:59]
  v_mfma_f32_16x16x32_bf16 v[60:63], v[112:115], a[236:239], v[60:63]
  buffer_load_dwordx4 v[112:115], v1, s[32:35], s80 offen offset:3072 sc1
  s_waitcnt lgkmcnt(8)
  s_waitcnt vmcnt(30)
  v_mfma_f32_16x16x32_bf16 v[48:51], v[212:215], a[240:243], v[48:51]
  v_mfma_f32_16x16x32_bf16 v[52:55], v[212:215], a[244:247], v[52:55]
  v_mfma_f32_16x16x32_bf16 v[56:59], v[212:215], a[248:251], v[56:59]
  v_mfma_f32_16x16x32_bf16 v[60:63], v[212:215], a[252:255], v[60:63]
  s_add_u32 s80, s80, 4096
  buffer_load_dwordx4 v[212:215], v1, s[32:35], s80 offen offset:0 sc1
  s_waitcnt lgkmcnt(0)
  v_mfma_f32_16x16x32_bf16 v[48:51], v[116:119], v[224:227], v[48:51]
  v_mfma_f32_16x16x32_bf16 v[52:55], v[116:119], v[228:231], v[52:55]
  v_mfma_f32_16x16x32_bf16 v[56:59], v[116:119], v[232:235], v[56:59]
  v_mfma_f32_16x16x32_bf16 v[60:63], v[116:119], v[236:239], v[60:63]
  buffer_load_dwordx4 v[116:119], v1, s[32:35], s80 offen offset:1024 sc1
  ds_read_b128 v[224:227], v1 offset:16384
  ds_read_b128 v[228:231], v1 offset:17408
  ds_read_b128 v[232:235], v1 offset:18432
  ds_read_b128 v[236:239], v1 offset:19456
  s_waitcnt vmcnt(31)
  v_mfma_f32_16x16x32_bf16 v[48:51], v[176:179], v[240:243], v[48:51]
  v_mfma_f32_16x16x32_bf16 v[52:55], v[176:179], v[244:247], v[52:55]
  v_mfma_f32_16x16x32_bf16 v[56:59], v[176:179], v[248:251], v[56:59]
  v_mfma_f32_16x16x32_bf16 v[60:63], v[176:179], v[252:255], v[60:63]
  buffer_load_dwordx4 v[176:179], v1, s[32:35], s80 offen offset:2048 sc1
  s_waitcnt vmcnt(30)
  v_mfma_f32_16x16x32_bf16 v[32:35], v[120:123], a[0:3], 0
  v_mfma_f32_16x16x32_bf16 v[36:39], v[120:123], a[4:7], 0
  v_mfma_f32_16x16x32_bf16 v[40:43], v[120:123], a[8:11], 0
  v_mfma_f32_16x16x32_bf16 v[44:47], v[120:123], a[12:15], 0
  buffer_load_dwordx4 v[120:123], v1, s[32:35], s80 offen offset:3072 sc1
  v_mfma_f32_16x16x32_bf16 v[32:35], v[180:183], a[16:19], v[32:35]
  v_mfma_f32_16x16x32_bf16 v[36:39], v[180:183], a[20:23], v[36:39]
  v_mfma_f32_16x16x32_bf16 v[40:43], v[180:183], a[24:27], v[40:43]
  s_and_b32 s56, s27, 1
  s_cmp_eq_u32 s56, 0
  s_cbranch_scc0 Lk_13
  v_mov_b32 v152, v48
  v_mov_b32 v153, v49
  v_mov_b32 v154, v50
  v_mov_b32 v155, v51
  v_mov_b32 v156, v52
  v_mov_b32 v157, v53
  v_mov_b32 v158, v54
  v_mov_b32 v159, v55
  s_branch Lk_14
Lk_13:
  v_mov_b32 v152, v56
  v_mov_b32 v153, v57
  v_mov_b32 v154, v58
  v_mov_b32 v155, v59
  v_mov_b32 v156, v60
  v_mov_b32 v157, v61
  v_mov_b32 v158, v62
  v_mov_b32 v159, v63
Lk_14:
  v_mfma_f32_16x16x32_bf16 v[44:47], v[180:183], a[28:31], v[44:47]
  s_add_u32 s80, s80, 4096
  buffer_load_dwordx4 v[180:183], v1, s[32:35], s80 offen offset:0 sc1
  s_waitcnt vmcnt(30)
  v_mfma_f32_16x16x32_bf16 v[32:35], v[184:187], a[32:35], v[32:35]
  v_mfma_f32_16x16x32_bf16 v[36:39], v[184:187], a[36:39], v[36:39]
  v_mfma_f32_16x16x32_bf16 v[40:43], v[184:187], a[40:43], v[40:43]
  v_cvt_pk_bf16_f32 v144, v48, v49
  v_cvt_pk_bf16_f32 v145, v50, v51
  v_mfma_f32_16x16x32_bf16 v[44:47], v[184:187], a[44:47], v[44:47]
  buffer_load_dwordx4 v[184:187], v1, s[32:35], s80 offen offset:1024 sc1
  v_mfma_f32_16x16x32_bf16 v[32:35], v[124:127], a[48:51], v[32:35]
  v_cvt_pk_bf16_f32 v146, v52, v53
  v_cvt_pk_bf16_f32 v147, v54, v55
  v_mfma_f32_16x16x32_bf16 v[36:39], v[124:127], a[52:55], v[36:39]
  v_cvt_pk_bf16_f32 v148, v56, v57
  v_cvt_pk_bf16_f32 v149, v58, v59
  v_mfma_f32_16x16x32_bf16 v[40:43], v[124:127], a[56:59], v[40:43]
  v_cvt_pk_bf16_f32 v150, v60, v61
  v_cvt_pk_bf16_f32 v151, v62, v63
  v_mfma_f32_16x16x32_bf16 v[44:47], v[124:127], a[60:63], v[44:47]
  buffer_load_dwordx4 v[124:127], v1, s[32:35], s80 offen offset:2048 sc1
  s_waitcnt lgkmcnt(0)
  s_waitcnt vmcnt(30)
  v_mfma_f32_16x16x32_bf16 v[32:35], v[128:131], v[224:227], v[32:35]
  v_mfma_f32_16x16x32_bf16 v[36:39], v[128:131], v[228:231], v[36:39]
  v_mfma_f32_16x16x32_bf16 v[40:43], v[128:131], v[232:235], v[40:43]
  v_mfma_f32_16x16x32_bf16 v[44:47], v[128:131], v[236:239], v[44:47]
  buffer_load_dwordx4 v[128:131], v1, s[32:35], s80 offen offset:3072 sc1
  s_lshl_b32 s78, s26, 14
  s_add_u32 s78, s78, s75
  s_add_u32 s79, s78, 8192
  buffer_store_dwordx4 v[144:147], v1, s[32:35], s78 offen sc1
  buffer_store_dwordx4 v[148:151], v1, s[32:35], s79 offen sc1
  ds_read_b128 v[224:227], v1 offset:36864
  ds_read_b128 v[228:231], v1 offset:37888
  ds_read_b128 v[232:235], v1 offset:38912
  ds_read_b128 v[236:239], v1 offset:39936
  v_mfma_f32_16x16x32_bf16 v[32:35], v[132:135], a[64:67], v[32:35]
  v_mfma_f32_16x16x32_bf16 v[36:39], v[132:135], a[68:71], v[36:39]
  v_mfma_f32_16x16x32_bf16 v[40:43], v[132:135], a[72:75], v[40:43]
  v_mfma_f32_16x16x32_bf16 v[44:47], v[132:135], a[76:79], v[44:47]
  s_add_u32 s80, s80, 4096
  buffer_load_dwordx4 v[132:135], v1, s[32:35], s80 offen offset:0 sc1
  s_waitcnt vmcnt(32)
  v_mfma_f32_16x16x32_bf16 v[32:35], v[136:139], a[80:83], v[32:35]
  v_mfma_f32_16x16x32_bf16 v[36:39], v[136:139], a[84:87], v[36:39]
  v_mfma_f32_16x16x32_bf16 v[40:43], v[136:139], a[88:91], v[40:43]
  v_mfma_f32_16x16x32_bf16 v[44:47], v[136:139], a[92:95], v[44:47]
  buffer_load_dwordx4 v[136:139], v1, s[32:35], s80 offen offset:1024 sc1
  v_mfma_f32_16x16x32_bf16 v[32:35], v[188:191], a[96:99], v[32:35]
  v_mfma_f32_16x16x32_bf16 v[36:39], v[188:191], a[100:103], v[36:39]
  v_mfma_f32_16x16x32_bf16 v[40:43], v[188:191], a[104:107], v[40:43]
  v_mfma_f32_16x16x32_bf16 v[44:47], v[188:191], a[108:111], v[44:47]
  buffer_load_dwordx4 v[188:191], v1, s[32:35], s80 offen offset:2048 sc1
  s_waitcnt vmcnt(32)
  v_mfma_f32_16x16x32_bf16 v[32:35], v[140:143], a[112:115], v[32:35]
  v_mfma_f32_16x16x32_bf16 v[36:39], v[140:143], a[116:119], v[36:39]
  v_mfma_f32_16x16x32_bf16 v[40:43], v[140:143], a[120:123], v[40:43]
  v_mfma_f32_16x16x32_bf16 v[44:47], v[140:143], a[124:127], v[44:47]
  buffer_load_dwordx4 v[140:143], v1, s[32:35], s80 offen offset:3072 sc1
  s_waitcnt lgkmcnt(0)
  v_mfma_f32_16x16x32_bf16 v[32:35], v[64:67], v[224:227], v[32:35]
  v_mfma_f32_16x16x32_bf16 v[36:39], v[64:67], v[228:231], v[36:39]
  v_mfma_f32_16x16x32_bf16 v[40:43], v[64:67], v[232:235], v[40:43]
  v_mfma_f32_16x16x32_bf16 v[44:47], v[64:67], v[236:239], v[44:47]
  s_add_u32 s80, s80, 4096
  buffer_load_dwordx4 v[64:67], v1, s[32:35], s80 offen offset:0 sc1
  ds_read_b128 v[224:227], v1 offset:57344
  ds_read_b128 v[228:231], v1 offset:58368
  ds_read_b128 v[232:235], v1 offset:59392
  ds_read_b128 v[236:239], v1 offset:60416
  s_waitcnt vmcnt(32)
  v_mfma_f32_16x16x32_bf16 v[32:35], v[68:71], a[128:131], v[32:35]
  v_mfma_f32_16x16x32_bf16 v[36:39], v[68:71], a[132:135], v[36:39]
  v_mfma_f32_16x16x32_bf16 v[40:43], v[68:71], a[136:139], v[40:43]
  v_mfma_f32_16x16x32_bf16 v[44:47], v[68:71], a[140:143], v[44:47]
  buffer_load_dwordx4 v[68:71], v1, s[32:35], s80 offen offset:1024 sc1
  v_mfma_f32_16x16x32_bf16 v[32:35], v[72:75], a[144:147], v[32:35]
  v_mfma_f32_16x16x32_bf16 v[36:39], v[72:75], a[148:151], v[36:39]
  v_mfma_f32_16x16x32_bf16 v[40:43], v[72:75], a[152:155], v[40:43]
  v_mfma_f32_16x16x32_bf16 v[44:47], v[72:75], a[156:159], v[44:47]
  buffer_load_dwordx4 v[72:75], v1, s[32:35], s80 offen offset:2048 sc1
  s_waitcnt vmcnt(32)
  v_mfma_f32_16x16x32_bf16 v[32:35], v[76:79], a[160:163], v[32:35]
  v_mfma_f32_16x16x32_bf16 v[36:39], v[76:79], a[164:167], v[36:39]
  v_mfma_f32_16x16x32_bf16 v[40:43], v[76:79], a[168:171], v[40:43]
  v_mfma_f32_16x16x32_bf16 v[44:47], v[76:79], a[172:175], v[44:47]
  buffer_load_dwordx4 v[76:79], v1, s[32:35], s80 offen offset:3072 sc1
  v_mfma_f32_16x16x32_bf16 v[32:35], v[192:195], a[176:179], v[32:35]
  v_mfma_f32_16x16x32_bf16 v[36:39], v[192:195], a[180:183], v[36:39]
  v_mfma_f32_16x16x32_bf16 v[40:43], v[192:195], a[184:187], v[40:43]
  v_mfma_f32_16x16x32_bf16 v[44:47], v[192:195], a[188:191], v[44:47]
  s_add_u32 s80, s80, 4096
  buffer_load_dwordx4 v[192:195], v1, s[32:35], s80 offen offset:0 sc1
  s_waitcnt lgkmcnt(0)
  s_waitcnt vmcnt(32)
  v_mfma_f32_16x16x32_bf16 v[32:35], v[80:83], v[224:227], v[32:35]
  v_mfma_f32_16x16x32_bf16 v[36:39], v[80:83], v[228:231], v[36:39]
  v_mfma_f32_16x16x32_bf16 v[40:43], v[80:83], v[232:235], v[40:43]
  v_mfma_f32_16x16x32_bf16 v[44:47], v[80:83], v[236:239], v[44:47]
  buffer_load_dwordx4 v[80:83], v1, s[32:35], s80 offen offset:1024 sc1
  ds_read_b128 v[224:227], v26 offset:12288
  ds_read_b128 v[228:231], v26 offset:13312
  ds_read_b128 v[232:235], v26 offset:14336
  ds_read_b128 v[236:239], v26 offset:15360
  v_mfma_f32_16x16x32_bf16 v[32:35], v[84:87], a[192:195], v[32:35]
  v_mfma_f32_16x16x32_bf16 v[36:39], v[84:87], a[196:199], v[36:39]
  v_mfma_f32_16x16x32_bf16 v[40:43], v[84:87], a[200:203], v[40:43]
  v_mfma_f32_16x16x32_bf16 v[44:47], v[84:87], a[204:207], v[44:47]
  buffer_load_dwordx4 v[84:87], v1, s[32:35], s80 offen offset:2048 sc1
  s_waitcnt vmcnt(32)
  v_mfma_f32_16x16x32_bf16 v[32:35], v[88:91], a[208:211], v[32:35]
  v_mfma_f32_16x16x32_bf16 v[36:39], v[88:91], a[212:215], v[36:39]
  v_mfma_f32_16x16x32_bf16 v[40:43], v[88:91], a[216:219], v[40:43]
  v_mfma_f32_16x16x32_bf16 v[44:47], v[88:91], a[220:223], v[44:47]
  buffer_load_dwordx4 v[88:91], v1, s[32:35], s80 offen offset:3072 sc1
  v_mfma_f32_16x16x32_bf16 v[32:35], v[216:219], a[224:227], v[32:35]
  v_mfma_f32_16x16x32_bf16 v[36:39], v[216:219], a[228:231], v[36:39]
  v_mfma_f32_16x16x32_bf16 v[40:43], v[216:219], a[232:235], v[40:43]
  v_mfma_f32_16x16x32_bf16 v[44:47], v[216:219], a[236:239], v[44:47]
  s_add_u32 s80, s80, 4096
  buffer_load_dwordx4 v[216:219], v1, s[32:35], s80 offen offset:0 sc1
  s_waitcnt vmcnt(32)
  v_mfma_f32_16x16x32_bf16 v[32:35], v[92:95], a[240:243], v[32:35]
  v_mfma_f32_16x16x32_bf16 v[36:39], v[92:95], a[244:247], v[36:39]
  v_mfma_f32_16x16x32_bf16 v[40:43], v[92:95], a[248:251], v[40:43]
  v_mfma_f32_16x16x32_bf16 v[44:47], v[92:95], a[252:255], v[44:47]
  buffer_load_dwordx4 v[92:95], v1, s[32:35], s80 offen offset:1024 sc1
  s_waitcnt lgkmcnt(0)
  v_mfma_f32_16x16x32_bf16 v[32:35], v[220:223], v[224:227], v[32:35]
  v_mfma_f32_16x16x32_bf16 v[36:39], v[220:223], v[228:231], v[36:39]
  v_mfma_f32_16x16x32_bf16 v[40:43], v[220:223], v[232:235], v[40:43]
  v_mfma_f32_16x16x32_bf16 v[44:47], v[220:223], v[236:239], v[44:47]
  buffer_load_dwordx4 v[220:223], v1, s[32:35], s80 offen offset:2048 sc1
  ds_read_b128 v[224:227], v1 offset:16384
  ds_read_b128 v[228:231], v1 offset:17408
  ds_read_b128 v[232:235], v1 offset:18432
  ds_read_b128 v[236:239], v1 offset:19456
  s_waitcnt vmcnt(33)
  v_mfma_f32_16x16x32_bf16 v[32:35], v[96:99], v[240:243], v[32:35]
  v_mfma_f32_16x16x32_bf16 v[36:39], v[96:99], v[244:247], v[36:39]
  v_mfma_f32_16x16x32_bf16 v[40:43], v[96:99], v[248:251], v[40:43]
  v_mfma_f32_16x16x32_bf16 v[44:47], v[96:99], v[252:255], v[44:47]
  buffer_load_dwordx4 v[96:99], v1, s[32:35], s80 offen offset:3072 sc1
  s_waitcnt vmcnt(32)
  v_mfma_f32_16x16x32_bf16 v[48:51], v[196:199], a[0:3], 0
  v_mfma_f32_16x16x32_bf16 v[52:55], v[196:199], a[4:7], 0
  v_mfma_f32_16x16x32_bf16 v[56:59], v[196:199], a[8:11], 0
  v_mfma_f32_16x16x32_bf16 v[60:63], v[196:199], a[12:15], 0
  s_add_u32 s80, s80, 4096
  buffer_load_dwordx4 v[196:199], v1, s[32:35], s80 offen offset:0 sc1
  v_mfma_f32_16x16x32_bf16 v[48:51], v[100:103], a[16:19], v[48:51]
  v_cvt_pk_bf16_f32 v160, v32, v33
  v_mfma_f32_16x16x32_bf16 v[52:55], v[100:103], a[20:23], v[52:55]
  v_cvt_pk_bf16_f32 v161, v34, v35
  v_mfma_f32_16x16x32_bf16 v[56:59], v[100:103], a[24:27], v[56:59]
  v_cvt_pk_bf16_f32 v162, v36, v37
  v_mfma_f32_16x16x32_bf16 v[60:63], v[100:103], a[28:31], v[60:63]
  buffer_load_dwordx4 v[100:103], v1, s[32:35], s80 offen offset:1024 sc1
  s_waitcnt vmcnt(32)
  v_mfma_f32_16x16x32_bf16 v[48:51], v[200:203], a[32:35], v[48:51]
  v_cvt_pk_bf16_f32 v163, v38, v39
  v_mfma_f32_16x16x32_bf16 v[52:55], v[200:203], a[36:39], v[52:55]
  v_mfma_f32_16x16x32_bf16 v[56:59], v[200:203], a[40:43], v[56:59]
  v_cvt_pk_bf16_f32 v164, v40, v41
  v_mfma_f32_16x16x32_bf16 v[60:63], v[200:203], a[44:47], v[60:63]
  buffer_load_dwordx4 v[200:203], v1, s[32:35], s80 offen offset:2048 sc1
  v_mfma_f32_16x16x32_bf16 v[48:51], v[104:107], a[48:51], v[48:51]
  v_cvt_pk_bf16_f32 v165, v42, v43
  v_mfma_f32_16x16x32_bf16 v[52:55], v[104:107], a[52:55], v[52:55]
  v_cvt_pk_bf16_f32 v166, v44, v45
  v_mfma_f32_16x16x32_bf16 v[56:59], v[104:107], a[56:59], v[56:59]
  v_cvt_pk_bf16_f32 v167, v46, v47
  v_mfma_f32_16x16x32_bf16 v[60:63], v[104:107], a[60:63], v[60:63]
  buffer_load_dwordx4 v[104:107], v1, s[32:35], s80 offen offset:3072 sc1
  s_waitcnt lgkmcnt(0)
  s_waitcnt vmcnt(32)
  v_mfma_f32_16x16x32_bf16 v[48:51], v[204:207], v[224:227], v[48:51]
  v_mfma_f32_16x16x32_bf16 v[52:55], v[204:207], v[228:231], v[52:55]
  v_mfma_f32_16x16x32_bf16 v[56:59], v[204:207], v[232:235], v[56:59]
  v_mfma_f32_16x16x32_bf16 v[60:63], v[204:207], v[236:239], v[60:63]
  s_add_u32 s80, s80, 4096
  buffer_load_dwordx4 v[204:207], v1, s[32:35], s80 offen offset:0 sc1
  s_add_u32 s78, s27, 1
  s_and_b32 s78, s78, 7
  s_lshl_b32 s78, s78, 16
  s_add_u32 s78, s78, s74
  s_add_u32 s79, s78, 1024
  buffer_store_dwordx4 v[160:163], v1, s[32:35], s78 offen sc1
  buffer_store_dwordx4 v[164:167], v1, s[32:35], s79 offen sc1
  ds_read_b128 v[224:227], v1 offset:36864
  ds_read_b128 v[228:231], v1 offset:37888
  ds_read_b128 v[232:235], v1 offset:38912
  ds_read_b128 v[236:239], v1 offset:39936
  v_mfma_f32_16x16x32_bf16 v[48:51], v[108:111], a[64:67], v[48:51]
  v_mfma_f32_16x16x32_bf16 v[52:55], v[108:111], a[68:71], v[52:55]
  v_mfma_f32_16x16x32_bf16 v[56:59], v[108:111], a[72:75], v[56:59]
  v_mfma_f32_16x16x32_bf16 v[60:63], v[108:111], a[76:79], v[60:63]
  buffer_load_dwordx4 v[108:111], v1, s[32:35], s80 offen offset:1024 sc1
  s_waitcnt vmcnt(34)
  v_mfma_f32_16x16x32_bf16 v[48:51], v[208:211], a[80:83], v[48:51]
  v_mfma_f32_16x16x32_bf16 v[52:55], v[208:211], a[84:87], v[52:55]
  v_mfma_f32_16x16x32_bf16 v[56:59], v[208:211], a[88:91], v[56:59]
  v_mfma_f32_16x16x32_bf16 v[60:63], v[208:211], a[92:95], v[60:63]
  buffer_load_dwordx4 v[208:211], v1, s[32:35], s80 offen offset:2048 sc1
  v_mfma_f32_16x16x32_bf16 v[48:51], v[112:115], a[96:99], v[48:51]
  v_mfma_f32_16x16x32_bf16 v[52:55], v[112:115], a[100:103], v[52:55]
  v_mfma_f32_16x16x32_bf16 v[56:59], v[112:115], a[104:107], v[56:59]
  v_mfma_f32_16x16x32_bf16 v[60:63], v[112:115], a[108:111], v[60:63]
  buffer_load_dwordx4 v[112:115], v1, s[32:35], s80 offen offset:3072 sc1
  s_waitcnt vmcnt(34)
  v_mfma_f32_16x16x32_bf16 v[48:51], v[212:215], a[112:115], v[48:51]
  v_mfma_f32_16x16x32_bf16 v[52:55], v[212:215], a[116:119], v[52:55]
  v_mfma_f32_16x16x32_bf16 v[56:59], v[212:215], a[120:123], v[56:59]
  v_mfma_f32_16x16x32_bf16 v[60:63], v[212:215], a[124:127], v[60:63]
  s_add_u32 s80, s80, 4096
  buffer_load_dwordx4 v[212:215], v1, s[32:35], s80 offen offset:0 sc1
  s_waitcnt lgkmcnt(0)
  v_mfma_f32_16x16x32_bf16 v[48:51], v[116:119], v[224:227], v[48:51]
  v_mfma_f32_16x16x32_bf16 v[52:55], v[116:119], v[228:231], v[52:55]
  v_mfma_f32_16x16x32_bf16 v[56:59], v[116:119], v[232:235], v[56:59]
  v_mfma_f32_16x16x32_bf16 v[60:63], v[116:119], v[236:239], v[60:63]
  buffer_load_dwordx4 v[116:119], v1, s[32:35], s80 offen offset:1024 sc1
  ds_read_b128 v[224:227], v1 offset:57344
  ds_read_b128 v[228:231], v1 offset:58368
  ds_read_b128 v[232:235], v1 offset:59392
  ds_read_b128 v[236:239], v1 offset:60416
  s_waitcnt vmcnt(34)
  v_mfma_f32_16x16x32_bf16 v[48:51], v[176:179], a[128:131], v[48:51]
  v_mfma_f32_16x16x32_bf16 v[52:55], v[176:179], a[132:135], v[52:55]
  v_mfma_f32_16x16x32_bf16 v[56:59], v[176:179], a[136:139], v[56:59]
  v_mfma_f32_16x16x32_bf16 v[60:63], v[176:179], a[140:143], v[60:63]
  buffer_load_dwordx4 v[176:179], v1, s[32:35], s80 offen offset:2048 sc1
  v_mfma_f32_16x16x32_bf16 v[48:51], v[120:123], a[144:147], v[48:51]
  v_mfma_f32_16x16x32_bf16 v[52:55], v[120:123], a[148:151], v[52:55]
  v_mfma_f32_16x16x32_bf16 v[56:59], v[120:123], a[152:155], v[56:59]
  v_mfma_f32_16x16x32_bf16 v[60:63], v[120:123], a[156:159], v[60:63]
  buffer_load_dwordx4 v[120:123], v1, s[32:35], s80 offen offset:3072 sc1
  s_waitcnt vmcnt(34)
  v_mfma_f32_16x16x32_bf16 v[48:51], v[180:183], a[160:163], v[48:51]
  v_mfma_f32_16x16x32_bf16 v[52:55], v[180:183], a[164:167], v[52:55]
  v_mfma_f32_16x16x32_bf16 v[56:59], v[180:183], a[168:171], v[56:59]
  v_mfma_f32_16x16x32_bf16 v[60:63], v[180:183], a[172:175], v[60:63]
  s_add_u32 s80, s80, 4096
  buffer_load_dwordx4 v[180:183], v1, s[32:35], s80 offen offset:0 sc1
  v_mfma_f32_16x16x32_bf16 v[48:51], v[184:187], a[176:179], v[48:51]
  v_mfma_f32_16x16x32_bf16 v[52:55], v[184:187], a[180:183], v[52:55]
  v_mfma_f32_16x16x32_bf16 v[56:59], v[184:187], a[184:187], v[56:59]
  v_mfma_f32_16x16x32_bf16 v[60:63], v[184:187], a[188:191], v[60:63]
  buffer_load_dwordx4 v[184:187], v1, s[32:35], s80 offen offset:1024 sc1
  s_waitcnt lgkmcnt(0)
  s_waitcnt vmcnt(34)
  v_mfma_f32_16x16x32_bf16 v[48:51], v[124:127], v[224:227], v[48:51]
  v_mfma_f32_16x16x32_bf16 v[52:55], v[124:127], v[228:231], v[52:55]
  v_mfma_f32_16x16x32_bf16 v[56:59], v[124:127], v[232:235], v[56:59]
  v_mfma_f32_16x16x32_bf16 v[60:63], v[124:127], v[236:239], v[60:63]
  buffer_load_dwordx4 v[124:127], v1, s[32:35], s80 offen offset:2048 sc1
  ds_read_b128 v[224:227], v26 offset:12288
  ds_read_b128 v[228:231], v26 offset:13312
  ds_read_b128 v[232:235], v26 offset:14336
  ds_read_b128 v[236:239], v26 offset:15360
  v_mfma_f32_16x16x32_bf16 v[48:51], v[128:131], a[192:195], v[48:51]
  v_mfma_f32_16x16x32_bf16 v[52:55], v[128:131], a[196:199], v[52:55]
  v_mfma_f32_16x16x32_bf16 v[56:59], v[128:131], a[200:203], v[56:59]
  v_mfma_f32_16x16x32_bf16 v[60:63], v[128:131], a[204:207], v[60:63]
  buffer_load_dwordx4 v[128:131], v1, s[32:35], s80 offen offset:3072 sc1
  s_waitcnt vmcnt(32)
  v_mfma_f32_16x16x32_bf16 v[48:51], v[132:135], a[208:211], v[48:51]
  v_mfma_f32_16x16x32_bf16 v[52:55], v[132:135], a[212:215], v[52:55]
  v_mfma_f32_16x16x32_bf16 v[56:59], v[132:135], a[216:219], v[56:59]
  v_mfma_f32_16x16x32_bf16 v[60:63], v[132:135], a[220:223], v[60:63]
  s_add_u32 s80, s80, 4096
  buffer_load_dwordx4 v[132:135], v1, s[32:35], s80 offen offset:0 sc1
  v_mfma_f32_16x16x32_bf16 v[48:51], v[136:139], a[224:227], v[48:51]
  v_mfma_f32_16x16x32_bf16 v[52:55], v[136:139], a[228:231], v[52:55]
  v_mfma_f32_16x16x32_bf16 v[56:59], v[136:139], a[232:235], v[56:59]
  v_mfma_f32_16x16x32_bf16 v[60:63], v[136:139], a[236:239], v[60:63]
  buffer_load_dwordx4 v[136:139], v1, s[32:35], s80 offen offset:1024 sc1
  s_waitcnt vmcnt(32)
  v_mfma_f32_16x16x32_bf16 v[48:51], v[188:191], a[240:243], v[48:51]
  v_mfma_f32_16x16x32_bf16 v[52:55], v[188:191], a[244:247], v[52:55]
  v_mfma_f32_16x16x32_bf16 v[56:59], v[188:191], a[248:251], v[56:59]
  v_mfma_f32_16x16x32_bf16 v[60:63], v[188:191], a[252:255], v[60:63]
  buffer_load_dwordx4 v[188:191], v1, s[32:35], s80 offen offset:2048 sc1
  s_waitcnt lgkmcnt(0)
  v_mfma_f32_16x16x32_bf16 v[48:51], v[140:143], v[224:227], v[48:51]
  v_mfma_f32_16x16x32_bf16 v[52:55], v[140:143], v[228:231], v[52:55]
  v_mfma_f32_16x16x32_bf16 v[56:59], v[140:143], v[232:235], v[56:59]
  v_mfma_f32_16x16x32_bf16 v[60:63], v[140:143], v[236:239], v[60:63]
  buffer_load_dwordx4 v[140:143], v1, s[32:35], s80 offen offset:3072 sc1
  ds_read_b128 v[224:227], v1 offset:16384
  ds_read_b128 v[228:231], v1 offset:17408
  ds_read_b128 v[232:235], v1 offset:18432
  ds_read_b128 v[236:239], v1 offset:19456
  s_waitcnt vmcnt(33)
  v_mfma_f32_16x16x32_bf16 v[48:51], v[64:67], v[240:243], v[48:51]
  v_mfma_f32_16x16x32_bf16 v[52:55], v[64:67], v[244:247], v[52:55]
  v_mfma_f32_16x16x32_bf16 v[56:59], v[64:67], v[248:251], v[56:59]
  v_mfma_f32_16x16x32_bf16 v[60:63], v[64:67], v[252:255], v[60:63]
  s_add_u32 s80, s80, 4096
  buffer_load_dwordx4 v[64:67], v1, s[32:35], s80 offen offset:0 sc1
  s_waitcnt vmcnt(32)
  v_mfma_f32_16x16x32_bf16 v[32:35], v[68:71], a[0:3], 0
  v_mfma_f32_16x16x32_bf16 v[36:39], v[68:71], a[4:7], 0
  v_mfma_f32_16x16x32_bf16 v[40:43], v[68:71], a[8:11], 0
  v_mfma_f32_16x16x32_bf16 v[44:47], v[68:71], a[12:15], 0
  buffer_load_dwordx4 v[68:71], v1, s[32:35], s80 offen offset:1024 sc1
  v_mfma_f32_16x16x32_bf16 v[32:35], v[72:75], a[16:19], v[32:35]
  v_cvt_pk_bf16_f32 v144, v48, v49
  v_mfma_f32_16x16x32_bf16 v[36:39], v[72:75], a[20:23], v[36:39]
  v_cvt_pk_bf16_f32 v145, v50, v51
  v_mfma_f32_16x16x32_bf16 v[40:43], v[72:75], a[24:27], v[40:43]
  v_cvt_pk_bf16_f32 v146, v52, v53
  v_mfma_f32_16x16x32_bf16 v[44:47], v[72:75], a[28:31], v[44:47]
  buffer_load_dwordx4 v[72:75], v1, s[32:35], s80 offen offset:2048 sc1
  s_waitcnt vmcnt(32)
  v_mfma_f32_16x16x32_bf16 v[32:35], v[76:79], a[32:35], v[32:35]
  v_cvt_pk_bf16_f32 v147, v54, v55
  v_mfma_f32_16x16x32_bf16 v[36:39], v[76:79], a[36:39], v[36:39]
  v_mfma_f32_16x16x32_bf16 v[40:43], v[76:79], a[40:43], v[40:43]
  v_cvt_pk_bf16_f32 v148, v56, v57
  v_mfma_f32_16x16x32_bf16 v[44:47], v[76:79], a[44:47], v[44:47]
  buffer_load_dwordx4 v[76:79], v1, s[32:35], s80 offen offset:3072 sc1
  v_mfma_f32_16x16x32_bf16 v[32:35], v[192:195], a[48:51], v[32:35]
  v_cvt_pk_bf16_f32 v149, v58, v59
  v_mfma_f32_16x16x32_bf16 v[36:39], v[192:195], a[52:55], v[36:39]
  v_cvt_pk_bf16_f32 v150, v60, v61
  v_mfma_f32_16x16x32_bf16 v[40:43], v[192:195], a[56:59], v[40:43]
  v_cvt_pk_bf16_f32 v151, v62, v63
  v_mfma_f32_16x16x32_bf16 v[44:47], v[192:195], a[60:63], v[44:47]
  s_add_u32 s80, s80, 4096
  buffer_load_dwordx4 v[192:195], v1, s[32:35], s80 offen offset:0 sc1
  s_waitcnt lgkmcnt(0)
  s_waitcnt vmcnt(32)
  v_mfma_f32_16x16x32_bf16 v[32:35], v[80:83], v[224:227], v[32:35]
  v_mfma_f32_16x16x32_bf16 v[36:39], v[80:83], v[228:231], v[36:39]
  v_mfma_f32_16x16x32_bf16 v[40:43], v[80:83], v[232:235], v[40:43]
  v_mfma_f32_16x16x32_bf16 v[44:47], v[80:83], v[236:239], v[44:47]
  buffer_load_dwordx4 v[80:83], v1, s[32:35], s80 offen offset:1024 sc1
  s_add_u32 s78, s27, 2
  s_and_b32 s78, s78, 7
  s_lshl_b32 s78, s78, 16
  s_add_u32 s78, s78, s74
  s_add_u32 s79, s78, 1024
  buffer_store_dwordx4 v[144:147], v1, s[32:35], s78 offen sc1
  buffer_store_dwordx4 v[148:151], v1, s[32:35], s79 offen sc1
  ds_read_b128 v[224:227], v1 offset:36864
  ds_read_b128 v[228:231], v1 offset:37888
  ds_read_b128 v[232:235], v1 offset:38912
  ds_read_b128 v[236:239], v1 offset:39936
  v_mfma_f32_16x16x32_bf16 v[32:35], v[84:87], a[64:67], v[32:35]
  v_mfma_f32_16x16x32_bf16 v[36:39], v[84:87], a[68:71], v[36:39]
  v_mfma_f32_16x16x32_bf16 v[40:43], v[84:87], a[72:75], v[40:43]
  v_mfma_f32_16x16x32_bf16 v[44:47], v[84:87], a[76:79], v[44:47]
  buffer_load_dwordx4 v[84:87], v1, s[32:35], s80 offen offset:2048 sc1
  s_waitcnt vmcnt(34)
  v_mfma_f32_16x16x32_bf16 v[32:35], v[88:91], a[80:83], v[32:35]
  v_mfma_f32_16x16x32_bf16 v[36:39], v[88:91], a[84:87], v[36:39]
  v_mfma_f32_16x16x32_bf16 v[40:43], v[88:91], a[88:91], v[40:43]
  v_mfma_f32_16x16x32_bf16 v[44:47], v[88:91], a[92:95], v[44:47]
  buffer_load_dwordx4 v[88:91], v1, s[32:35], s80 offen offset:3072 sc1
  v_mfma_f32_16x16x32_bf16 v[32:35], v[216:219], a[96:99], v[32:35]
  v_mfma_f32_16x16x32_bf16 v[36:39], v[216:219], a[100:103], v[36:39]
  v_mfma_f32_16x16x32_bf16 v[40:43], v[216:219], a[104:107], v[40:43]
  v_mfma_f32_16x16x32_bf16 v[44:47], v[216:219], a[108:111], v[44:47]
  s_add_u32 s80, s80, 4096
  buffer_load_dwordx4 v[216:219], v1, s[32:35], s80 offen offset:0 sc1
  s_waitcnt vmcnt(34)
  v_mfma_f32_16x16x32_bf16 v[32:35], v[92:95], a[112:115], v[32:35]
  v_mfma_f32_16x16x32_bf16 v[36:39], v[92:95], a[116:119], v[36:39]
  v_mfma_f32_16x16x32_bf16 v[40:43], v[92:95], a[120:123], v[40:43]
  v_mfma_f32_16x16x32_bf16 v[44:47], v[92:95], a[124:127], v[44:47]
  buffer_load_dwordx4 v[92:95], v1, s[32:35], s80 offen offset:1024 sc1
  s_waitcnt lgkmcnt(0)
  v_mfma_f32_16x16x32_bf16 v[32:35], v[220:223], v[224:227], v[32:35]
  v_mfma_f32_16x16x32_bf16 v[36:39], v[220:223], v[228:231], v[36:39]
  v_mfma_f32_16x16x32_bf16 v[40:43], v[220:223], v[232:235], v[40:43]
  v_mfma_f32_16x16x32_bf16 v[44:47], v[220:223], v[236:239], v[44:47]
  buffer_load_dwordx4 v[220:223], v1, s[32:35], s80 offen offset:2048 sc1
  ds_read_b128 v[224:227], v1 offset:57344
  ds_read_b128 v[228:231], v1 offset:58368
  ds_read_b128 v[232:235], v1 offset:59392
  ds_read_b128 v[236:239], v1 offset:60416
  s_waitcnt vmcnt(34)
  v_mfma_f32_16x16x32_bf16 v[32:35], v[96:99], a[128:131], v[32:35]
  v_mfma_f32_16x16x32_bf16 v[36:39], v[96:99], a[132:135], v[36:39]
  v_mfma_f32_16x16x32_bf16 v[40:43], v[96:99], a[136:139], v[40:43]
  v_mfma_f32_16x16x32_bf16 v[44:47], v[96:99], a[140:143], v[44:47]
  buffer_load_dwordx4 v[96:99], v1, s[32:35], s80 offen offset:3072 sc1
  v_mfma_f32_16x16x32_bf16 v[32:35], v[196:199], a[144:147], v[32:35]
  v_mfma_f32_16x16x32_bf16 v[36:39], v[196:199], a[148:151], v[36:39]
  v_mfma_f32_16x16x32_bf16 v[40:43], v[196:199], a[152:155], v[40:43]
  v_mfma_f32_16x16x32_bf16 v[44:47], v[196:199], a[156:159], v[44:47]
  s_add_u32 s80, s80, 4096
  buffer_load_dwordx4 v[196:199], v1, s[32:35], s80 offen offset:0 sc1
  s_waitcnt vmcnt(34)
  v_mfma_f32_16x16x32_bf16 v[32:35], v[100:103], a[160:163], v[32:35]
  v_mfma_f32_16x16x32_bf16 v[36:39], v[100:103], a[164:167], v[36:39]
  v_mfma_f32_16x16x32_bf16 v[40:43], v[100:103], a[168:171], v[40:43]
  v_mfma_f32_16x16x32_bf16 v[44:47], v[100:103], a[172:175], v[44:47]
  buffer_load_dwordx4 v[100:103], v1, s[32:35], s80 offen offset:1024 sc1
  v_mfma_f32_16x16x32_bf16 v[32:35], v[200:203], a[176:179], v[32:35]
  v_mfma_f32_16x16x32_bf16 v[36:39], v[200:203], a[180:183], v[36:39]
  v_mfma_f32_16x16x32_bf16 v[40:43], v[200:203], a[184:187], v[40:43]
  v_mfma_f32_16x16x32_bf16 v[44:47], v[200:203], a[188:191], v[44:47]
  buffer_load_dwordx4 v[200:203], v1, s[32:35], s80 offen offset:2048 sc1
  s_waitcnt lgkmcnt(0)
  s_waitcnt vmcnt(34)
  v_mfma_f32_16x16x32_bf16 v[32:35], v[104:107], v[224:227], v[32:35]
  v_mfma_f32_16x16x32_bf16 v[36:39], v[104:107], v[228:231], v[36:39]
  v_mfma_f32_16x16x32_bf16 v[40:43], v[104:107], v[232:235], v[40:43]
  v_mfma_f32_16x16x32_bf16 v[44:47], v[104:107], v[236:239], v[44:47]
  buffer_load_dwordx4 v[104:107], v1, s[32:35], s80 offen offset:3072 sc1
  ds_read_b128 v[224:227], v26 offset:12288
  ds_read_b128 v[228:231], v26 offset:13312
  ds_read_b128 v[232:235], v26 offset:14336
  ds_read_b128 v[236:239], v26 offset:15360
  v_mfma_f32_16x16x32_bf16 v[32:35], v[204:207], a[192:195], v[32:35]
  v_mfma_f32_16x16x32_bf16 v[36:39], v[204:207], a[196:199], v[36:39]
  v_mfma_f32_16x16x32_bf16 v[40:43], v[204:207], a[200:203], v[40:43]
  v_mfma_f32_16x16x32_bf16 v[44:47], v[204:207], a[204:207], v[44:47]
  s_add_u32 s80, s80, 4096
  buffer_load_dwordx4 v[204:207], v1, s[32:35], s80 offen offset:0 sc1
  s_waitcnt vmcnt(32)
  v_mfma_f32_16x16x32_bf16 v[32:35], v[108:111], a[208:211], v[32:35]
  v_mfma_f32_16x16x32_bf16 v[36:39], v[108:111], a[212:215], v[36:39]
  v_mfma_f32_16x16x32_bf16 v[40:43], v[108:111], a[216:219], v[40:43]
  v_mfma_f32_16x16x32_bf16 v[44:47], v[108:111], a[220:223], v[44:47]
  buffer_load_dwordx4 v[108:111], v1, s[32:35], s80 offen offset:1024 sc1
  v_mfma_f32_16x16x32_bf16 v[32:35], v[208:211], a[224:227], v[32:35]
  v_mfma_f32_16x16x32_bf16 v[36:39], v[208:211], a[228:231], v[36:39]
  v_mfma_f32_16x16x32_bf16 v[40:43], v[208:211], a[232:235], v[40:43]
  v_mfma_f32_16x16x32_bf16 v[44:47], v[208:211], a[236:239], v[44:47]
  buffer_load_dwordx4 v[208:211], v1, s[32:35], s80 offen offset:2048 sc1
  s_waitcnt vmcnt(32)
  v_mfma_f32_16x16x32_bf16 v[32:35], v[112:115], a[240:243], v[32:35]
  v_mfma_f32_16x16x32_bf16 v[36:39], v[112:115], a[244:247], v[36:39]
  v_mfma_f32_16x16x32_bf16 v[40:43], v[112:115], a[248:251], v[40:43]
  v_mfma_f32_16x16x32_bf16 v[44:47], v[112:115], a[252:255], v[44:47]
  buffer_load_dwordx4 v[112:115], v1, s[32:35], s80 offen offset:3072 sc1
  s_waitcnt lgkmcnt(0)
  v_mfma_f32_16x16x32_bf16 v[32:35], v[212:215], v[224:227], v[32:35]
  v_mfma_f32_16x16x32_bf16 v[36:39], v[212:215], v[228:231], v[36:39]
  v_mfma_f32_16x16x32_bf16 v[40:43], v[212:215], v[232:235], v[40:43]
  v_mfma_f32_16x16x32_bf16 v[44:47], v[212:215], v[236:239], v[44:47]
  s_add_u32 s80, s80, 4096
  buffer_load_dwordx4 v[212:215], v1, s[32:35], s80 offen offset:0 sc1
  ds_read_b128 v[224:227], v1 offset:16384
  ds_read_b128 v[228:231], v1 offset:17408
  ds_read_b128 v[232:235], v1 offset:18432
  ds_read_b128 v[236:239], v1 offset:19456
  s_waitcnt vmcnt(33)
  v_mfma_f32_16x16x32_bf16 v[32:35], v[116:119], v[240:243], v[32:35]
  v_mfma_f32_16x16x32_bf16 v[36:39], v[116:119], v[244:247], v[36:39]
  v_mfma_f32_16x16x32_bf16 v[40:43], v[116:119], v[248:251], v[40:43]
  v_mfma_f32_16x16x32_bf16 v[44:47], v[116:119], v[252:255], v[44:47]
  buffer_load_dwordx4 v[116:119], v1, s[32:35], s80 offen offset:1024 sc1
  s_waitcnt vmcnt(32)
  v_mfma_f32_16x16x32_bf16 v[48:51], v[176:179], a[0:3], 0
  v_mfma_f32_16x16x32_bf16 v[52:55], v[176:179], a[4:7], 0
  v_mfma_f32_16x16x32_bf16 v[56:59], v[176:179], a[8:11], 0
  v_mfma_f32_16x16x32_bf16 v[60:63], v[176:179], a[12:15], 0
  buffer_load_dwordx4 v[176:179], v1, s[32:35], s80 offen offset:2048 sc1
  v_mfma_f32_16x16x32_bf16 v[48:51], v[120:123], a[16:19], v[48:51]
  v_cvt_pk_bf16_f32 v160, v32, v33
  v_mfma_f32_16x16x32_bf16 v[52:55], v[120:123], a[20:23], v[52:55]
  v_cvt_pk_bf16_f32 v161, v34, v35
  v_mfma_f32_16x16x32_bf16 v[56:59], v[120:123], a[24:27], v[56:59]
  v_cvt_pk_bf16_f32 v162, v36, v37
  v_mfma_f32_16x16x32_bf16 v[60:63], v[120:123], a[28:31], v[60:63]
  buffer_load_dwordx4 v[120:123], v1, s[32:35], s80 offen offset:3072 sc1
  s_waitcnt vmcnt(32)
  v_mfma_f32_16x16x32_bf16 v[48:51], v[180:183], a[32:35], v[48:51]
  v_cvt_pk_bf16_f32 v163, v38, v39
  v_mfma_f32_16x16x32_bf16 v[52:55], v[180:183], a[36:39], v[52:55]
  v_mfma_f32_16x16x32_bf16 v[56:59], v[180:183], a[40:43], v[56:59]
  v_cvt_pk_bf16_f32 v164, v40, v41
  v_mfma_f32_16x16x32_bf16 v[60:63], v[180:183], a[44:47], v[60:63]
  s_add_u32 s80, s80, 4096
  buffer_load_dwordx4 v[180:183], v1, s[32:35], s80 offen offset:0 sc1
  v_mfma_f32_16x16x32_bf16 v[48:51], v[184:187], a[48:51], v[48:51]
  v_cvt_pk_bf16_f32 v165, v42, v43
  v_mfma_f32_16x16x32_bf16 v[52:55], v[184:187], a[52:55], v[52:55]
  v_cvt_pk_bf16_f32 v166, v44, v45
  v_mfma_f32_16x16x32_bf16 v[56:59], v[184:187], a[56:59], v[56:59]
  v_cvt_pk_bf16_f32 v167, v46, v47
  v_mfma_f32_16x16x32_bf16 v[60:63], v[184:187], a[60:63], v[60:63]
  buffer_load_dwordx4 v[184:187], v1, s[32:35], s80 offen offset:1024 sc1
  s_waitcnt lgkmcnt(0)
  s_waitcnt vmcnt(32)
  v_mfma_f32_16x16x32_bf16 v[48:51], v[124:127], v[224:227], v[48:51]
  v_mfma_f32_16x16x32_bf16 v[52:55], v[124:127], v[228:231], v[52:55]
  v_mfma_f32_16x16x32_bf16 v[56:59], v[124:127], v[232:235], v[56:59]
  v_mfma_f32_16x16x32_bf16 v[60:63], v[124:127], v[236:239], v[60:63]
  buffer_load_dwordx4 v[124:127], v1, s[32:35], s80 offen offset:2048 sc1
  s_add_u32 s78, s27, 3
  s_and_b32 s78, s78, 7
  s_lshl_b32 s78, s78, 16
  s_add_u32 s78, s78, s74
  s_add_u32 s79, s78, 1024
  buffer_store_dwordx4 v[160:163], v1, s[32:35], s78 offen sc1
  buffer_store_dwordx4 v[164:167], v1, s[32:35], s79 offen sc1
  ds_read_b128 v[224:227], v1 offset:36864
  ds_read_b128 v[228:231], v1 offset:37888
  ds_read_b128 v[232:235], v1 offset:38912
  ds_read_b128 v[236:239], v1 offset:39936
  v_mfma_f32_16x16x32_bf16 v[48:51], v[128:131], a[64:67], v[48:51]
  v_mfma_f32_16x16x32_bf16 v[52:55], v[128:131], a[68:71], v[52:55]
  v_mfma_f32_16x16x32_bf16 v[56:59], v[128:131], a[72:75], v[56:59]
  v_mfma_f32_16x16x32_bf16 v[60:63], v[128:131], a[76:79], v[60:63]
  buffer_load_dwordx4 v[128:131], v1, s[32:35], s80 offen offset:3072 sc1
  s_waitcnt vmcnt(34)
  v_mfma_f32_16x16x32_bf16 v[48:51], v[132:135], a[80:83], v[48:51]
  v_mfma_f32_16x16x32_bf16 v[52:55], v[132:135], a[84:87], v[52:55]
  v_mfma_f32_16x16x32_bf16 v[56:59], v[132:135], a[88:91], v[56:59]
  v_mfma_f32_16x16x32_bf16 v[60:63], v[132:135], a[92:95], v[60:63]
  s_add_u32 s80, s80, 4096
  buffer_load_dwordx4 v[132:135], v1, s[32:35], s80 offen offset:0 sc1
  v_mfma_f32_16x16x32_bf16 v[48:51], v[136:139], a[96:99], v[48:51]
  v_mfma_f32_16x16x32_bf16 v[52:55], v[136:139], a[100:103], v[52:55]
  v_mfma_f32_16x16x32_bf16 v[56:59], v[136:139], a[104:107], v[56:59]
  v_mfma_f32_16x16x32_bf16 v[60:63], v[136:139], a[108:111], v[60:63]
  buffer_load_dwordx4 v[136:139], v1, s[32:35], s80 offen offset:1024 sc1
  s_waitcnt vmcnt(34)
  v_mfma_f32_16x16x32_bf16 v[48:51], v[188:191], a[112:115], v[48:51]
  v_mfma_f32_16x16x32_bf16 v[52:55], v[188:191], a[116:119], v[52:55]
  v_mfma_f32_16x16x32_bf16 v[56:59], v[188:191], a[120:123], v[56:59]
  v_mfma_f32_16x16x32_bf16 v[60:63], v[188:191], a[124:127], v[60:63]
  buffer_load_dwordx4 v[188:191], v1, s[32:35], s80 offen offset:2048 sc1
  s_waitcnt lgkmcnt(0)
  v_mfma_f32_16x16x32_bf16 v[48:51], v[140:143], v[224:227], v[48:51]
  v_mfma_f32_16x16x32_bf16 v[52:55], v[140:143], v[228:231], v[52:55]
  v_mfma_f32_16x16x32_bf16 v[56:59], v[140:143], v[232:235], v[56:59]
  v_mfma_f32_16x16x32_bf16 v[60:63], v[140:143], v[236:239], v[60:63]
  buffer_load_dwordx4 v[140:143], v1, s[32:35], s80 offen offset:3072 sc1
  ds_read_b128 v[224:227], v1 offset:57344
  ds_read_b128 v[228:231], v1 offset:58368
  ds_read_b128 v[232:235], v1 offset:59392
  ds_read_b128 v[236:239], v1 offset:60416
  s_waitcnt vmcnt(34)
  v_mfma_f32_16x16x32_bf16 v[48:51], v[64:67], a[128:131], v[48:51]
  v_mfma_f32_16x16x32_bf16 v[52:55], v[64:67], a[132:135], v[52:55]
  v_mfma_f32_16x16x32_bf16 v[56:59], v[64:67], a[136:139], v[56:59]
  v_mfma_f32_16x16x32_bf16 v[60:63], v[64:67], a[140:143], v[60:63]
  s_add_u32 s80, s80, 4096
  buffer_load_dwordx4 v[64:67], v1, s[32:35], s80 offen offset:0 sc1
  v_mfma_f32_16x16x32_bf16 v[48:51], v[68:71], a[144:147], v[48:51]
  v_mfma_f32_16x16x32_bf16 v[52:55], v[68:71], a[148:151], v[52:55]
  v_mfma_f32_16x16x32_bf16 v[56:59], v[68:71], a[152:155], v[56:59]
  v_mfma_f32_16x16x32_bf16 v[60:63], v[68:71], a[156:159], v[60:63]
  buffer_load_dwordx4 v[68:71], v1, s[32:35], s80 offen offset:1024 sc1
  s_waitcnt vmcnt(34)
  v_mfma_f32_16x16x32_bf16 v[48:51], v[72:75], a[160:163], v[48:51]
  v_mfma_f32_16x16x32_bf16 v[52:55], v[72:75], a[164:167], v[52:55]
  v_mfma_f32_16x16x32_bf16 v[56:59], v[72:75], a[168:171], v[56:59]
  v_mfma_f32_16x16x32_bf16 v[60:63], v[72:75], a[172:175], v[60:63]
  buffer_load_dwordx4 v[72:75], v1, s[32:35], s80 offen offset:2048 sc1
  v_mfma_f32_16x16x32_bf16 v[48:51], v[76:79], a[176:179], v[48:51]
  v_mfma_f32_16x16x32_bf16 v[52:55], v[76:79], a[180:183], v[52:55]
  v_mfma_f32_16x16x32_bf16 v[56:59], v[76:79], a[184:187], v[56:59]
  v_mfma_f32_16x16x32_bf16 v[60:63], v[76:79], a[188:191], v[60:63]
  buffer_load_dwordx4 v[76:79], v1, s[32:35], s80 offen offset:3072 sc1
  s_waitcnt lgkmcnt(0)
  s_waitcnt vmcnt(34)
  v_mfma_f32_16x16x32_bf16 v[48:51], v[192:195], v[224:227], v[48:51]
  v_mfma_f32_16x16x32_bf16 v[52:55], v[192:195], v[228:231], v[52:55]
  v_mfma_f32_16x16x32_bf16 v[56:59], v[192:195], v[232:235], v[56:59]
  v_mfma_f32_16x16x32_bf16 v[60:63], v[192:195], v[236:239], v[60:63]
  s_add_u32 s80, s80, 4096
  buffer_load_dwordx4 v[192:195], v1, s[32:35], s80 offen offset:0 sc1
  ds_read_b128 v[224:227], v26 offset:12288
  ds_read_b128 v[228:231], v26 offset:13312
  ds_read_b128 v[232:235], v26 offset:14336
  ds_read_b128 v[236:239], v26 offset:15360
  v_mfma_f32_16x16x32_bf16 v[48:51], v[80:83], a[192:195], v[48:51]
  v_mfma_f32_16x16x32_bf16 v[52:55], v[80:83], a[196:199], v[52:55]
  v_mfma_f32_16x16x32_bf16 v[56:59], v[80:83], a[200:203], v[56:59]
  v_mfma_f32_16x16x32_bf16 v[60:63], v[80:83], a[204:207], v[60:63]
  buffer_load_dwordx4 v[80:83], v1, s[32:35], s80 offen offset:1024 sc1
  s_waitcnt vmcnt(32)
  v_mfma_f32_16x16x32_bf16 v[48:51], v[84:87], a[208:211], v[48:51]
  v_mfma_f32_16x16x32_bf16 v[52:55], v[84:87], a[212:215], v[52:55]
  v_mfma_f32_16x16x32_bf16 v[56:59], v[84:87], a[216:219], v[56:59]
  v_mfma_f32_16x16x32_bf16 v[60:63], v[84:87], a[220:223], v[60:63]
  buffer_load_dwordx4 v[84:87], v1, s[32:35], s80 offen offset:2048 sc1
  v_mfma_f32_16x16x32_bf16 v[48:51], v[88:91], a[224:227], v[48:51]
  v_mfma_f32_16x16x32_bf16 v[52:55], v[88:91], a[228:231], v[52:55]
  v_mfma_f32_16x16x32_bf16 v[56:59], v[88:91], a[232:235], v[56:59]
  v_mfma_f32_16x16x32_bf16 v[60:63], v[88:91], a[236:239], v[60:63]
  buffer_load_dwordx4 v[88:91], v1, s[32:35], s80 offen offset:3072 sc1
  s_waitcnt vmcnt(32)
  v_mfma_f32_16x16x32_bf16 v[48:51], v[216:219], a[240:243], v[48:51]
  v_mfma_f32_16x16x32_bf16 v[52:55], v[216:219], a[244:247], v[52:55]
  v_mfma_f32_16x16x32_bf16 v[56:59], v[216:219], a[248:251], v[56:59]
  v_mfma_f32_16x16x32_bf16 v[60:63], v[216:219], a[252:255], v[60:63]
  s_add_u32 s80, s80, 4096
  buffer_load_dwordx4 v[216:219], v1, s[32:35], s80 offen offset:0 sc1
  s_waitcnt lgkmcnt(0)
  v_mfma_f32_16x16x32_bf16 v[48:51], v[92:95], v[224:227], v[48:51]
  v_mfma_f32_16x16x32_bf16 v[52:55], v[92:95], v[228:231], v[52:55]
  v_mfma_f32_16x16x32_bf16 v[56:59], v[92:95], v[232:235], v[56:59]
  v_mfma_f32_16x16x32_bf16 v[60:63], v[92:95], v[236:239], v[60:63]
  buffer_load_dwordx4 v[92:95], v1, s[32:35], s80 offen offset:1024 sc1
  s_add_u32 s56, s27, 1
  v_lshrrev_b32 v173, 4, v1
  v_add_u32 v173, s56, v173
  v_and_b32 v173, 7, v173
  v_lshlrev_b32 v173, 12, v173
  v_mov_b32 v172, s29
  s_mov_b64 exec, 1
  buffer_store_dword v172, v173, s[32:35], s76 offen sc1
  s_mov_b64 exec, -1
  ds_read_b128 v[224:227], v1 offset:16384
  ds_read_b128 v[228:231], v1 offset:17408
  ds_read_b128 v[232:235], v1 offset:18432
  ds_read_b128 v[236:239], v1 offset:19456
  s_waitcnt vmcnt(34)
  v_mfma_f32_16x16x32_bf16 v[48:51], v[220:223], v[240:243], v[48:51]
  v_mfma_f32_16x16x32_bf16 v[52:55], v[220:223], v[244:247], v[52:55]
  v_mfma_f32_16x16x32_bf16 v[56:59], v[220:223], v[248:251], v[56:59]
  v_mfma_f32_16x16x32_bf16 v[60:63], v[220:223], v[252:255], v[60:63]
  buffer_load_dwordx4 v[220:223], v1, s[32:35], s80 offen offset:2048 sc1
  s_waitcnt vmcnt(33)
  v_mfma_f32_16x16x32_bf16 v[32:35], v[96:99], a[0:3], 0
  v_mfma_f32_16x16x32_bf16 v[36:39], v[96:99], a[4:7], 0
  v_mfma_f32_16x16x32_bf16 v[40:43], v[96:99], a[8:11], 0
  v_mfma_f32_16x16x32_bf16 v[44:47], v[96:99], a[12:15], 0
  buffer_load_dwordx4 v[96:99], v1, s[32:35], s80 offen offset:3072 sc1
  v_mfma_f32_16x16x32_bf16 v[32:35], v[196:199], a[16:19], v[32:35]
  v_cvt_pk_bf16_f32 v4, v48, v49
  v_mfma_f32_16x16x32_bf16 v[36:39], v[196:199], a[20:23], v[36:39]
  v_cvt_pk_bf16_f32 v5, v50, v51
  v_mfma_f32_16x16x32_bf16 v[40:43], v[196:199], a[24:27], v[40:43]
  v_cvt_pk_bf16_f32 v6, v52, v53
  v_mfma_f32_16x16x32_bf16 v[44:47], v[196:199], a[28:31], v[44:47]
  s_add_u32 s80, s80, 4096
  buffer_load_dwordx4 v[196:199], v1, s[32:35], s80 offen offset:0 sc1
  s_waitcnt vmcnt(33)
  v_mfma_f32_16x16x32_bf16 v[32:35], v[100:103], a[32:35], v[32:35]
  v_cvt_pk_bf16_f32 v7, v54, v55
  v_mfma_f32_16x16x32_bf16 v[36:39], v[100:103], a[36:39], v[36:39]
  v_mfma_f32_16x16x32_bf16 v[40:43], v[100:103], a[40:43], v[40:43]
  v_cvt_pk_bf16_f32 v8, v56, v57
  v_mfma_f32_16x16x32_bf16 v[44:47], v[100:103], a[44:47], v[44:47]
  buffer_load_dwordx4 v[100:103], v1, s[32:35], s80 offen offset:1024 sc1
  v_mfma_f32_16x16x32_bf16 v[32:35], v[200:203], a[48:51], v[32:35]
  v_cvt_pk_bf16_f32 v9, v58, v59
  v_mfma_f32_16x16x32_bf16 v[36:39], v[200:203], a[52:55], v[36:39]
  v_cvt_pk_bf16_f32 v10, v60, v61
  v_mfma_f32_16x16x32_bf16 v[40:43], v[200:203], a[56:59], v[40:43]
  v_cvt_pk_bf16_f32 v11, v62, v63
  v_mfma_f32_16x16x32_bf16 v[44:47], v[200:203], a[60:63], v[44:47]
  buffer_load_dwordx4 v[200:203], v1, s[32:35], s80 offen offset:2048 sc1
  s_waitcnt lgkmcnt(0)
  s_waitcnt vmcnt(33)
  v_mfma_f32_16x16x32_bf16 v[32:35], v[104:107], v[224:227], v[32:35]
  v_mfma_f32_16x16x32_bf16 v[36:39], v[104:107], v[228:231], v[36:39]
  v_mfma_f32_16x16x32_bf16 v[40:43], v[104:107], v[232:235], v[40:43]
  v_mfma_f32_16x16x32_bf16 v[44:47], v[104:107], v[236:239], v[44:47]
  buffer_load_dwordx4 v[104:107], v1, s[32:35], s80 offen offset:3072 sc1
  ds_read_b128 v[224:227], v1 offset:36864
  ds_read_b128 v[228:231], v1 offset:37888
  ds_read_b128 v[232:235], v1 offset:38912
  ds_read_b128 v[236:239], v1 offset:39936
  v_mfma_f32_16x16x32_bf16 v[32:35], v[204:207], a[64:67], v[32:35]
  v_mfma_f32_16x16x32_bf16 v[36:39], v[204:207], a[68:71], v[36:39]
  v_mfma_f32_16x16x32_bf16 v[40:43], v[204:207], a[72:75], v[40:43]
  v_mfma_f32_16x16x32_bf16 v[44:47], v[204:207], a[76:79], v[44:47]
  s_add_u32 s80, s80, 4096
  buffer_load_dwordx4 v[204:207], v1, s[32:35], s80 offen offset:0 sc1
  s_waitcnt vmcnt(33)
  v_mfma_f32_16x16x32_bf16 v[32:35], v[108:111], a[80:83], v[32:35]
  v_mfma_f32_16x16x32_bf16 v[36:39], v[108:111], a[84:87], v[36:39]
  v_mfma_f32_16x16x32_bf16 v[40:43], v[108:111], a[88:91], v[40:43]
  v_mfma_f32_16x16x32_bf16 v[44:47], v[108:111], a[92:95], v[44:47]
  buffer_load_dwordx4 v[108:111], v1, s[32:35], s80 offen offset:1024 sc1
  v_mfma_f32_16x16x32_bf16 v[32:35], v[208:211], a[96:99], v[32:35]
  v_mfma_f32_16x16x32_bf16 v[36:39], v[208:211], a[100:103], v[36:39]
  v_mfma_f32_16x16x32_bf16 v[40:43], v[208:211], a[104:107], v[40:43]
  v_mfma_f32_16x16x32_bf16 v[44:47], v[208:211], a[108:111], v[44:47]
  buffer_load_dwordx4 v[208:211], v1, s[32:35], s80 offen offset:2048 sc1
  s_waitcnt vmcnt(33)
  v_mfma_f32_16x16x32_bf16 v[32:35], v[112:115], a[112:115], v[32:35]
  v_mfma_f32_16x16x32_bf16 v[36:39], v[112:115], a[116:119], v[36:39]
  v_mfma_f32_16x16x32_bf16 v[40:43], v[112:115], a[120:123], v[40:43]
  v_mfma_f32_16x16x32_bf16 v[44:47], v[112:115], a[124:127], v[44:47]
  buffer_load_dwordx4 v[112:115], v1, s[32:35], s80 offen offset:3072 sc1
  s_waitcnt lgkmcnt(0)
  v_mfma_f32_16x16x32_bf16 v[32:35], v[212:215], v[224:227], v[32:35]
  v_mfma_f32_16x16x32_bf16 v[36:39], v[212:215], v[228:231], v[36:39]
  v_mfma_f32_16x16x32_bf16 v[40:43], v[212:215], v[232:235], v[40:43]
  v_mfma_f32_16x16x32_bf16 v[44:47], v[212:215], v[236:239], v[44:47]
  s_add_u32 s80, s80, 4096
  buffer_load_dwordx4 v[212:215], v1, s[32:35], s80 offen offset:0 sc1
  ds_read_b128 v[224:227], v1 offset:57344
  ds_read_b128 v[228:231], v1 offset:58368
  ds_read_b128 v[232:235], v1 offset:59392
  ds_read_b128 v[236:239], v1 offset:60416
  s_waitcnt vmcnt(33)
  v_mfma_f32_16x16x32_bf16 v[32:35], v[116:119], a[128:131], v[32:35]
  v_mfma_f32_16x16x32_bf16 v[36:39], v[116:119], a[132:135], v[36:39]
  v_mfma_f32_16x16x32_bf16 v[40:43], v[116:119], a[136:139], v[40:43]
  v_mfma_f32_16x16x32_bf16 v[44:47], v[116:119], a[140:143], v[44:47]
  buffer_load_dwordx4 v[116:119], v1, s[32:35], s80 offen offset:1024 sc1
  v_mfma_f32_16x16x32_bf16 v[32:35], v[176:179], a[144:147], v[32:35]
  v_mfma_f32_16x16x32_bf16 v[36:39], v[176:179], a[148:151], v[36:39]
  v_mfma_f32_16x16x32_bf16 v[40:43], v[176:179], a[152:155], v[40:43]
  v_mfma_f32_16x16x32_bf16 v[44:47], v[176:179], a[156:159], v[44:47]
  buffer_load_dwordx4 v[176:179], v1, s[32:35], s80 offen offset:2048 sc1
  s_waitcnt vmcnt(33)
  v_mfma_f32_16x16x32_bf16 v[32:35], v[120:123], a[160:163], v[32:35]
  v_mfma_f32_16x16x32_bf16 v[36:39], v[120:123], a[164:167], v[36:39]
  v_mfma_f32_16x16x32_bf16 v[40:43], v[120:123], a[168:171], v[40:43]
  v_mfma_f32_16x16x32_bf16 v[44:47], v[120:123], a[172:175], v[44:47]
  buffer_load_dwordx4 v[120:123], v1, s[32:35], s80 offen offset:3072 sc1
  v_mfma_f32_16x16x32_bf16 v[32:35], v[180:183], a[176:179], v[32:35]
  v_mfma_f32_16x16x32_bf16 v[36:39], v[180:183], a[180:183], v[36:39]
  v_mfma_f32_16x16x32_bf16 v[40:43], v[180:183], a[184:187], v[40:43]
  v_mfma_f32_16x16x32_bf16 v[44:47], v[180:183], a[188:191], v[44:47]
  s_add_u32 s80, s80, 4096
  buffer_load_dwordx4 v[180:183], v1, s[32:35], s80 offen offset:0 sc1
  s_waitcnt lgkmcnt(0)
  s_waitcnt vmcnt(33)
  v_mfma_f32_16x16x32_bf16 v[32:35], v[184:187], v[224:227], v[32:35]
  v_mfma_f32_16x16x32_bf16 v[36:39], v[184:187], v[228:231], v[36:39]
  v_mfma_f32_16x16x32_bf16 v[40:43], v[184:187], v[232:235], v[40:43]
  v_mfma_f32_16x16x32_bf16 v[44:47], v[184:187], v[236:239], v[44:47]
  buffer_load_dwordx4 v[184:187], v1, s[32:35], s80 offen offset:1024 sc1
  ds_read_b128 v[224:227], v26 offset:12288
  ds_read_b128 v[228:231], v26 offset:13312
  ds_read_b128 v[232:235], v26 offset:14336
  ds_read_b128 v[236:239], v26 offset:15360
  v_mfma_f32_16x16x32_bf16 v[32:35], v[124:127], a[192:195], v[32:35]
  v_mfma_f32_16x16x32_bf16 v[36:39], v[124:127], a[196:199], v[36:39]
  v_mfma_f32_16x16x32_bf16 v[40:43], v[124:127], a[200:203], v[40:43]
  v_mfma_f32_16x16x32_bf16 v[44:47], v[124:127], a[204:207], v[44:47]
  buffer_load_dwordx4 v[124:127], v1, s[32:35], s80 offen offset:2048 sc1
  s_waitcnt vmcnt(31)
  v_mfma_f32_16x16x32_bf16 v[32:35], v[128:131], a[208:211], v[32:35]
  v_mfma_f32_16x16x32_bf16 v[36:39], v[128:131], a[212:215], v[36:39]
  v_mfma_f32_16x16x32_bf16 v[40:43], v[128:131], a[216:219], v[40:43]
  v_mfma_f32_16x16x32_bf16 v[44:47], v[128:131], a[220:223], v[44:47]
  buffer_load_dwordx4 v[128:131], v1, s[32:35], s80 offen offset:3072 sc1
  v_mfma_f32_16x16x32_bf16 v[32:35], v[132:135], a[224:227], v[32:35]
  v_mfma_f32_16x16x32_bf16 v[36:39], v[132:135], a[228:231], v[36:39]
  v_mfma_f32_16x16x32_bf16 v[40:43], v[132:135], a[232:235], v[40:43]
  v_mfma_f32_16x16x32_bf16 v[44:47], v[132:135], a[236:239], v[44:47]
  s_add_u32 s80, s80, 4096
  buffer_load_dwordx4 v[132:135], v1, s[32:35], s80 offen offset:0 sc1
  s_waitcnt vmcnt(31)
  v_mfma_f32_16x16x32_bf16 v[32:35], v[136:139], a[240:243], v[32:35]
  v_mfma_f32_16x16x32_bf16 v[36:39], v[136:139], a[244:247], v[36:39]
  v_mfma_f32_16x16x32_bf16 v[40:43], v[136:139], a[248:251], v[40:43]
  v_mfma_f32_16x16x32_bf16 v[44:47], v[136:139], a[252:255], v[44:47]
  buffer_load_dwordx4 v[136:139], v1, s[32:35], s80 offen offset:1024 sc1
  s_waitcnt lgkmcnt(0)
  v_mfma_f32_16x16x32_bf16 v[32:35], v[188:191], v[224:227], v[32:35]
  v_mfma_f32_16x16x32_bf16 v[36:39], v[188:191], v[228:231], v[36:39]
  v_mfma_f32_16x16x32_bf16 v[40:43], v[188:191], v[232:235], v[40:43]
  v_mfma_f32_16x16x32_bf16 v[44:47], v[188:191], v[236:239], v[44:47]
  buffer_load_dwordx4 v[188:191], v1, s[32:35], s80 offen offset:2048 sc1
  s_add_u32 s56, s27, 2
  v_lshrrev_b32 v173, 4, v1
  v_add_u32 v173, s56, v173
  v_and_b32 v173, 7, v173
  v_lshlrev_b32 v173, 12, v173
  v_mov_b32 v172, s29
  s_mov_b64 exec, 1
  buffer_store_dword v172, v173, s[32:35], s76 offen sc1
  s_mov_b64 exec, -1
  ds_read_b128 v[224:227], v1 offset:16384
  ds_read_b128 v[228:231], v1 offset:17408
  ds_read_b128 v[232:235], v1 offset:18432
  ds_read_b128 v[236:239], v1 offset:19456
  s_waitcnt vmcnt(33)
  v_mfma_f32_16x16x32_bf16 v[32:35], v[140:143], v[240:243], v[32:35]
  v_mfma_f32_16x16x32_bf16 v[36:39], v[140:143], v[244:247], v[36:39]
  v_mfma_f32_16x16x32_bf16 v[40:43], v[140:143], v[248:251], v[40:43]
  v_mfma_f32_16x16x32_bf16 v[44:47], v[140:143], v[252:255], v[44:47]
  buffer_load_dwordx4 v[140:143], v1, s[32:35], s80 offen offset:3072 sc1
  s_waitcnt vmcnt(32)
  v_mfma_f32_16x16x32_bf16 v[48:51], v[64:67], a[0:3], 0
  v_mfma_f32_16x16x32_bf16 v[52:55], v[64:67], a[4:7], 0
  v_mfma_f32_16x16x32_bf16 v[56:59], v[64:67], a[8:11], 0
  v_mfma_f32_16x16x32_bf16 v[60:63], v[64:67], a[12:15], 0
  s_add_u32 s80, s80, 4096
  buffer_load_dwordx4 v[64:67], v1, s[32:35], s80 offen offset:0 sc1
  v_mfma_f32_16x16x32_bf16 v[48:51], v[68:71], a[16:19], v[48:51]
  v_cvt_pk_bf16_f32 v12, v32, v33
  v_mfma_f32_16x16x32_bf16 v[52:55], v[68:71], a[20:23], v[52:55]
  v_cvt_pk_bf16_f32 v13, v34, v35
  v_mfma_f32_16x16x32_bf16 v[56:59], v[68:71], a[24:27], v[56:59]
  v_cvt_pk_bf16_f32 v14, v36, v37
  v_mfma_f32_16x16x32_bf16 v[60:63], v[68:71], a[28:31], v[60:63]
  buffer_load_dwordx4 v[68:71], v1, s[32:35], s80 offen offset:1024 sc1
  s_waitcnt vmcnt(32)
  v_mfma_f32_16x16x32_bf16 v[48:51], v[72:75], a[32:35], v[48:51]
  v_cvt_pk_bf16_f32 v15, v38, v39
  v_mfma_f32_16x16x32_bf16 v[52:55], v[72:75], a[36:39], v[52:55]
  v_mfma_f32_16x16x32_bf16 v[56:59], v[72:75], a[40:43], v[56:59]
  v_cvt_pk_bf16_f32 v16, v40, v41
  v_mfma_f32_16x16x32_bf16 v[60:63], v[72:75], a[44:47], v[60:63]
  buffer_load_dwordx4 v[72:75], v1, s[32:35], s80 offen offset:2048 sc1
  v_mfma_f32_16x16x32_bf16 v[48:51], v[76:79], a[48:51], v[48:51]
  v_cvt_pk_bf16_f32 v17, v42, v43
  v_mfma_f32_16x16x32_bf16 v[52:55], v[76:79], a[52:55], v[52:55]
  v_cvt_pk_bf16_f32 v18, v44, v45
  v_mfma_f32_16x16x32_bf16 v[56:59], v[76:79], a[56:59], v[56:59]
  v_cvt_pk_bf16_f32 v19, v46, v47
  v_mfma_f32_16x16x32_bf16 v[60:63], v[76:79], a[60:63], v[60:63]
  buffer_load_dwordx4 v[76:79], v1, s[32:35], s80 offen offset:3072 sc1
  s_waitcnt lgkmcnt(0)
  s_waitcnt vmcnt(32)
  v_mfma_f32_16x16x32_bf16 v[48:51], v[192:195], v[224:227], v[48:51]
  v_mfma_f32_16x16x32_bf16 v[52:55], v[192:195], v[228:231], v[52:55]
  v_mfma_f32_16x16x32_bf16 v[56:59], v[192:195], v[232:235], v[56:59]
  v_mfma_f32_16x16x32_bf16 v[60:63], v[192:195], v[236:239], v[60:63]
  s_add_u32 s80, s80, 4096
  buffer_load_dwordx4 v[192:195], v1, s[32:35], s80 offen offset:0 sc1
  ds_read_b128 v[224:227], v1 offset:36864
  ds_read_b128 v[228:231], v1 offset:37888
  ds_read_b128 v[232:235], v1 offset:38912
  ds_read_b128 v[236:239], v1 offset:39936
  v_mfma_f32_16x16x32_bf16 v[48:51], v[80:83], a[64:67], v[48:51]
  v_mfma_f32_16x16x32_bf16 v[52:55], v[80:83], a[68:71], v[52:55]
  v_mfma_f32_16x16x32_bf16 v[56:59], v[80:83], a[72:75], v[56:59]
  v_mfma_f32_16x16x32_bf16 v[60:63], v[80:83], a[76:79], v[60:63]
  buffer_load_dwordx4 v[80:83], v1, s[32:35], s80 offen offset:1024 sc1
  s_waitcnt vmcnt(32)
  v_mfma_f32_16x16x32_bf16 v[48:51], v[84:87], a[80:83], v[48:51]
  v_mfma_f32_16x16x32_bf16 v[52:55], v[84:87], a[84:87], v[52:55]
  v_mfma_f32_16x16x32_bf16 v[56:59], v[84:87], a[88:91], v[56:59]
  v_mfma_f32_16x16x32_bf16 v[60:63], v[84:87], a[92:95], v[60:63]
  buffer_load_dwordx4 v[84:87], v1, s[32:35], s80 offen offset:2048 sc1
  v_mfma_f32_16x16x32_bf16 v[48:51], v[88:91], a[96:99], v[48:51]
  v_mfma_f32_16x16x32_bf16 v[52:55], v[88:91], a[100:103], v[52:55]
  v_mfma_f32_16x16x32_bf16 v[56:59], v[88:91], a[104:107], v[56:59]
  v_mfma_f32_16x16x32_bf16 v[60:63], v[88:91], a[108:111], v[60:63]
  buffer_load_dwordx4 v[88:91], v1, s[32:35], s80 offen offset:3072 sc1
  s_waitcnt vmcnt(32)
  v_mfma_f32_16x16x32_bf16 v[48:51], v[216:219], a[112:115], v[48:51]
  v_mfma_f32_16x16x32_bf16 v[52:55], v[216:219], a[116:119], v[52:55]
  v_mfma_f32_16x16x32_bf16 v[56:59], v[216:219], a[120:123], v[56:59]
  v_mfma_f32_16x16x32_bf16 v[60:63], v[216:219], a[124:127], v[60:63]
  s_add_u32 s80, s80, 4096
  buffer_load_dwordx4 v[216:219], v1, s[32:35], s80 offen offset:0 sc1
  s_waitcnt lgkmcnt(0)
  v_mfma_f32_16x16x32_bf16 v[48:51], v[92:95], v[224:227], v[48:51]
  v_mfma_f32_16x16x32_bf16 v[52:55], v[92:95], v[228:231], v[52:55]
  v_mfma_f32_16x16x32_bf16 v[56:59], v[92:95], v[232:235], v[56:59]
  v_mfma_f32_16x16x32_bf16 v[60:63], v[92:95], v[236:239], v[60:63]
  buffer_load_dwordx4 v[92:95], v1, s[32:35], s80 offen offset:1024 sc1
  ds_read_b128 v[224:227], v1 offset:57344
  ds_read_b128 v[228:231], v1 offset:58368
  ds_read_b128 v[232:235], v1 offset:59392
  ds_read_b128 v[236:239], v1 offset:60416
  s_waitcnt vmcnt(31)
  v_mfma_f32_16x16x32_bf16 v[48:51], v[220:223], a[128:131], v[48:51]
  v_mfma_f32_16x16x32_bf16 v[52:55], v[220:223], a[132:135], v[52:55]
  v_mfma_f32_16x16x32_bf16 v[56:59], v[220:223], a[136:139], v[56:59]
  v_mfma_f32_16x16x32_bf16 v[60:63], v[220:223], a[140:143], v[60:63]
  buffer_load_dwordx4 v[220:223], v1, s[32:35], s80 offen offset:2048 sc1
  v_mfma_f32_16x16x32_bf16 v[48:51], v[96:99], a[144:147], v[48:51]
  v_mfma_f32_16x16x32_bf16 v[52:55], v[96:99], a[148:151], v[52:55]
  v_mfma_f32_16x16x32_bf16 v[56:59], v[96:99], a[152:155], v[56:59]
  v_mfma_f32_16x16x32_bf16 v[60:63], v[96:99], a[156:159], v[60:63]
  buffer_load_dwordx4 v[96:99], v1, s[32:35], s80 offen offset:3072 sc1
  s_waitcnt vmcnt(31)
  v_mfma_f32_16x16x32_bf16 v[48:51], v[196:199], a[160:163], v[48:51]
  v_mfma_f32_16x16x32_bf16 v[52:55], v[196:199], a[164:167], v[52:55]
  v_mfma_f32_16x16x32_bf16 v[56:59], v[196:199], a[168:171], v[56:59]
  v_mfma_f32_16x16x32_bf16 v[60:63], v[196:199], a[172:175], v[60:63]
  s_add_u32 s80, s80, 4096
  buffer_load_dwordx4 v[196:199], v1, s[32:35], s80 offen offset:0 sc1
  v_mfma_f32_16x16x32_bf16 v[48:51], v[100:103], a[176:179], v[48:51]
  v_mfma_f32_16x16x32_bf16 v[52:55], v[100:103], a[180:183], v[52:55]
  v_mfma_f32_16x16x32_bf16 v[56:59], v[100:103], a[184:187], v[56:59]
  v_mfma_f32_16x16x32_bf16 v[60:63], v[100:103], a[188:191], v[60:63]
  buffer_load_dwordx4 v[100:103], v1, s[32:35], s80 offen offset:1024 sc1
  s_waitcnt lgkmcnt(0)
  s_waitcnt vmcnt(31)
  v_mfma_f32_16x16x32_bf16 v[48:51], v[200:203], v[224:227], v[48:51]
  v_mfma_f32_16x16x32_bf16 v[52:55], v[200:203], v[228:231], v[52:55]
  v_mfma_f32_16x16x32_bf16 v[56:59], v[200:203], v[232:235], v[56:59]
  v_mfma_f32_16x16x32_bf16 v[60:63], v[200:203], v[236:239], v[60:63]
  buffer_load_dwordx4 v[200:203], v1, s[32:35], s80 offen offset:2048 sc1
  ds_read_b128 v[224:227], v26 offset:12288
  ds_read_b128 v[228:231], v26 offset:13312
  ds_read_b128 v[232:235], v26 offset:14336
  ds_read_b128 v[236:239], v26 offset:15360
  v_mfma_f32_16x16x32_bf16 v[48:51], v[104:107], a[192:195], v[48:51]
  v_mfma_f32_16x16x32_bf16 v[52:55], v[104:107], a[196:199], v[52:55]
  v_mfma_f32_16x16x32_bf16 v[56:59], v[104:107], a[200:203], v[56:59]
  v_mfma_f32_16x16x32_bf16 v[60:63], v[104:107], a[204:207], v[60:63]
  buffer_load_dwordx4 v[104:107], v1, s[32:35], s80 offen offset:3072 sc1
  s_waitcnt vmcnt(31)
  v_mfma_f32_16x16x32_bf16 v[48:51], v[204:207], a[208:211], v[48:51]
  v_mfma_f32_16x16x32_bf16 v[52:55], v[204:207], a[212:215], v[52:55]
  v_mfma_f32_16x16x32_bf16 v[56:59], v[204:207], a[216:219], v[56:59]
  v_mfma_f32_16x16x32_bf16 v[60:63], v[204:207], a[220:223], v[60:63]
  s_add_u32 s80, s80, 4096
  buffer_load_dwordx4 v[204:207], v1, s[32:35], s80 offen offset:0 sc1
  v_mfma_f32_16x16x32_bf16 v[48:51], v[108:111], a[224:227], v[48:51]
  v_mfma_f32_16x16x32_bf16 v[52:55], v[108:111], a[228:231], v[52:55]
  v_mfma_f32_16x16x32_bf16 v[56:59], v[108:111], a[232:235], v[56:59]
  v_mfma_f32_16x16x32_bf16 v[60:63], v[108:111], a[236:239], v[60:63]
  buffer_load_dwordx4 v[108:111], v1, s[32:35], s80 offen offset:1024 sc1
  s_waitcnt vmcnt(31)
  v_mfma_f32_16x16x32_bf16 v[48:51], v[208:211], a[240:243], v[48:51]
  v_mfma_f32_16x16x32_bf16 v[52:55], v[208:211], a[244:247], v[52:55]
  v_mfma_f32_16x16x32_bf16 v[56:59], v[208:211], a[248:251], v[56:59]
  v_mfma_f32_16x16x32_bf16 v[60:63], v[208:211], a[252:255], v[60:63]
  buffer_load_dwordx4 v[208:211], v1, s[32:35], s80 offen offset:2048 sc1
  s_waitcnt lgkmcnt(0)
  v_mfma_f32_16x16x32_bf16 v[48:51], v[112:115], v[224:227], v[48:51]
  v_mfma_f32_16x16x32_bf16 v[52:55], v[112:115], v[228:231], v[52:55]
  v_mfma_f32_16x16x32_bf16 v[56:59], v[112:115], v[232:235], v[56:59]
  v_mfma_f32_16x16x32_bf16 v[60:63], v[112:115], v[236:239], v[60:63]
  buffer_load_dwordx4 v[112:115], v1, s[32:35], s80 offen offset:3072 sc1
  s_add_u32 s56, s27, 3
  v_lshrrev_b32 v173, 4, v1
  v_add_u32 v173, s56, v173
  v_and_b32 v173, 7, v173
  v_lshlrev_b32 v173, 12, v173
  v_mov_b32 v172, s29
  s_mov_b64 exec, 1
  buffer_store_dword v172, v173, s[32:35], s76 offen sc1
  s_mov_b64 exec, -1
  ds_read_b128 v[224:227], v1 offset:16384
  ds_read_b128 v[228:231], v1 offset:17408
  ds_read_b128 v[232:235], v1 offset:18432
  ds_read_b128 v[236:239], v1 offset:19456
  s_waitcnt vmcnt(33)
  v_mfma_f32_16x16x32_bf16 v[48:51], v[212:215], v[240:243], v[48:51]
  v_mfma_f32_16x16x32_bf16 v[52:55], v[212:215], v[244:247], v[52:55]
  v_mfma_f32_16x16x32_bf16 v[56:59], v[212:215], v[248:251], v[56:59]
  v_mfma_f32_16x16x32_bf16 v[60:63], v[212:215], v[252:255], v[60:63]
  s_add_u32 s80, s80, 4096
  buffer_load_dwordx4 v[212:215], v1, s[32:35], s80 offen offset:0 sc1
  s_waitcnt vmcnt(32)
  v_mfma_f32_16x16x32_bf16 v[32:35], v[116:119], a[0:3], 0
  v_mfma_f32_16x16x32_bf16 v[36:39], v[116:119], a[4:7], 0
  v_mfma_f32_16x16x32_bf16 v[40:43], v[116:119], a[8:11], 0
  v_mfma_f32_16x16x32_bf16 v[44:47], v[116:119], a[12:15], 0
  buffer_load_dwordx4 v[116:119], v1, s[32:35], s80 offen offset:1024 sc1
  v_mfma_f32_16x16x32_bf16 v[32:35], v[176:179], a[16:19], v[32:35]
  v_cvt_pk_bf16_f32 v144, v48, v49
  v_mfma_f32_16x16x32_bf16 v[36:39], v[176:179], a[20:23], v[36:39]
  v_cvt_pk_bf16_f32 v145, v50, v51
  v_mfma_f32_16x16x32_bf16 v[40:43], v[176:179], a[24:27], v[40:43]
  v_cvt_pk_bf16_f32 v146, v52, v53
  v_mfma_f32_16x16x32_bf16 v[44:47], v[176:179], a[28:31], v[44:47]
  buffer_load_dwordx4 v[176:179], v1, s[32:35], s80 offen offset:2048 sc1
  s_waitcnt vmcnt(32)
  v_mfma_f32_16x16x32_bf16 v[32:35], v[120:123], a[32:35], v[32:35]
  v_cvt_pk_bf16_f32 v147, v54, v55
  v_mfma_f32_16x16x32_bf16 v[36:39], v[120:123], a[36:39], v[36:39]
  v_mfma_f32_16x16x32_bf16 v[40:43], v[120:123], a[40:43], v[40:43]
  v_cvt_pk_bf16_f32 v148, v56, v57
  v_mfma_f32_16x16x32_bf16 v[44:47], v[120:123], a[44:47], v[44:47]
  buffer_load_dwordx4 v[120:123], v1, s[32:35], s80 offen offset:3072 sc1
  v_mfma_f32_16x16x32_bf16 v[32:35], v[180:183], a[48:51], v[32:35]
  v_cvt_pk_bf16_f32 v149, v58, v59
  v_mfma_f32_16x16x32_bf16 v[36:39], v[180:183], a[52:55], v[36:39]
  v_cvt_pk_bf16_f32 v150, v60, v61
  v_mfma_f32_16x16x32_bf16 v[40:43], v[180:183], a[56:59], v[40:43]
  v_cvt_pk_bf16_f32 v151, v62, v63
  v_mfma_f32_16x16x32_bf16 v[44:47], v[180:183], a[60:63], v[44:47]
  s_add_u32 s80, s80, 4096
  buffer_load_dwordx4 v[180:183], v1, s[32:35], s80 offen offset:0 sc1
  s_waitcnt lgkmcnt(0)
  s_waitcnt vmcnt(32)
  v_mfma_f32_16x16x32_bf16 v[32:35], v[184:187], v[224:227], v[32:35]
  v_mfma_f32_16x16x32_bf16 v[36:39], v[184:187], v[228:231], v[36:39]
  v_mfma_f32_16x16x32_bf16 v[40:43], v[184:187], v[232:235], v[40:43]
  v_mfma_f32_16x16x32_bf16 v[44:47], v[184:187], v[236:239], v[44:47]
  buffer_load_dwordx4 v[184:187], v1, s[32:35], s80 offen offset:1024 sc1
  ds_read_b128 v[224:227], v1 offset:36864
  ds_read_b128 v[228:231], v1 offset:37888
  ds_read_b128 v[232:235], v1 offset:38912
  ds_read_b128 v[236:239], v1 offset:39936
  v_mfma_f32_16x16x32_bf16 v[32:35], v[124:127], a[64:67], v[32:35]
  v_mfma_f32_16x16x32_bf16 v[36:39], v[124:127], a[68:71], v[36:39]
  v_mfma_f32_16x16x32_bf16 v[40:43], v[124:127], a[72:75], v[40:43]
  v_mfma_f32_16x16x32_bf16 v[44:47], v[124:127], a[76:79], v[44:47]
  buffer_load_dwordx4 v[124:127], v1, s[32:35], s80 offen offset:2048 sc1
  s_waitcnt vmcnt(32)
  v_mfma_f32_16x16x32_bf16 v[32:35], v[128:131], a[80:83], v[32:35]
  v_mfma_f32_16x16x32_bf16 v[36:39], v[128:131], a[84:87], v[36:39]
  v_mfma_f32_16x16x32_bf16 v[40:43], v[128:131], a[88:91], v[40:43]
  v_mfma_f32_16x16x32_bf16 v[44:47], v[128:131], a[92:95], v[44:47]
  buffer_load_dwordx4 v[128:131], v1, s[32:35], s80 offen offset:3072 sc1
  v_mfma_f32_16x16x32_bf16 v[32:35], v[132:135], a[96:99], v[32:35]
  v_mfma_f32_16x16x32_bf16 v[36:39], v[132:135], a[100:103], v[36:39]
  v_mfma_f32_16x16x32_bf16 v[40:43], v[132:135], a[104:107], v[40:43]
  v_mfma_f32_16x16x32_bf16 v[44:47], v[132:135], a[108:111], v[44:47]
  s_add_u32 s80, s80, 4096
  buffer_load_dwordx4 v[132:135], v1, s[32:35], s80 offen offset:0 sc1
  s_waitcnt vmcnt(32)
  v_mfma_f32_16x16x32_bf16 v[32:35], v[136:139], a[112:115], v[32:35]
  v_mfma_f32_16x16x32_bf16 v[36:39], v[136:139], a[116:119], v[36:39]
  v_mfma_f32_16x16x32_bf16 v[40:43], v[136:139], a[120:123], v[40:43]
  v_mfma_f32_16x16x32_bf16 v[44:47], v[136:139], a[124:127], v[44:47]
  buffer_load_dwordx4 v[136:139], v1, s[32:35], s80 offen offset:1024 sc1
  s_waitcnt lgkmcnt(0)
  v_mfma_f32_16x16x32_bf16 v[32:35], v[188:191], v[224:227], v[32:35]
  v_mfma_f32_16x16x32_bf16 v[36:39], v[188:191], v[228:231], v[36:39]
  v_mfma_f32_16x16x32_bf16 v[40:43], v[188:191], v[232:235], v[40:43]
  v_mfma_f32_16x16x32_bf16 v[44:47], v[188:191], v[236:239], v[44:47]
  buffer_load_dwordx4 v[188:191], v1, s[32:35], s80 offen offset:2048 sc1
  ds_read_b128 v[224:227], v1 offset:57344
  ds_read_b128 v[228:231], v1 offset:58368
  ds_read_b128 v[232:235], v1 offset:59392
  ds_read_b128 v[236:239], v1 offset:60416
  s_waitcnt vmcnt(31)
  v_mfma_f32_16x16x32_bf16 v[32:35], v[140:143], a[128:131], v[32:35]
  v_mfma_f32_16x16x32_bf16 v[36:39], v[140:143], a[132:135], v[36:39]
  v_mfma_f32_16x16x32_bf16 v[40:43], v[140:143], a[136:139], v[40:43]
  v_mfma_f32_16x16x32_bf16 v[44:47], v[140:143], a[140:143], v[44:47]
  s_add_u32 s78, s27, 4
  s_and_b32 s78, s78, 7
  s_lshl_b32 s78, s78, 16
  s_add_u32 s78, s78, s74
  s_add_u32 s79, s78, 1024
  buffer_store_dwordx4 v[4:7], v1, s[32:35], s78 offen sc1
  buffer_store_dwordx4 v[8:11], v1, s[32:35], s79 offen sc1
  v_mfma_f32_16x16x32_bf16 v[32:35], v[64:67], a[144:147], v[32:35]
  v_mfma_f32_16x16x32_bf16 v[36:39], v[64:67], a[148:151], v[36:39]
  v_mfma_f32_16x16x32_bf16 v[40:43], v[64:67], a[152:155], v[40:43]
  v_mfma_f32_16x16x32_bf16 v[44:47], v[64:67], a[156:159], v[44:47]
  s_waitcnt vmcnt(31)
  v_mfma_f32_16x16x32_bf16 v[32:35], v[68:71], a[160:163], v[32:35]
  v_mfma_f32_16x16x32_bf16 v[36:39], v[68:71], a[164:167], v[36:39]
  v_mfma_f32_16x16x32_bf16 v[40:43], v[68:71], a[168:171], v[40:43]
  v_mfma_f32_16x16x32_bf16 v[44:47], v[68:71], a[172:175], v[44:47]
  v_mfma_f32_16x16x32_bf16 v[32:35], v[72:75], a[176:179], v[32:35]
  v_mfma_f32_16x16x32_bf16 v[36:39], v[72:75], a[180:183], v[36:39]
  v_mfma_f32_16x16x32_bf16 v[40:43], v[72:75], a[184:187], v[40:43]
  v_mfma_f32_16x16x32_bf16 v[44:47], v[72:75], a[188:191], v[44:47]
  s_add_u32 s78, s27, 5
  s_and_b32 s78, s78, 7
  s_lshl_b32 s78, s78, 16
  s_add_u32 s78, s78, s74
  s_add_u32 s79, s78, 1024
  buffer_store_dwordx4 v[12:15], v1, s[32:35], s78 offen sc1
  buffer_store_dwordx4 v[16:19], v1, s[32:35], s79 offen sc1
  s_waitcnt lgkmcnt(0)
  s_waitcnt vmcnt(31)
  v_mfma_f32_16x16x32_bf16 v[32:35], v[76:79], v[224:227], v[32:35]
  v_mfma_f32_16x16x32_bf16 v[36:39], v[76:79], v[228:231], v[36:39]
  v_mfma_f32_16x16x32_bf16 v[40:43], v[76:79], v[232:235], v[40:43]
  v_mfma_f32_16x16x32_bf16 v[44:47], v[76:79], v[236:239], v[44:47]
  ds_read_b128 v[224:227], v26 offset:12288
  ds_read_b128 v[228:231], v26 offset:13312
  ds_read_b128 v[232:235], v26 offset:14336
  ds_read_b128 v[236:239], v26 offset:15360
  v_mfma_f32_16x16x32_bf16 v[32:35], v[192:195], a[192:195], v[32:35]
  v_mfma_f32_16x16x32_bf16 v[36:39], v[192:195], a[196:199], v[36:39]
  v_mfma_f32_16x16x32_bf16 v[40:43], v[192:195], a[200:203], v[40:43]
  v_mfma_f32_16x16x32_bf16 v[44:47], v[192:195], a[204:207], v[44:47]
  s_waitcnt vmcnt(29)
  v_mfma_f32_16x16x32_bf16 v[32:35], v[80:83], a[208:211], v[32:35]
  v_mfma_f32_16x16x32_bf16 v[36:39], v[80:83], a[212:215], v[36:39]
  v_mfma_f32_16x16x32_bf16 v[40:43], v[80:83], a[216:219], v[40:43]
  v_mfma_f32_16x16x32_bf16 v[44:47], v[80:83], a[220:223], v[44:47]
  v_mfma_f32_16x16x32_bf16 v[32:35], v[84:87], a[224:227], v[32:35]
  v_mfma_f32_16x16x32_bf16 v[36:39], v[84:87], a[228:231], v[36:39]
  v_mfma_f32_16x16x32_bf16 v[40:43], v[84:87], a[232:235], v[40:43]
  v_mfma_f32_16x16x32_bf16 v[44:47], v[84:87], a[236:239], v[44:47]
  s_add_u32 s78, s27, 6
  s_and_b32 s78, s78, 7
  s_lshl_b32 s78, s78, 16
  s_add_u32 s78, s78, s74
  s_add_u32 s79, s78, 1024
  buffer_store_dwordx4 v[144:147], v1, s[32:35], s78 offen sc1
  buffer_store_dwordx4 v[148:151], v1, s[32:35], s79 offen sc1
  s_waitcnt vmcnt(29)
  v_mfma_f32_16x16x32_bf16 v[32:35], v[88:91], a[240:243], v[32:35]
  v_mfma_f32_16x16x32_bf16 v[36:39], v[88:91], a[244:247], v[36:39]
  v_mfma_f32_16x16x32_bf16 v[40:43], v[88:91], a[248:251], v[40:43]
  v_mfma_f32_16x16x32_bf16 v[44:47], v[88:91], a[252:255], v[44:47]
  s_waitcnt lgkmcnt(0)
  v_mfma_f32_16x16x32_bf16 v[32:35], v[216:219], v[224:227], v[32:35]
  v_mfma_f32_16x16x32_bf16 v[36:39], v[216:219], v[228:231], v[36:39]
  v_mfma_f32_16x16x32_bf16 v[40:43], v[216:219], v[232:235], v[40:43]
  v_mfma_f32_16x16x32_bf16 v[44:47], v[216:219], v[236:239], v[44:47]
  s_lshr_b32 s59, s27, 1
  s_cmp_eq_u32 s59, s26
  s_cselect_b32 s77, 0, 1879048192
  s_lshl_b32 s64, s28, 3
  s_add_u32 s64, s64, s27
  s_lshl_b32 s64, s64, 2
  s_add_u32 s64, s64, s26
  s_lshl_b32 s64, s64, 10
  s_add_u32 s64, s64, 36700160
  v_lshlrev_b32 v170, 3, v1
  s_mov_b64 exec, 0xff
  buffer_load_dwordx2 v[168:169], v170, s[32:35], s64 offen sc1
  s_mov_b64 exec, -1
  s_lshl_b32 s60, s28, 3
  s_add_u32 s60, s60, s27
  s_lshl_b32 s61, s28, 19
  s_lshl_b32 s62, s26, 11
  s_add_u32 s61, s61, s62
  s_add_u32 s61, s61, 16777216
  s_lshl_b32 s62, s27, 16
  s_add_u32 s61, s61, s62
  s_lshl_b32 s62, s60, 13
  s_add_u32 s62, s62, 33554432
  s_add_u32 s62, s62, s77
  ds_read_b128 v[224:227], v1 offset:16384
  ds_read_b128 v[228:231], v1 offset:17408
  ds_read_b128 v[232:235], v1 offset:18432
  ds_read_b128 v[236:239], v1 offset:19456
  s_waitcnt vmcnt(29)
  v_mfma_f32_16x16x32_bf16 v[32:35], v[92:95], v[240:243], v[32:35]
  v_mfma_f32_16x16x32_bf16 v[36:39], v[92:95], v[244:247], v[36:39]
  v_mfma_f32_16x16x32_bf16 v[40:43], v[92:95], v[248:251], v[40:43]
  v_mfma_f32_16x16x32_bf16 v[44:47], v[92:95], v[252:255], v[44:47]
  s_waitcnt vmcnt(27)
  v_mfma_f32_16x16x32_bf16 v[48:51], v[220:223], a[0:3], 0
  v_mfma_f32_16x16x32_bf16 v[52:55], v[220:223], a[4:7], 0
  v_mfma_f32_16x16x32_bf16 v[56:59], v[220:223], a[8:11], 0
  v_mfma_f32_16x16x32_bf16 v[60:63], v[220:223], a[12:15], 0
  v_mfma_f32_16x16x32_bf16 v[48:51], v[96:99], a[16:19], v[48:51]
  v_cvt_pk_bf16_f32 v160, v32, v33
  v_mfma_f32_16x16x32_bf16 v[52:55], v[96:99], a[20:23], v[52:55]
  v_cvt_pk_bf16_f32 v161, v34, v35
  v_mfma_f32_16x16x32_bf16 v[56:59], v[96:99], a[24:27], v[56:59]
  v_cvt_pk_bf16_f32 v162, v36, v37
  v_mfma_f32_16x16x32_bf16 v[60:63], v[96:99], a[28:31], v[60:63]
  s_waitcnt vmcnt(25)
  v_mfma_f32_16x16x32_bf16 v[48:51], v[196:199], a[32:35], v[48:51]
  v_cvt_pk_bf16_f32 v163, v38, v39
  v_mfma_f32_16x16x32_bf16 v[52:55], v[196:199], a[36:39], v[52:55]
  v_mfma_f32_16x16x32_bf16 v[56:59], v[196:199], a[40:43], v[56:59]
  v_cvt_pk_bf16_f32 v164, v40, v41
  v_mfma_f32_16x16x32_bf16 v[60:63], v[196:199], a[44:47], v[60:63]
  v_mfma_f32_16x16x32_bf16 v[48:51], v[100:103], a[48:51], v[48:51]
  v_cvt_pk_bf16_f32 v165, v42, v43
  v_mfma_f32_16x16x32_bf16 v[52:55], v[100:103], a[52:55], v[52:55]
  v_cvt_pk_bf16_f32 v166, v44, v45
  v_mfma_f32_16x16x32_bf16 v[56:59], v[100:103], a[56:59], v[56:59]
  v_cvt_pk_bf16_f32 v167, v46, v47
  v_mfma_f32_16x16x32_bf16 v[60:63], v[100:103], a[60:63], v[60:63]
  s_waitcnt lgkmcnt(0)
  s_waitcnt vmcnt(23)
  v_mfma_f32_16x16x32_bf16 v[48:51], v[200:203], v[224:227], v[48:51]
  v_mfma_f32_16x16x32_bf16 v[52:55], v[200:203], v[228:231], v[52:55]
  v_mfma_f32_16x16x32_bf16 v[56:59], v[200:203], v[232:235], v[56:59]
  v_mfma_f32_16x16x32_bf16 v[60:63], v[200:203], v[236:239], v[60:63]
  s_add_u32 s78, s27, 7
  s_and_b32 s78, s78, 7
  s_lshl_b32 s78, s78, 16
  s_add_u32 s78, s78, s74
  s_add_u32 s79, s78, 1024
  buffer_store_dwordx4 v[160:163], v1, s[32:35], s78 offen sc1
  buffer_store_dwordx4 v[164:167], v1, s[32:35], s79 offen sc1
  ds_read_b128 v[224:227], v1 offset:36864
  ds_read_b128 v[228:231], v1 offset:37888
  ds_read_b128 v[232:235], v1 offset:38912
  ds_read_b128 v[236:239], v1 offset:39936
  v_mfma_f32_16x16x32_bf16 v[48:51], v[104:107], a[64:67], v[48:51]
  v_mfma_f32_16x16x32_bf16 v[52:55], v[104:107], a[68:71], v[52:55]
  v_mfma_f32_16x16x32_bf16 v[56:59], v[104:107], a[72:75], v[56:59]
  v_mfma_f32_16x16x32_bf16 v[60:63], v[104:107], a[76:79], v[60:63]
  s_waitcnt vmcnt(23)
  v_mfma_f32_16x16x32_bf16 v[48:51], v[204:207], a[80:83], v[48:51]
  v_mfma_f32_16x16x32_bf16 v[52:55], v[204:207], a[84:87], v[52:55]
  v_mfma_f32_16x16x32_bf16 v[56:59], v[204:207], a[88:91], v[56:59]
  v_mfma_f32_16x16x32_bf16 v[60:63], v[204:207], a[92:95], v[60:63]
  s_mov_b32 s44, s20
  s_mov_b32 s45, s21
  s_mov_b32 s46, 2359296
  s_mov_b32 s47, 0x20000
  s_mov_b32 s48, s18
  s_mov_b32 s49, s19
  s_mov_b32 s50, 1152
  s_mov_b32 s51, 0x20000
  v_lshrrev_b32 v20, 4, v1
  v_lshrrev_b32 v21, 3, v20
  v_and_b32 v22, 7, v20
  s_lshl_b32 s56, s28, 6
  s_lshl_b32 s57, s26, 4
  s_add_u32 s56, s56, s57
  v_add_u32 v23, s56, v21
  v_mul_u32_u24 v23, 1152, v23
  s_lshl_b32 s57, s27, 7
  v_lshl_add_u32 v24, v22, 4, s57
  v_add_u32 v27, v23, v24
  s_mul_i32 s56, s26, 4352
  s_add_u32 s56, s56, 86016
  v_mul_u32_u24 v28, 272, v21
  v_lshl_add_u32 v28, v22, 5, v28
  v_add_u32 v28, s56, v28
  v_lshrrev_b32 v21, 1, v20
  v_and_b32 v22, 1, v20
  s_and_b32 s58, s27, 1
  s_lshl_b32 s58, s58, 5
  s_lshl_b32 s56, s28, 6
  s_add_u32 s56, s56, s58
  v_add_u32 v23, s56, v21
  v_mul_u32_u24 v23, 1152, v23
  s_lshr_b32 s59, s27, 1
  s_lshl_b32 s57, s59, 5
  s_add_u32 s57, s57, 1024
  v_lshl_add_u32 v25, v22, 4, s57
  v_add_u32 v29, v23, v25
  v_mul_u32_u24 v30, 80, v21
  v_lshl_add_u32 v30, v22, 5, v30
  v_add_u32 v30, 106496, v30
  s_cmp_eq_u32 s59, s26
  s_cselect_b32 s77, 0, 1879048192
  buffer_load_dwordx4 v[4:7], v27, s[40:43], 0 offen
  s_mov_b32 s60, 9216
  buffer_load_dwordx4 v[8:11], v27, s[40:43], s60 offen
  buffer_load_dwordx4 v[12:15], v29, s[40:43], s77 offen
  buffer_load_dwordx4 v[16:19], v24, s[48:51], 0 offen
  buffer_load_dwordx4 v[20:23], v25, s[48:51], 0 offen
  v_mfma_f32_16x16x32_bf16 v[48:51], v[108:111], a[96:99], v[48:51]
  v_mfma_f32_16x16x32_bf16 v[52:55], v[108:111], a[100:103], v[52:55]
  v_mfma_f32_16x16x32_bf16 v[56:59], v[108:111], a[104:107], v[56:59]
  v_mfma_f32_16x16x32_bf16 v[60:63], v[108:111], a[108:111], v[60:63]
  s_waitcnt vmcnt(26)
  v_mfma_f32_16x16x32_bf16 v[48:51], v[208:211], a[112:115], v[48:51]
  v_mfma_f32_16x16x32_bf16 v[52:55], v[208:211], a[116:119], v[52:55]
  v_mfma_f32_16x16x32_bf16 v[56:59], v[208:211], a[120:123], v[56:59]
  v_mfma_f32_16x16x32_bf16 v[60:63], v[208:211], a[124:127], v[60:63]
  s_waitcnt lgkmcnt(0)
  v_mfma_f32_16x16x32_bf16 v[48:51], v[112:115], v[224:227], v[48:51]
  v_mfma_f32_16x16x32_bf16 v[52:55], v[112:115], v[228:231], v[52:55]
  v_mfma_f32_16x16x32_bf16 v[56:59], v[112:115], v[232:235], v[56:59]
  v_mfma_f32_16x16x32_bf16 v[60:63], v[112:115], v[236:239], v[60:63]
  ds_read_b128 v[224:227], v1 offset:57344
  ds_read_b128 v[228:231], v1 offset:58368
  ds_read_b128 v[232:235], v1 offset:59392
  ds_read_b128 v[236:239], v1 offset:60416
  s_waitcnt vmcnt(23)
  v_mfma_f32_16x16x32_bf16 v[48:51], v[212:215], a[128:131], v[48:51]
  v_mfma_f32_16x16x32_bf16 v[52:55], v[212:215], a[132:135], v[52:55]
  v_mfma_f32_16x16x32_bf16 v[56:59], v[212:215], a[136:139], v[56:59]
  v_mfma_f32_16x16x32_bf16 v[60:63], v[212:215], a[140:143], v[60:63]
  v_mfma_f32_16x16x32_bf16 v[48:51], v[116:119], a[144:147], v[48:51]
  v_mfma_f32_16x16x32_bf16 v[52:55], v[116:119], a[148:151], v[52:55]
  v_mfma_f32_16x16x32_bf16 v[56:59], v[116:119], a[152:155], v[56:59]
  v_mfma_f32_16x16x32_bf16 v[60:63], v[116:119], a[156:159], v[60:63]
  s_waitcnt vmcnt(21)
  v_mfma_f32_16x16x32_bf16 v[48:51], v[176:179], a[160:163], v[48:51]
  v_mfma_f32_16x16x32_bf16 v[52:55], v[176:179], a[164:167], v[52:55]
  v_mfma_f32_16x16x32_bf16 v[56:59], v[176:179], a[168:171], v[56:59]
  v_mfma_f32_16x16x32_bf16 v[60:63], v[176:179], a[172:175], v[60:63]
  v_mfma_f32_16x16x32_bf16 v[48:51], v[120:123], a[176:179], v[48:51]
  v_mfma_f32_16x16x32_bf16 v[52:55], v[120:123], a[180:183], v[52:55]
  v_mfma_f32_16x16x32_bf16 v[56:59], v[120:123], a[184:187], v[56:59]
  v_mfma_f32_16x16x32_bf16 v[60:63], v[120:123], a[188:191], v[60:63]
  s_waitcnt lgkmcnt(0)
  s_waitcnt vmcnt(19)
  v_mfma_f32_16x16x32_bf16 v[48:51], v[180:183], v[224:227], v[48:51]
  v_mfma_f32_16x16x32_bf16 v[52:55], v[180:183], v[228:231], v[52:55]
  v_mfma_f32_16x16x32_bf16 v[56:59], v[180:183], v[232:235], v[56:59]
  v_mfma_f32_16x16x32_bf16 v[60:63], v[180:183], v[236:239], v[60:63]
  ds_read_b128 v[224:227], v26 offset:12288
  ds_read_b128 v[228:231], v26 offset:13312
  ds_read_b128 v[232:235], v26 offset:14336
  ds_read_b128 v[236:239], v26 offset:15360
  v_mfma_f32_16x16x32_bf16 v[48:51], v[184:187], a[192:195], v[48:51]
  v_mfma_f32_16x16x32_bf16 v[52:55], v[184:187], a[196:199], v[52:55]
  v_mfma_f32_16x16x32_bf16 v[56:59], v[184:187], a[200:203], v[56:59]
  v_mfma_f32_16x16x32_bf16 v[60:63], v[184:187], a[204:207], v[60:63]
  s_waitcnt vmcnt(17)
  v_mfma_f32_16x16x32_bf16 v[48:51], v[124:127], a[208:211], v[48:51]
  v_mfma_f32_16x16x32_bf16 v[52:55], v[124:127], a[212:215], v[52:55]
  v_mfma_f32_16x16x32_bf16 v[56:59], v[124:127], a[216:219], v[56:59]
  v_mfma_f32_16x16x32_bf16 v[60:63], v[124:127], a[220:223], v[60:63]
  v_mfma_f32_16x16x32_bf16 v[48:51], v[128:131], a[224:227], v[48:51]
  v_mfma_f32_16x16x32_bf16 v[52:55], v[128:131], a[228:231], v[52:55]
  v_mfma_f32_16x16x32_bf16 v[56:59], v[128:131], a[232:235], v[56:59]
  v_mfma_f32_16x16x32_bf16 v[60:63], v[128:131], a[236:239], v[60:63]
  s_waitcnt vmcnt(15)
  v_mfma_f32_16x16x32_bf16 v[48:51], v[132:135], a[240:243], v[48:51]
  v_mfma_f32_16x16x32_bf16 v[52:55], v[132:135], a[244:247], v[52:55]
  v_mfma_f32_16x16x32_bf16 v[56:59], v[132:135], a[248:251], v[56:59]
  v_mfma_f32_16x16x32_bf16 v[60:63], v[132:135], a[252:255], v[60:63]
  s_mov_b32 s57, 57568
  s_lshl_b32 s57, s57, s27
  s_lshr_b32 s57, s57, 8
  s_and_b32 s63, s57, 0xff
  s_mov_b32 s59, 0
  s_mov_b32 s58, 200000
  s_waitcnt vmcnt(7)
Lx_15:
  v_cmp_ne_u32 vcc, s29, v168
  v_cmp_ne_u32 s[66:67], s29, v169
  s_nop 1
  s_and_b32 s57, vcc_lo, s63
  s_and_b32 s66, s66, s59
  s_or_b32 s57, s57, s66
  s_cmp_eq_u32 s57, 0
  s_cbranch_scc1 Lx_16
  s_sub_u32 s58, s58, 1
  s_cbranch_scc1 Lx_16
  s_mov_b64 exec, 0xff
  buffer_load_dwordx2 v[168:169], v170, s[32:35], s64 offen sc1
  s_mov_b64 exec, -1
  s_waitcnt vmcnt(0)
  s_branch Lx_15
Lx_16:
  s_add_u32 s56, s27, 7
  s_and_b32 s56, s56, 7
  s_lshl_b32 s57, s56, 13
  s_add_u32 s57, s57, s61
  buffer_load_dwordx4 v[140:143], v1, s[32:35], s57 offen sc1
  buffer_load_dwordx4 v[64:67], v1, s[32:35], s57 offen offset:1024 sc1
  s_lshl_b32 s57, s56, 10
  s_add_u32 s57, s57, s62
  buffer_load_dwordx4 v[68:71], v1, s[32:35], s57 offen sc1
  s_add_u32 s56, s27, 6
  s_and_b32 s56, s56, 7
  s_lshl_b32 s57, s56, 13
  s_add_u32 s57, s57, s61
  buffer_load_dwordx4 v[72:75], v1, s[32:35], s57 offen sc1
  buffer_load_dwordx4 v[76:79], v1, s[32:35], s57 offen offset:1024 sc1
  s_lshl_b32 s57, s56, 10
  s_add_u32 s57, s57, s62
  buffer_load_dwordx4 v[80:83], v1, s[32:35], s57 offen sc1
  s_add_u32 s56, s27, 5
  s_and_b32 s56, s56, 7
  s_lshl_b32 s57, s56, 13
  s_add_u32 s57, s57, s61
  buffer_load_dwordx4 v[84:87], v1, s[32:35], s57 offen sc1
  buffer_load_dwordx4 v[88:91], v1, s[32:35], s57 offen offset:1024 sc1
  s_lshl_b32 s57, s56, 10
  s_add_u32 s57, s57, s62
  buffer_load_dwordx4 v[92:95], v1, s[32:35], s57 offen sc1
  s_waitcnt lgkmcnt(0)
  v_mfma_f32_16x16x32_bf16 v[48:51], v[136:139], v[224:227], v[48:51]
  v_mfma_f32_16x16x32_bf16 v[52:55], v[136:139], v[228:231], v[52:55]
  v_mfma_f32_16x16x32_bf16 v[56:59], v[136:139], v[232:235], v[56:59]
  v_mfma_f32_16x16x32_bf16 v[60:63], v[136:139], v[236:239], v[60:63]
  v_mfma_f32_16x16x32_bf16 v[48:51], v[188:191], v[240:243], v[48:51]
  v_mfma_f32_16x16x32_bf16 v[52:55], v[188:191], v[244:247], v[52:55]
  v_mfma_f32_16x16x32_bf16 v[56:59], v[188:191], v[248:251], v[56:59]
  v_mfma_f32_16x16x32_bf16 v[60:63], v[188:191], v[252:255], v[60:63]
  s_waitcnt vmcnt(14)
  s_add_u32 s56, s27, 4
  v_lshrrev_b32 v173, 4, v1
  v_add_u32 v173, s56, v173
  v_and_b32 v173, 7, v173
  v_lshlrev_b32 v173, 12, v173
  v_mov_b32 v172, s29
  s_mov_b64 exec, 15
  buffer_store_dword v172, v173, s[32:35], s76 offen sc1
  s_mov_b64 exec, -1
  s_mov_b64 exec, 0xff
  buffer_load_dwordx2 v[168:169], v170, s[32:35], s64 offen sc1
  s_mov_b64 exec, -1
  s_mov_b32 s57, 7710
  s_lshl_b32 s57, s57, s27
  s_lshr_b32 s57, s57, 8
  s_and_b32 s63, s57, 0xff
  s_mov_b32 s59, 0
  s_mov_b32 s58, 200000
  s_waitcnt vmcnt(0)
Lx_17:
  v_cmp_ne_u32 vcc, s29, v168
  v_cmp_ne_u32 s[66:67], s29, v169
  s_nop 1
  s_and_b32 s57, vcc_lo, s63
  s_and_b32 s66, s66, s59
  s_or_b32 s57, s57, s66
  s_cmp_eq_u32 s57, 0
  s_cbranch_scc1 Lx_18
  s_sub_u32 s58, s58, 1
  s_cbranch_scc1 Lx_18
  s_mov_b64 exec, 0xff
  buffer_load_dwordx2 v[168:169], v170, s[32:35], s64 offen sc1
  s_mov_b64 exec, -1
  s_waitcnt vmcnt(0)
  s_branch Lx_17
Lx_18:
  s_add_u32 s56, s27, 4
  s_and_b32 s56, s56, 7
  s_lshl_b32 s57, s56, 13
  s_add_u32 s57, s57, s61
  buffer_load_dwordx4 v[96:99], v1, s[32:35], s57 offen sc1
  buffer_load_dwordx4 v[100:103], v1, s[32:35], s57 offen offset:1024 sc1
  s_lshl_b32 s57, s56, 10
  s_add_u32 s57, s57, s62
  buffer_load_dwordx4 v[104:107], v1, s[32:35], s57 offen sc1
  s_add_u32 s56, s27, 3
  s_and_b32 s56, s56, 7
  s_lshl_b32 s57, s56, 13
  s_add_u32 s57, s57, s61
  buffer_load_dwordx4 v[108:111], v1, s[32:35], s57 offen sc1
  buffer_load_dwordx4 v[112:115], v1, s[32:35], s57 offen offset:1024 sc1
  s_lshl_b32 s57, s56, 10
  s_add_u32 s57, s57, s62
  buffer_load_dwordx4 v[116:119], v1, s[32:35], s57 offen sc1
  s_add_u32 s56, s27, 2
  s_and_b32 s56, s56, 7
  s_lshl_b32 s57, s56, 13
  s_add_u32 s57, s57, s61
  buffer_load_dwordx4 v[120:123], v1, s[32:35], s57 offen sc1
  buffer_load_dwordx4 v[124:127], v1, s[32:35], s57 offen offset:1024 sc1
  s_lshl_b32 s57, s56, 10
  s_add_u32 s57, s57, s62
  buffer_load_dwordx4 v[128:131], v1, s[32:35], s57 offen sc1
  s_add_u32 s56, s27, 1
  s_and_b32 s56, s56, 7
  s_lshl_b32 s57, s56, 13
  s_add_u32 s57, s57, s61
  buffer_load_dwordx4 v[132:135], v1, s[32:35], s57 offen sc1
  buffer_load_dwordx4 v[136:139], v1, s[32:35], s57 offen offset:1024 sc1
  s_lshl_b32 s57, s56, 10
  s_add_u32 s57, s57, s62
  buffer_load_dwordx4 v[192:195], v1, s[32:35], s57 offen sc1
  s_mov_b32 s56, 0x3f80
  s_mov_b32 s57, 0x3f800000
  v_dot2_f32_bf16 v48, v140, s56, v48
  v_dot2_f32_bf16 v49, v140, s57, v49
  v_dot2_f32_bf16 v50, v141, s56, v50
  v_dot2_f32_bf16 v51, v141, s57, v51
  v_dot2_f32_bf16 v52, v142, s56, v52
  v_dot2_f32_bf16 v53, v142, s57, v53
  v_dot2_f32_bf16 v54, v143, s56, v54
  v_dot2_f32_bf16 v55, v143, s57, v55
  v_dot2_f32_bf16 v56, v64, s56, v56
  v_dot2_f32_bf16 v57, v64, s57, v57
  v_dot2_f32_bf16 v58, v65, s56, v58
  v_dot2_f32_bf16 v59, v65, s57, v59
  v_dot2_f32_bf16 v60, v66, s56, v60
  v_dot2_f32_bf16 v61, v66, s57, v61
  v_dot2_f32_bf16 v62, v67, s56, v62
  v_dot2_f32_bf16 v63, v67, s57, v63
  v_dot2_f32_bf16 v152, v68, s56, v152
  v_dot2_f32_bf16 v153, v68, s57, v153
  v_dot2_f32_bf16 v154, v69, s56, v154
  v_dot2_f32_bf16 v155, v69, s57, v155
  v_dot2_f32_bf16 v156, v70, s56, v156
  v_dot2_f32_bf16 v157, v70, s57, v157
  v_dot2_f32_bf16 v158, v71, s56, v158
  v_dot2_f32_bf16 v159, v71, s57, v159
  v_dot2_f32_bf16 v48, v72, s56, v48
  v_dot2_f32_bf16 v49, v72, s57, v49
  v_dot2_f32_bf16 v50, v73, s56, v50
  v_dot2_f32_bf16 v51, v73, s57, v51
  v_dot2_f32_bf16 v52, v74, s56, v52
  v_dot2_f32_bf16 v53, v74, s57, v53
  v_dot2_f32_bf16 v54, v75, s56, v54
  v_dot2_f32_bf16 v55, v75, s57, v55
  v_dot2_f32_bf16 v56, v76, s56, v56
  v_dot2_f32_bf16 v57, v76, s57, v57
  v_dot2_f32_bf16 v58, v77, s56, v58
  v_dot2_f32_bf16 v59, v77, s57, v59
  v_dot2_f32_bf16 v60, v78, s56, v60
  v_dot2_f32_bf16 v61, v78, s57, v61
  v_dot2_f32_bf16 v62, v79, s56, v62
  v_dot2_f32_bf16 v63, v79, s57, v63
  v_dot2_f32_bf16 v152, v80, s56, v152
  v_dot2_f32_bf16 v153, v80, s57, v153
  v_dot2_f32_bf16 v154, v81, s56, v154
  v_dot2_f32_bf16 v155, v81, s57, v155
  v_dot2_f32_bf16 v156, v82, s56, v156
  v_dot2_f32_bf16 v157, v82, s57, v157
  v_dot2_f32_bf16 v158, v83, s56, v158
  v_dot2_f32_bf16 v159, v83, s57, v159
  v_dot2_f32_bf16 v48, v84, s56, v48
  v_dot2_f32_bf16 v49, v84, s57, v49
  v_dot2_f32_bf16 v50, v85, s56, v50
  v_dot2_f32_bf16 v51, v85, s57, v51
  v_dot2_f32_bf16 v52, v86, s56, v52
  v_dot2_f32_bf16 v53, v86, s57, v53
  v_dot2_f32_bf16 v54, v87, s56, v54
  v_dot2_f32_bf16 v55, v87, s57, v55
  v_dot2_f32_bf16 v56, v88, s56, v56
  v_dot2_f32_bf16 v57, v88, s57, v57
  v_dot2_f32_bf16 v58, v89, s56, v58
  v_dot2_f32_bf16 v59, v89, s57, v59
  v_dot2_f32_bf16 v60, v90, s56, v60
  v_dot2_f32_bf16 v61, v90, s57, v61
  v_dot2_f32_bf16 v62, v91, s56, v62
  v_dot2_f32_bf16 v63, v91, s57, v63
  v_dot2_f32_bf16 v152, v92, s56, v152
  v_dot2_f32_bf16 v153, v92, s57, v153
  v_dot2_f32_bf16 v154, v93, s56, v154
  v_dot2_f32_bf16 v155, v93, s57, v155
  v_dot2_f32_bf16 v156, v94, s56, v156
  v_dot2_f32_bf16 v157, v94, s57, v157
  v_dot2_f32_bf16 v158, v95, s56, v158
  v_dot2_f32_bf16 v159, v95, s57, v159
  s_waitcnt vmcnt(9)
  v_dot2_f32_bf16 v48, v96, s56, v48
  v_dot2_f32_bf16 v49, v96, s57, v49
  v_dot2_f32_bf16 v50, v97, s56, v50
  v_dot2_f32_bf16 v51, v97, s57, v51
  v_dot2_f32_bf16 v52, v98, s56, v52
  v_dot2_f32_bf16 v53, v98, s57, v53
  v_dot2_f32_bf16 v54, v99, s56, v54
  v_dot2_f32_bf16 v55, v99, s57, v55
  v_dot2_f32_bf16 v56, v100, s56, v56
  v_dot2_f32_bf16 v57, v100, s57, v57
  v_dot2_f32_bf16 v58, v101, s56, v58
  v_dot2_f32_bf16 v59, v101, s57, v59
  v_dot2_f32_bf16 v60, v102, s56, v60
  v_dot2_f32_bf16 v61, v102, s57, v61
  v_dot2_f32_bf16 v62, v103, s56, v62
  v_dot2_f32_bf16 v63, v103, s57, v63
  v_dot2_f32_bf16 v152, v104, s56, v152
  v_dot2_f32_bf16 v153, v104, s57, v153
  v_dot2_f32_bf16 v154, v105, s56, v154
  v_dot2_f32_bf16 v155, v105, s57, v155
  v_dot2_f32_bf16 v156, v106, s56, v156
  v_dot2_f32_bf16 v157, v106, s57, v157
  v_dot2_f32_bf16 v158, v107, s56, v158
  v_dot2_f32_bf16 v159, v107, s57, v159
  s_waitcnt vmcnt(6)
  v_dot2_f32_bf16 v48, v108, s56, v48
  v_dot2_f32_bf16 v49, v108, s57, v49
  v_dot2_f32_bf16 v50, v109, s56, v50
  v_dot2_f32_bf16 v51, v109, s57, v51
  v_dot2_f32_bf16 v52, v110, s56, v52
  v_dot2_f32_bf16 v53, v110, s57, v53
  v_dot2_f32_bf16 v54, v111, s56, v54
  v_dot2_f32_bf16 v55, v111, s57, v55
  v_dot2_f32_bf16 v56, v112, s56, v56
  v_dot2_f32_bf16 v57, v112, s57, v57
  v_dot2_f32_bf16 v58, v113, s56, v58
  v_dot2_f32_bf16 v59, v113, s57, v59
  v_dot2_f32_bf16 v60, v114, s56, v60
  v_dot2_f32_bf16 v61, v114, s57, v61
  v_dot2_f32_bf16 v62, v115, s56, v62
  v_dot2_f32_bf16 v63, v115, s57, v63
  v_dot2_f32_bf16 v152, v116, s56, v152
  v_dot2_f32_bf16 v153, v116, s57, v153
  v_dot2_f32_bf16 v154, v117, s56, v154
  v_dot2_f32_bf16 v155, v117, s57, v155
  v_dot2_f32_bf16 v156, v118, s56, v156
  v_dot2_f32_bf16 v157, v118, s57, v157
  v_dot2_f32_bf16 v158, v119, s56, v158
  v_dot2_f32_bf16 v159, v119, s57, v159
  s_waitcnt vmcnt(3)
  v_dot2_f32_bf16 v48, v120, s56, v48
  v_dot2_f32_bf16 v49, v120, s57, v49
  v_dot2_f32_bf16 v50, v121, s56, v50
  v_dot2_f32_bf16 v51, v121, s57, v51
  v_dot2_f32_bf16 v52, v122, s56, v52
  v_dot2_f32_bf16 v53, v122, s57, v53
  v_dot2_f32_bf16 v54, v123, s56, v54
  v_dot2_f32_bf16 v55, v123, s57, v55
  v_dot2_f32_bf16 v56, v124, s56, v56
  v_dot2_f32_bf16 v57, v124, s57, v57
  v_dot2_f32_bf16 v58, v125, s56, v58
  v_dot2_f32_bf16 v59, v125, s57, v59
  v_dot2_f32_bf16 v60, v126, s56, v60
  v_dot2_f32_bf16 v61, v126, s57, v61
  v_dot2_f32_bf16 v62, v127, s56, v62
  v_dot2_f32_bf16 v63, v127, s57, v63
  v_dot2_f32_bf16 v152, v128, s56, v152
  v_dot2_f32_bf16 v153, v128, s57, v153
  v_dot2_f32_bf16 v154, v129, s56, v154
  v_dot2_f32_bf16 v155, v129, s57, v155
  v_dot2_f32_bf16 v156, v130, s56, v156
  v_dot2_f32_bf16 v157, v130, s57, v157
  v_dot2_f32_bf16 v158, v131, s56, v158
  v_dot2_f32_bf16 v159, v131, s57, v159
  s_waitcnt vmcnt(0)
  v_dot2_f32_bf16 v48, v132, s56, v48
  v_dot2_f32_bf16 v49, v132, s57, v49
  v_dot2_f32_bf16 v50, v133, s56, v50
  v_dot2_f32_bf16 v51, v133, s57, v51
  v_dot2_f32_bf16 v52, v134, s56, v52
  v_dot2_f32_bf16 v53, v134, s57, v53
  v_dot2_f32_bf16 v54, v135, s56, v54
  v_dot2_f32_bf16 v55, v135, s57, v55
  v_dot2_f32_bf16 v56, v136, s56, v56
  v_dot2_f32_bf16 v57, v136, s57, v57
  v_dot2_f32_bf16 v58, v137, s56, v58
  v_dot2_f32_bf16 v59, v137, s57, v59
  v_dot2_f32_bf16 v60, v138, s56, v60
  v_dot2_f32_bf16 v61, v138, s57, v61
  v_dot2_f32_bf16 v62, v139, s56, v62
  v_dot2_f32_bf16 v63, v139, s57, v63
  v_dot2_f32_bf16 v152, v192, s56, v152
  v_dot2_f32_bf16 v153, v192, s57, v153
  v_dot2_f32_bf16 v154, v193, s56, v154
  v_dot2_f32_bf16 v155, v193, s57, v155
  v_dot2_f32_bf16 v156, v194, s56, v156
  v_dot2_f32_bf16 v157, v194, s57, v157
  v_dot2_f32_bf16 v158, v195, s56, v158
  v_dot2_f32_bf16 v159, v195, s57, v159
  v_mul_u32_u24 v168, 272, v2
  v_lshl_add_u32 v168, v3, 4, v168
  s_lshl_b32 s58, s26, 6
  s_add_u32 s58, s58, 86016
  v_add_u32 v168, s58, v168
  v_mul_u32_u24 v169, 80, v2
  v_lshl_add_u32 v169, v3, 4, v169
  v_add_u32 v169, 106496, v169
  v_mov_b32 v170, 162304
  s_cmp_eq_u32 s77, 0
  s_cselect_b64 vcc, -1, 0
  v_cndmask_b32 v169, v170, v169, vcc
  ds_write_b128 v168, v[48:51] offset:0
  ds_write_b128 v168, v[52:55] offset:4352
  ds_write_b128 v168, v[56:59] offset:8704
  ds_write_b128 v168, v[60:63] offset:13056
  ds_write_b128 v169, v[152:155] offset:0
  ds_write_b128 v169, v[156:159] offset:1280
  s_waitcnt lgkmcnt(0)
  s_barrier
  ds_read_b128 v[64:67], v28 offset:0
  ds_read_b128 v[68:71], v28 offset:16
  ds_read_b128 v[72:75], v28 offset:2176
  ds_read_b128 v[76:79], v28 offset:2192
  ds_read_b128 v[80:83], v30
  ds_read_b128 v[84:87], v30 offset:16
  s_waitcnt lgkmcnt(4)
  v_dot2_f32_bf16 v64, v4, s56, v64
  v_dot2_f32_bf16 v65, v4, s57, v65
  v_dot2_f32_bf16 v66, v5, s56, v66
  v_dot2_f32_bf16 v67, v5, s57, v67
  v_dot2_f32_bf16 v68, v6, s56, v68
  v_dot2_f32_bf16 v69, v6, s57, v69
  v_dot2_f32_bf16 v70, v7, s56, v70
  v_dot2_f32_bf16 v71, v7, s57, v71
  v_dot2_f32_bf16 v64, v16, s56, v64
  v_dot2_f32_bf16 v65, v16, s57, v65
  v_dot2_f32_bf16 v66, v17, s56, v66
  v_dot2_f32_bf16 v67, v17, s57, v67
  v_dot2_f32_bf16 v68, v18, s56, v68
  v_dot2_f32_bf16 v69, v18, s57, v69
  v_dot2_f32_bf16 v70, v19, s56, v70
  v_dot2_f32_bf16 v71, v19, s57, v71
  s_waitcnt lgkmcnt(2)
  v_dot2_f32_bf16 v72, v8, s56, v72
  v_dot2_f32_bf16 v73, v8, s57, v73
  v_dot2_f32_bf16 v74, v9, s56, v74
  v_dot2_f32_bf16 v75, v9, s57, v75
  v_dot2_f32_bf16 v76, v10, s56, v76
  v_dot2_f32_bf16 v77, v10, s57, v77
  v_dot2_f32_bf16 v78, v11, s56, v78
  v_dot2_f32_bf16 v79, v11, s57, v79
  v_dot2_f32_bf16 v72, v16, s56, v72
  v_dot2_f32_bf16 v73, v16, s57, v73
  v_dot2_f32_bf16 v74, v17, s56, v74
  v_dot2_f32_bf16 v75, v17, s57, v75
  v_dot2_f32_bf16 v76, v18, s56, v76
  v_dot2_f32_bf16 v77, v18, s57, v77
  v_dot2_f32_bf16 v78, v19, s56, v78
  v_dot2_f32_bf16 v79, v19, s57, v79
  s_waitcnt lgkmcnt(0)
  v_dot2_f32_bf16 v80, v12, s56, v80
  v_dot2_f32_bf16 v81, v12, s57, v81
  v_dot2_f32_bf16 v82, v13, s56, v82
  v_dot2_f32_bf16 v83, v13, s57, v83
  v_dot2_f32_bf16 v84, v14, s56, v84
  v_dot2_f32_bf16 v85, v14, s57, v85
  v_dot2_f32_bf16 v86, v15, s56, v86
  v_dot2_f32_bf16 v87, v15, s57, v87
  v_dot2_f32_bf16 v80, v20, s56, v80
  v_dot2_f32_bf16 v81, v20, s57, v81
  v_dot2_f32_bf16 v82, v21, s56, v82
  v_dot2_f32_bf16 v83, v21, s57, v83
  v_dot2_f32_bf16 v84, v22, s56, v84
  v_dot2_f32_bf16 v85, v22, s57, v85
  v_dot2_f32_bf16 v86, v23, s56, v86
  v_dot2_f32_bf16 v87, v23, s57, v87
  v_cvt_pk_bf16_f32 v4, v64, v65
  v_cvt_pk_bf16_f32 v5, v66, v67
  v_cvt_pk_bf16_f32 v6, v68, v69
  v_cvt_pk_bf16_f32 v7, v70, v71
  v_cvt_pk_bf16_f32 v8, v72, v73
  v_cvt_pk_bf16_f32 v9, v74, v75
  v_cvt_pk_bf16_f32 v10, v76, v77
  v_cvt_pk_bf16_f32 v11, v78, v79
  v_cvt_pk_bf16_f32 v12, v80, v81
  v_cvt_pk_bf16_f32 v13, v82, v83
  v_cvt_pk_bf16_f32 v14, v84, v85
  v_cvt_pk_bf16_f32 v15, v86, v87
  buffer_store_dwordx4 v[4:7], v27, s[44:47], 0 offen sc1
  s_mov_b32 s60, 9216
  buffer_store_dwordx4 v[8:11], v27, s[44:47], s60 offen sc1
  buffer_store_dwordx4 v[12:15], v29, s[44:47], s77 offen sc1
  s_or_b32 s56, s2, s26
  s_cmp_eq_u32 s56, 0
  s_mov_b32 s57, 35684352
  s_cselect_b32 s56, s57, 1879048192
  v_mov_b32 v172, s29
  v_mov_b32 v173, 0
  s_mov_b64 exec, 1
  buffer_store_dword v172, v173, s[32:35], s56 offen sc1
  s_mov_b64 exec, -1
L_end:
  s_endpgm

.section .rodata,"a"
.p2align 6
.amdhsa_kernel parallel_sum__linear_attn_block__mixer_channel_mlp__prompt_kernel
  .amdhsa_next_free_vgpr 512
  .amdhsa_next_free_sgpr 102
  .amdhsa_accum_offset 256
  .amdhsa_group_segment_fixed_size 0
  .amdhsa_kernarg_size 88
  .amdhsa_user_sgpr_count 2
  .amdhsa_user_sgpr_kernarg_segment_ptr 1
  .amdhsa_system_sgpr_workgroup_id_x 1
  .amdhsa_float_denorm_mode_32 3
.end_amdhsa_kernel
```
